```python
import torch

def _softmax(x, axis=-1):
    return torch.softmax(x, dim=axis)
def _gelu(x):
    return torch.nn.functional.gelu(x, approximate="tanh")
def _silu(x):
    return torch.nn.functional.silu(x)
def _sigmoid(x):
    return torch.sigmoid(x)
def _layernorm(x, axis=-1, eps=1e-5):
    m = x.mean(dim=axis, keepdim=True)
    v = x.var(dim=axis, keepdim=True, unbiased=False)
    return (x - m) / torch.sqrt(v + eps)
def _scatter_add(tgt, idx, src, axis=0):
    return tgt.clone().index_add_(axis, idx, src)
def _segment_sum(src, seg, n):
    out = torch.zeros((n,) + src.shape[1:], dtype=src.dtype)
    return out.index_add_(0, seg, src)
def _pad(x, pw):
    flat = tuple(v for pair in reversed(pw) for v in pair)
    return torch.nn.functional.pad(x, flat)

kernel_name = 'interleave_layers__linear_attn_block__ssm_conv_s4__prompt'

def setup_inputs():

    _w = (lambda a: (lambda t: t.to(torch.bfloat16) if t.is_floating_point() else t)(torch.as_tensor(a)))
    def _A_setup():
        B, S, D = 1, 2048, 512
        return {
            "x": _w((lambda *s: torch.randn(*s, dtype=torch.bfloat16) * 0.05)(B, S, D)),
            "wqkv": _w((lambda *s: torch.randn(*s, dtype=torch.bfloat16) * 0.05)(D, 3 * D)),
            "wo": _w((lambda *s: torch.randn(*s, dtype=torch.bfloat16) * 0.05)(D, D)),
        }
    _A_in = _A_setup()

    def _B_setup():
        B, L, D, N = 1, 2048, 512, 128
        A_re = -(lambda _x: torch.exp(torch.as_tensor(_x)))((lambda *s: torch.randn(*s, dtype=torch.bfloat16) * 1.6)(D, N))
        A_im = torch.pi * (lambda *s: torch.randn(*s, dtype=torch.bfloat16) * 0.1)(D, N)
        B_re = (lambda *s: torch.randn(*s, dtype=torch.bfloat16) * 0.1)(D, N)
        B_im = (lambda *s: torch.randn(*s, dtype=torch.bfloat16) * 0.1)(D, N)
        C_re = (lambda *s: torch.randn(*s, dtype=torch.bfloat16) * 0.1)(D, N)
        C_im = (lambda *s: torch.randn(*s, dtype=torch.bfloat16) * 0.1)(D, N)
        log_dt = (lambda *s: torch.randn(*s, dtype=torch.bfloat16) * 0.1)(D) * 0.5 - 4.0
        Dskip = (lambda *s: torch.randn(*s, dtype=torch.bfloat16) * 0.1)(D)
        return {
            "u": _w((lambda *s: torch.randn(*s, dtype=torch.bfloat16) * 0.05)(B, L, D)),
            "A_re": _w(A_re),
            "A_im": _w(A_im),
            "B_re": _w(B_re),
            "B_im": _w(B_im),
            "C_re": _w(C_re),
            "C_im": _w(C_im),
            "log_dt": _w(log_dt),
            "Dskip": _w(Dskip),
        }
    _B_in = _B_setup()

    return {
        "A_x": _A_in["x"],
        "A_wqkv": _A_in["wqkv"],
        "A_wo": _A_in["wo"],
        "B_u": _B_in["u"],
        "B_A_re": _B_in["A_re"],
        "B_A_im": _B_in["A_im"],
        "B_B_re": _B_in["B_re"],
        "B_B_im": _B_in["B_im"],
        "B_C_re": _B_in["C_re"],
        "B_C_im": _B_in["C_im"],
        "B_log_dt": _B_in["log_dt"],
        "B_Dskip": _B_in["Dskip"],
    }

def reference(A_x, A_wqkv, A_wo, B_u, B_A_re, B_A_im, B_B_re, B_B_im, B_C_re, B_C_im, B_log_dt, B_Dskip):
    def _A_ref(x, wqkv, wo):
        B, S, D = x.shape
        H = 32; Dh = D // H
        qkv = (lambda x, *d: x.permute(*d))((x @ wqkv).reshape(B, S, 3, H, Dh), 2, 0, 3, 1, 4)
        q, k, v = qkv[0], qkv[1], qkv[2]
        phi = lambda t: torch.where(t > 0, t + 1, torch.exp(t)) + 1e-6
        pq, pk = phi(q), phi(k)
        kv = torch.einsum("bhsd,bhse->bhde", pk, v)
        z = torch.einsum("bhsd->bhd", pk)
        num = torch.einsum("bhqd,bhde->bhqe", pq, kv)
        den = torch.einsum("bhqd,bhd->bhq", pq, z)[..., None] + 1e-6
        o = num / den
        return (lambda x, *d: x.permute(*d))(o, 0, 2, 1, 3).reshape(B, S, D) @ wo

    def _B_ref(u, A_re, A_im, B_re, B_im, C_re, C_im, log_dt, Dskip):
        Bsz, L, D = u.shape
        dt = torch.exp(log_dt)[:, None]
        A = A_re + 1j * A_im
        Bc = B_re + 1j * B_im
        Cc = C_re + 1j * C_im
        logdA = dt * A
        dB = dt * Bc
        l = (lambda x, dt: x.to(dt))(torch.arange(L), A_re.dtype)
        P = torch.exp(logdA[:, :, None] * l[None, None, :])
        K = torch.einsum("dn,dnl,dn->dl", Cc, P, dB).real
        L2 = 2 * L
        Kp = _pad(K, ((0, 0), (0, L)))
        up = (lambda x, *d: x.permute(*d))(u, 0, 2, 1)
        up = _pad(up, ((0, 0), (0, 0), (0, L)))
        Kf = (lambda x, axes=(-2,-1): torch.fft.rfft2(x.float(), dim=axes))(Kp[:, None, :], axes=(-2, -1))
        Uf = (lambda x, axes=(-2,-1): torch.fft.rfft2(x.float(), dim=axes))(up[:, :, None, :], axes=(-2, -1))
        Yf = Uf * Kf[None, :, :, :]
        y = (lambda x, s, axes=(-2,-1): torch.fft.irfft2(x, s=s, dim=axes).to(torch.bfloat16))(Yf, (1, L2), axes=(-2, -1))[:, :, 0, :L]
        y = (lambda x, *d: x.permute(*d))(y, 0, 2, 1) + u * Dskip[None, None, :]
        return y

    x = A_x
    x = x + _A_ref(_layernorm(x, axis=-1), A_wqkv, A_wo)
    x = x + _B_ref(_layernorm(x, axis=-1), B_A_re, B_A_im, B_B_re, B_B_im, B_C_re, B_C_im, B_log_dt, B_Dskip)
    x = x + _A_ref(_layernorm(x, axis=-1), A_wqkv, A_wo)
    x = x + _B_ref(_layernorm(x, axis=-1), B_A_re, B_A_im, B_B_re, B_B_im, B_C_re, B_C_im, B_log_dt, B_Dskip)
    return x
```

```asm
; @launch grid=(256,1,1) block=(256,1,1) lds=163840
.amdgcn_target "amdgcn-amd-amdhsa--gfx950"
.text
.globl interleave_layers__linear_attn_block__ssm_conv_s4__prompt_kernel
.p2align 8
.type interleave_layers__linear_attn_block__ssm_conv_s4__prompt_kernel,@function
interleave_layers__linear_attn_block__ssm_conv_s4__prompt_kernel:
L_code_start:
    s_load_dwordx4 s[44:47], s[0:1], 0
    s_load_dwordx2 s[48:49], s[0:1], 16
    s_load_dwordx4 s[52:55], s[0:1], 96
    s_load_dwordx2 s[50:51], s[0:1], 112
    s_load_dwordx16 s[68:83], s[0:1], 32
    s_cmp_ge_u32 s2, 256
    s_cbranch_scc1 L_end
    v_lshrrev_b32 v5, 6, v0
    v_and_b32 v1, 63, v0
    v_readfirstlane_b32 s28, v5
    s_getpc_b64 s[56:57]
L_pc0:
    s_sub_u32 s56, s56, L_pc0-L_code_start
    s_subb_u32 s57, s57, 0
    s_lshr_b32 s58, s2, 3
    s_lshl_b32 s59, s58, 2
    s_add_u32 s59, s59, s28
    s_lshl_b32 s59, s59, 10
    s_min_u32 s59, s59, L_code_end-L_code_start-1024
    v_lshl_add_u32 v5, v1, 4, s59
    global_load_dwordx4 v[232:235], v5, s[56:57]
    v_and_b32 v2, 15, v1
    v_lshrrev_b32 v3, 4, v1
    v_mov_b32 v4, 0x7ffffff0
    s_and_b32 s60, s2, 7
    s_lshr_b32 s29, s60, 1
    s_lshl_b32 s29, s29, 3
    s_and_b32 s61, s58, 7
    s_add_u32 s29, s29, s61
    s_and_b32 s30, s60, 1
    s_lshl_b32 s30, s30, 2
    s_lshr_b32 s61, s58, 3
    s_add_u32 s30, s30, s61
    s_lshl_b32 s31, s60, 2
    s_and_b32 s61, s58, 3
    s_add_u32 s31, s31, s61
    s_lshr_b32 s32, s58, 2
    s_lshl_b32 s33, s60, 4
    s_and_b32 s61, s58, 15
    s_add_u32 s33, s33, s61
    s_lshr_b32 s34, s58, 4
    s_lshl_b32 s35, s30, 2
    s_add_u32 s35, s35, s28
    s_lshl_b32 s61, s2, 9
    v_lshl_add_u32 v9, v0, 1, s61
    s_lshl_b32 s61, s2, 2
    s_lshl_b32 s59, s33, 3
    s_lshr_b32 s57, s28, 1
    s_lshl_b32 s56, s57, 2
    s_add_u32 s59, s59, s56
    v_lshrrev_b32 v6, 1, v1
    v_lshlrev_b32 v6, 10, v6
    v_and_b32 v7, 1, v1
    v_lshl_add_u32 v6, v7, 7, v6
    v_cmp_gt_u32 vcc, 32, v0
    s_nop 1
    v_cndmask_b32 v36, v4, v6, vcc
    v_lshrrev_b32 v6, 2, v1
    v_lshlrev_b32 v6, 10, v6
    v_and_b32 v7, 3, v1
    v_lshl_add_u32 v6, v7, 7, v6
    v_cmp_gt_u32 vcc, 48, v0
    s_nop 1
    v_cndmask_b32 v37, v4, v6, vcc
    s_lshr_b32 s40, s29, 3
    s_lshl_b32 s40, s40, 19
    s_lshl_b32 s41, s58, 14
    s_add_u32 s40, s40, s41
    s_mul_i32 s41, s58, 12288
    s_lshr_b32 s60, s30, 2
    s_lshl_b32 s60, s60, 9
    s_add_u32 s41, s41, s60
    s_waitcnt lgkmcnt(0)
    global_load_ushort a192, v9, s[68:69]
    global_load_ushort a193, v9, s[70:71]
    global_load_ushort a194, v9, s[72:73]
    global_load_ushort a195, v9, s[74:75]
    global_load_ushort a196, v9, s[76:77]
    global_load_ushort a197, v9, s[78:79]
    s_mov_b32 s8, s46
    s_and_b32 s9, s47, 0xffff
    s_mov_b32 s10, 0x00180000
    s_mov_b32 s11, 0x20000
    buffer_load_dword v222, v37, s[8:11], s41 offen
    s_mov_b32 s4, s44
    s_and_b32 s5, s45, 0xffff
    s_mov_b32 s6, 0x00200000
    s_mov_b32 s7, 0x20000
    buffer_load_dword v223, v36, s[4:7], s40 offen
    s_load_dword s38, s[80:81], s61
    s_load_dword s39, s[82:83], s59
    s_mov_b32 s37, s57
    s_mov_b32 s16, s50
    s_and_b32 s17, s51, 0xffff
    s_mov_b32 s18, 0x01000000
    s_mov_b32 s19, 0x20000
    s_mov_b32 s20, s54
    s_and_b32 s21, s55, 0xffff
    s_mov_b32 s22, 0x00000100
    s_mov_b32 s23, 0x20000
    s_mov_b32 s12, s48
    s_and_b32 s13, s49, 0xffff
    s_mov_b32 s14, 0x00080000
    s_mov_b32 s15, 0x20000
    s_mov_b32 s24, s52
    s_and_b32 s25, s53, 0xffff
    s_mov_b32 s26, 0x00200000
    s_mov_b32 s27, 0x20000
    v_lshrrev_b32 v5, 3, v1
    v_and_b32 v6, 7, v1
    s_and_b32 s61, s28, 1
    s_lshl_b32 s61, s61, 2
    v_lshrrev_b32 v7, 1, v5
    v_or_b32 v7, s61, v7
    v_xor_b32 v7, v7, v6
    v_lshlrev_b32 v7, 4, v7
    v_lshl_add_u32 v10, v5, 10, v7
    v_and_b32 v7, 2, v5
    v_or_b32 v7, s61, v7
    v_xor_b32 v7, v7, v6
    v_lshlrev_b32 v7, 4, v7
    v_mul_u32_u24 v8, 3072, v5
    v_add_u32 v11, v7, v8
    s_lshl_b32 s62, s29, 16
    s_lshl_b32 s61, s28, 13
    s_add_u32 s62, s62, s61
    s_mul_i32 s63, s28, 24576
    s_lshl_b32 s61, s30, 7
    s_add_u32 s63, s63, s61
    s_lshl_b32 s64, s28, 13
    v_add_u32 v30, 29696, v10
    v_add_u32 v31, 98304, v11
    v_add_u32 v32, 95232, v11
    v_mov_b32 v16, 0
    v_mov_b32 v17, 0
    v_mov_b32 v18, 0
    v_mov_b32 v19, 0
    s_mul_i32 s36, s35, 1088
    s_add_u32 s44, s36, 0x00f00000
    s_cmp_eq_u32 s29, 0
    s_cselect_b32 s45, s44, 0x7ffffff0
    v_lshlrev_b32 v7, 4, v1
    v_add_u32 v12, s45, v7
    s_mul_i32 s46, s2, 288
    s_add_u32 s46, s46, 0x00f08fc0
    s_cmp_eq_u32 s28, 1
    s_cselect_b32 s46, s46, 0x7ffffff0
    v_add_u32 v13, 1024, v12
    v_add_u32 v8, s46, v7
    v_cmp_gt_u32 vcc, 4, v1
    s_nop 1
    v_cndmask_b32 v13, v8, v13, vcc
    v_cmp_gt_u32 vcc, 22, v1
    s_nop 1
    v_cndmask_b32 v13, v4, v13, vcc
    s_mov_b32 s46, 0x00f1b000
    s_cmp_eq_u32 s2, 0
    s_cselect_b32 s46, s46, 0x7ffffff0
    v_lshlrev_b32 v38, 8, v0
    v_add_u32 v38, s46, v38
    v_cmp_gt_u32 vcc, 32, v0
    s_nop 1
    v_cndmask_b32 v38, v4, v38, vcc
    s_lshl_b32 s47, s35, 2
    s_add_u32 s47, s47, 64
    s_cmp_eq_u32 s29, 0
    s_cselect_b32 s45, s47, 0x7ffffff0
    v_mov_b32 v14, s45
    v_cmp_eq_u32 vcc, 0, v1
    s_nop 1
    v_cndmask_b32 v14, v4, v14, vcc
    s_lshl_b32 s45, s28, 2
    s_add_u32 s45, s45, 192
    s_cmp_eq_u32 s2, 0
    s_cselect_b32 s45, s45, 0x7ffffff0
    v_mov_b32 v8, s45
    v_cmp_eq_u32 vcc, 1, v1
    s_nop 1
    v_cndmask_b32 v14, v14, v8, vcc
    v_mov_b32 v15, s47
    v_mov_b32 v8, 192
    v_cndmask_b32 v15, v15, v8, vcc
    v_lshrrev_b32 v5, 1, v2
    v_xor_b32 v5, v5, v3
    v_lshlrev_b32 v5, 4, v5
    v_and_b32 v6, 7, v2
    v_lshl_add_u32 v5, v6, 7, v5
    v_lshrrev_b32 v6, 3, v2
    v_lshl_add_u32 v6, v6, 13, v5
    v_xor_b32 v7, 64, v6
    s_xor_b32 s44, s28, 0
    s_and_b32 s45, s44, 1
    s_lshl_b32 s45, s45, 14
    s_lshr_b32 s44, s44, 1
    s_mul_i32 s44, s44, 3072
    s_add_u32 s45, s45, s44
    v_add_u32 v20, s45, v6
    v_add_u32 v21, s45, v7
    s_xor_b32 s44, s28, 1
    s_and_b32 s45, s44, 1
    s_lshl_b32 s45, s45, 14
    s_lshr_b32 s44, s44, 1
    s_mul_i32 s44, s44, 3072
    s_add_u32 s45, s45, s44
    v_add_u32 v22, s45, v6
    v_add_u32 v23, s45, v7
    s_xor_b32 s44, s28, 2
    s_and_b32 s45, s44, 1
    s_lshl_b32 s45, s45, 14
    s_lshr_b32 s44, s44, 1
    s_mul_i32 s44, s44, 3072
    s_add_u32 s45, s45, s44
    v_add_u32 v24, s45, v6
    v_add_u32 v25, s45, v7
    s_xor_b32 s44, s28, 3
    s_and_b32 s45, s44, 1
    s_lshl_b32 s45, s45, 14
    s_lshr_b32 s44, s44, 1
    s_mul_i32 s44, s44, 3072
    s_add_u32 s45, s45, s44
    v_add_u32 v26, s45, v6
    v_add_u32 v27, s45, v7
    v_lshrrev_b32 v5, 2, v2
    v_lshlrev_b32 v6, 7, v5
    v_lshl_add_u32 v6, v3, 13, v6
    v_lshrrev_b32 v5, 1, v5
    v_and_b32 v7, 1, v3
    v_lshl_or_b32 v5, v7, 1, v5
    v_xor_b32 v5, s28, v5
    v_lshl_add_u32 v6, v5, 5, v6
    v_and_b32 v7, 3, v2
    v_lshl_add_u32 v28, v7, 3, v6
    v_mov_b32 v240, 0x3f803f80
    v_mov_b32 v241, 0x3f803f80
    v_mov_b32 v242, 0x3f803f80
    v_mov_b32 v243, 0x3f803f80
    s_add_u32 s41, s41, 393216
    buffer_load_dword v224, v37, s[8:11], s41 offen
    buffer_load_dword v225, v36, s[4:7], s40 offen offset:256
    s_lshl_b32 s46, s28, 14
    s_add_u32 s46, s46, 98304
    v_lshl_add_u32 v8, v1, 2, s46
    v_xor_b32 v124, 0, v8
    v_xor_b32 v125, 32, v8
    v_xor_b32 v126, 64, v8
    v_xor_b32 v127, 96, v8
    v_xor_b32 v128, 128, v8
    v_xor_b32 v129, 160, v8
    v_xor_b32 v130, 192, v8
    v_xor_b32 v131, 224, v8
    v_and_b32 v5, 14, v2
    v_xor_b32 v5, v5, v3
    v_lshlrev_b32 v5, 4, v5
    v_lshl_add_u32 v5, v2, 8, v5
    v_add_u32 v5, s46, v5
    v_xor_b32 v140, 0, v5
    v_xor_b32 v141, 64, v5
    v_xor_b32 v142, 128, v5
    v_xor_b32 v143, 192, v5
    s_waitcnt lgkmcnt(0)
    s_lshl_b32 s46, s38, 16
    s_and_b32 s47, s38, 0xffff0000
    s_cmp_eq_u32 s37, 0
    s_cselect_b32 s38, s46, s47
    s_and_b32 s48, s28, 1
    s_lshl_b32 s46, s39, 16
    s_and_b32 s47, s39, 0xffff0000
    s_cmp_eq_u32 s48, 0
    s_cselect_b32 s39, s46, s47
    s_lshl_b32 s49, s2, 2
    s_add_u32 s49, s49, s28
    s_mul_i32 s49, s49, 3072
    s_add_u32 s49, s49, 0x00a00000
    v_lshlrev_b32 v29, 4, v1
    v_mov_b32 v7, s38
    v_mul_f32 v7, 0x3fb8aa3b, v7
    v_exp_f32 v7, v7
    s_nop 0
    v_cvt_pk_bf16_f32 v7, v7, v7
    v_and_b32 v7, 0xffff0000, v7
    s_waitcnt vmcnt(9)
    v_accvgpr_read_b32 v40, a192
    s_waitcnt vmcnt(8)
    v_accvgpr_read_b32 v41, a193
    s_waitcnt vmcnt(7)
    v_accvgpr_read_b32 v42, a194
    s_waitcnt vmcnt(6)
    v_accvgpr_read_b32 v43, a195
    s_waitcnt vmcnt(5)
    v_accvgpr_read_b32 v44, a196
    s_waitcnt vmcnt(4)
    v_accvgpr_read_b32 v45, a197
    v_lshlrev_b32 v40, 16, v40
    v_lshlrev_b32 v41, 16, v41
    v_lshlrev_b32 v42, 16, v42
    v_lshlrev_b32 v43, 16, v43
    v_lshlrev_b32 v44, 16, v44
    v_lshlrev_b32 v45, 16, v45
    v_mul_f32 v40, v40, v7
    v_mul_f32 v41, v41, v7
    v_mul_f32 v42, v42, v7
    v_mul_f32 v43, v43, v7
    v_mul_f32 v40, 0x3fb8aa3b, v40
    v_mul_f32 v41, 0x3e22f983, v41
    v_pk_mul_f32 v[46:47], v[44:45], v[42:43] op_sel:[0,0] op_sel_hi:[0,1]
    v_pk_fma_f32 v[46:47], v[44:45], v[42:43], v[46:47] op_sel:[1,1,0] op_sel_hi:[1,0,1] neg_lo:[1,0,0]
    v_mul_f32 v74, 0x41000000, v40
    v_mul_f32 v75, 0x41000000, v41
    v_exp_f32 v74, v74
    v_fract_f32 v75, v75
    v_cos_f32 v48, v75
    v_sin_f32 v49, v75
    v_mul_f32 v48, v48, v74
    v_mul_f32 v49, -v49, v74
    v_mul_f32 v74, 0x43000000, v40
    v_mul_f32 v75, 0x43000000, v41
    v_exp_f32 v74, v74
    v_fract_f32 v75, v75
    v_cos_f32 v50, v75
    v_sin_f32 v51, v75
    v_mul_f32 v50, v50, v74
    v_mul_f32 v51, v51, v74
    v_mul_f32 v74, 0x3f800000, v40
    v_mul_f32 v75, 0x3f800000, v41
    v_exp_f32 v74, v74
    v_fract_f32 v75, v75
    v_cos_f32 v54, v75
    v_sin_f32 v55, v75
    v_mul_f32 v54, v54, v74
    v_mul_f32 v55, v55, v74
    v_mov_b32 v80, 0x3f80
    v_cvt_pk_bf16_f32 v81, v48, v49
    v_pk_mul_f32 v[68:69], v[48:49], v[48:49] op_sel:[0,0] op_sel_hi:[0,1]
    v_pk_fma_f32 v[68:69], v[48:49], v[48:49], v[68:69] op_sel:[1,1,0] op_sel_hi:[1,0,1] neg_lo:[1,0,0]
    ds_write2st64_b32 v124, v80, v81 offset0:48 offset1:49
    s_add_u32 s41, s41, 393216
    buffer_load_dword v226, v37, s[8:11], s41 offen
    buffer_load_dword v227, v36, s[4:7], s40 offen offset:512
    v_cvt_pk_bf16_f32 v82, v68, v69
    v_pk_mul_f32 v[70:71], v[68:69], v[48:49] op_sel:[0,0] op_sel_hi:[0,1]
    v_pk_fma_f32 v[70:71], v[68:69], v[48:49], v[70:71] op_sel:[1,1,0] op_sel_hi:[1,0,1] neg_lo:[1,0,0]
    v_cvt_pk_bf16_f32 v83, v70, v71
    v_pk_mul_f32 v[68:69], v[70:71], v[48:49] op_sel:[0,0] op_sel_hi:[0,1]
    v_pk_fma_f32 v[68:69], v[70:71], v[48:49], v[68:69] op_sel:[1,1,0] op_sel_hi:[1,0,1] neg_lo:[1,0,0]
    ds_write2st64_b32 v125, v82, v83 offset0:50 offset1:51
    buffer_store_dwordx4 v[16:19], v12, s[16:19], 0 offen sc1
    v_cvt_pk_bf16_f32 v84, v68, v69
    v_pk_mul_f32 v[70:71], v[68:69], v[48:49] op_sel:[0,0] op_sel_hi:[0,1]
    v_pk_fma_f32 v[70:71], v[68:69], v[48:49], v[70:71] op_sel:[1,1,0] op_sel_hi:[1,0,1] neg_lo:[1,0,0]
    v_cvt_pk_bf16_f32 v85, v70, v71
    v_pk_mul_f32 v[68:69], v[70:71], v[48:49] op_sel:[0,0] op_sel_hi:[0,1]
    v_pk_fma_f32 v[68:69], v[70:71], v[48:49], v[68:69] op_sel:[1,1,0] op_sel_hi:[1,0,1] neg_lo:[1,0,0]
    ds_write2st64_b32 v126, v84, v85 offset0:52 offset1:53
    buffer_store_dwordx4 v[16:19], v13, s[16:19], 0 offen sc1
    v_cvt_pk_bf16_f32 v86, v68, v69
    v_pk_mul_f32 v[70:71], v[68:69], v[48:49] op_sel:[0,0] op_sel_hi:[0,1]
    v_pk_fma_f32 v[70:71], v[68:69], v[48:49], v[70:71] op_sel:[1,1,0] op_sel_hi:[1,0,1] neg_lo:[1,0,0]
    v_cvt_pk_bf16_f32 v87, v70, v71
    v_pk_mul_f32 v[68:69], v[70:71], v[48:49] op_sel:[0,0] op_sel_hi:[0,1]
    v_pk_fma_f32 v[68:69], v[70:71], v[48:49], v[68:69] op_sel:[1,1,0] op_sel_hi:[1,0,1] neg_lo:[1,0,0]
    ds_write2st64_b32 v127, v86, v87 offset0:54 offset1:55
    buffer_store_dword v16, v38, s[16:19], 0 offen sc1
    v_cvt_pk_bf16_f32 v88, v68, v69
    v_pk_mul_f32 v[70:71], v[68:69], v[48:49] op_sel:[0,0] op_sel_hi:[0,1]
    v_pk_fma_f32 v[70:71], v[68:69], v[48:49], v[70:71] op_sel:[1,1,0] op_sel_hi:[1,0,1] neg_lo:[1,0,0]
    v_cvt_pk_bf16_f32 v89, v70, v71
    v_pk_mul_f32 v[68:69], v[70:71], v[48:49] op_sel:[0,0] op_sel_hi:[0,1]
    v_pk_fma_f32 v[68:69], v[70:71], v[48:49], v[68:69] op_sel:[1,1,0] op_sel_hi:[1,0,1] neg_lo:[1,0,0]
    ds_write2st64_b32 v128, v88, v89 offset0:56 offset1:57
    v_cvt_pk_bf16_f32 v90, v68, v69
    v_pk_mul_f32 v[70:71], v[68:69], v[48:49] op_sel:[0,0] op_sel_hi:[0,1]
    v_pk_fma_f32 v[70:71], v[68:69], v[48:49], v[70:71] op_sel:[1,1,0] op_sel_hi:[1,0,1] neg_lo:[1,0,0]
    v_cvt_pk_bf16_f32 v91, v70, v71
    v_pk_mul_f32 v[68:69], v[70:71], v[48:49] op_sel:[0,0] op_sel_hi:[0,1]
    v_pk_fma_f32 v[68:69], v[70:71], v[48:49], v[68:69] op_sel:[1,1,0] op_sel_hi:[1,0,1] neg_lo:[1,0,0]
    ds_write2st64_b32 v129, v90, v91 offset0:58 offset1:59
    v_cvt_pk_bf16_f32 v92, v68, v69
    v_pk_mul_f32 v[70:71], v[68:69], v[48:49] op_sel:[0,0] op_sel_hi:[0,1]
    v_pk_fma_f32 v[70:71], v[68:69], v[48:49], v[70:71] op_sel:[1,1,0] op_sel_hi:[1,0,1] neg_lo:[1,0,0]
    v_cvt_pk_bf16_f32 v93, v70, v71
    v_pk_mul_f32 v[68:69], v[70:71], v[48:49] op_sel:[0,0] op_sel_hi:[0,1]
    v_pk_fma_f32 v[68:69], v[70:71], v[48:49], v[68:69] op_sel:[1,1,0] op_sel_hi:[1,0,1] neg_lo:[1,0,0]
    ds_write2st64_b32 v130, v92, v93 offset0:60 offset1:61
    v_cvt_pk_bf16_f32 v94, v68, v69
    v_pk_mul_f32 v[70:71], v[68:69], v[48:49] op_sel:[0,0] op_sel_hi:[0,1]
    v_pk_fma_f32 v[70:71], v[68:69], v[48:49], v[70:71] op_sel:[1,1,0] op_sel_hi:[1,0,1] neg_lo:[1,0,0]
    v_cvt_pk_bf16_f32 v95, v70, v71
    v_pk_mul_f32 v[56:57], v[54:55], v[54:55] op_sel:[0,0] op_sel_hi:[0,1]
    v_pk_fma_f32 v[56:57], v[54:55], v[54:55], v[56:57] op_sel:[1,1,0] op_sel_hi:[1,0,1] neg_lo:[1,0,0]
    v_pk_mul_f32 v[58:59], v[56:57], v[54:55] op_sel:[0,0] op_sel_hi:[0,1]
    v_pk_fma_f32 v[58:59], v[56:57], v[54:55], v[58:59] op_sel:[1,1,0] op_sel_hi:[1,0,1] neg_lo:[1,0,0]
    v_pk_mul_f32 v[60:61], v[58:59], v[54:55] op_sel:[0,0] op_sel_hi:[0,1]
    v_pk_fma_f32 v[60:61], v[58:59], v[54:55], v[60:61] op_sel:[1,1,0] op_sel_hi:[1,0,1] neg_lo:[1,0,0]
    v_pk_mul_f32 v[62:63], v[60:61], v[54:55] op_sel:[0,0] op_sel_hi:[0,1]
    v_pk_fma_f32 v[62:63], v[60:61], v[54:55], v[62:63] op_sel:[1,1,0] op_sel_hi:[1,0,1] neg_lo:[1,0,0]
    v_pk_mul_f32 v[64:65], v[62:63], v[54:55] op_sel:[0,0] op_sel_hi:[0,1]
    v_pk_fma_f32 v[64:65], v[62:63], v[54:55], v[64:65] op_sel:[1,1,0] op_sel_hi:[1,0,1] neg_lo:[1,0,0]
    v_pk_mul_f32 v[66:67], v[64:65], v[54:55] op_sel:[0,0] op_sel_hi:[0,1]
    v_pk_fma_f32 v[66:67], v[64:65], v[54:55], v[66:67] op_sel:[1,1,0] op_sel_hi:[1,0,1] neg_lo:[1,0,0]
    ds_write2st64_b32 v131, v94, v95 offset0:62 offset1:63
    v_cvt_pk_bf16_f32 v96, v46, v47
    v_pk_mul_f32 v[72:73], v[46:47], v[54:55] op_sel:[0,0] op_sel_hi:[0,1]
    v_pk_fma_f32 v[72:73], v[46:47], v[54:55], v[72:73] op_sel:[1,1,0] op_sel_hi:[1,0,1] neg_lo:[1,0,0]
    v_cvt_pk_bf16_f32 v97, v72, v73
    v_pk_mul_f32 v[72:73], v[46:47], v[56:57] op_sel:[0,0] op_sel_hi:[0,1]
    v_pk_fma_f32 v[72:73], v[46:47], v[56:57], v[72:73] op_sel:[1,1,0] op_sel_hi:[1,0,1] neg_lo:[1,0,0]
    ds_write2st64_b32 v124, v96, v97 offset0:0 offset1:1
    v_cvt_pk_bf16_f32 v98, v72, v73
    v_pk_mul_f32 v[72:73], v[46:47], v[58:59] op_sel:[0,0] op_sel_hi:[0,1]
    v_pk_fma_f32 v[72:73], v[46:47], v[58:59], v[72:73] op_sel:[1,1,0] op_sel_hi:[1,0,1] neg_lo:[1,0,0]
    v_cvt_pk_bf16_f32 v99, v72, v73
    v_pk_mul_f32 v[72:73], v[46:47], v[60:61] op_sel:[0,0] op_sel_hi:[0,1]
    v_pk_fma_f32 v[72:73], v[46:47], v[60:61], v[72:73] op_sel:[1,1,0] op_sel_hi:[1,0,1] neg_lo:[1,0,0]
    ds_write2st64_b32 v125, v98, v99 offset0:2 offset1:3
    v_cvt_pk_bf16_f32 v100, v72, v73
    v_pk_mul_f32 v[72:73], v[46:47], v[62:63] op_sel:[0,0] op_sel_hi:[0,1]
    v_pk_fma_f32 v[72:73], v[46:47], v[62:63], v[72:73] op_sel:[1,1,0] op_sel_hi:[1,0,1] neg_lo:[1,0,0]
    v_cvt_pk_bf16_f32 v101, v72, v73
    v_pk_mul_f32 v[72:73], v[46:47], v[64:65] op_sel:[0,0] op_sel_hi:[0,1]
    v_pk_fma_f32 v[72:73], v[46:47], v[64:65], v[72:73] op_sel:[1,1,0] op_sel_hi:[1,0,1] neg_lo:[1,0,0]
    ds_write2st64_b32 v126, v100, v101 offset0:4 offset1:5
    s_add_u32 s41, s41, 393216
    buffer_load_dword v228, v37, s[8:11], s41 offen
    buffer_load_dword v229, v36, s[4:7], s40 offen offset:768
    v_cvt_pk_bf16_f32 v102, v72, v73
    v_pk_mul_f32 v[72:73], v[46:47], v[66:67] op_sel:[0,0] op_sel_hi:[0,1]
    v_pk_fma_f32 v[72:73], v[46:47], v[66:67], v[72:73] op_sel:[1,1,0] op_sel_hi:[1,0,1] neg_lo:[1,0,0]
    v_cvt_pk_bf16_f32 v103, v72, v73
    v_pk_mul_f32 v[70:71], v[46:47], v[50:51] op_sel:[0,0] op_sel_hi:[0,1]
    v_pk_fma_f32 v[70:71], v[46:47], v[50:51], v[70:71] op_sel:[1,1,0] op_sel_hi:[1,0,1] neg_lo:[1,0,0]
    ds_write2st64_b32 v127, v102, v103 offset0:6 offset1:7
    v_cvt_pk_bf16_f32 v104, v70, v71
    v_pk_mul_f32 v[72:73], v[70:71], v[54:55] op_sel:[0,0] op_sel_hi:[0,1]
    v_pk_fma_f32 v[72:73], v[70:71], v[54:55], v[72:73] op_sel:[1,1,0] op_sel_hi:[1,0,1] neg_lo:[1,0,0]
    v_cvt_pk_bf16_f32 v105, v72, v73
    v_pk_mul_f32 v[72:73], v[70:71], v[56:57] op_sel:[0,0] op_sel_hi:[0,1]
    v_pk_fma_f32 v[72:73], v[70:71], v[56:57], v[72:73] op_sel:[1,1,0] op_sel_hi:[1,0,1] neg_lo:[1,0,0]
    ds_write2st64_b32 v128, v104, v105 offset0:8 offset1:9
    v_cvt_pk_bf16_f32 v106, v72, v73
    v_pk_mul_f32 v[72:73], v[70:71], v[58:59] op_sel:[0,0] op_sel_hi:[0,1]
    v_pk_fma_f32 v[72:73], v[70:71], v[58:59], v[72:73] op_sel:[1,1,0] op_sel_hi:[1,0,1] neg_lo:[1,0,0]
    v_cvt_pk_bf16_f32 v107, v72, v73
    v_pk_mul_f32 v[72:73], v[70:71], v[60:61] op_sel:[0,0] op_sel_hi:[0,1]
    v_pk_fma_f32 v[72:73], v[70:71], v[60:61], v[72:73] op_sel:[1,1,0] op_sel_hi:[1,0,1] neg_lo:[1,0,0]
    ds_write2st64_b32 v129, v106, v107 offset0:10 offset1:11
    v_cvt_pk_bf16_f32 v108, v72, v73
    v_pk_mul_f32 v[72:73], v[70:71], v[62:63] op_sel:[0,0] op_sel_hi:[0,1]
    v_pk_fma_f32 v[72:73], v[70:71], v[62:63], v[72:73] op_sel:[1,1,0] op_sel_hi:[1,0,1] neg_lo:[1,0,0]
    v_cvt_pk_bf16_f32 v109, v72, v73
    v_pk_mul_f32 v[72:73], v[70:71], v[64:65] op_sel:[0,0] op_sel_hi:[0,1]
    v_pk_fma_f32 v[72:73], v[70:71], v[64:65], v[72:73] op_sel:[1,1,0] op_sel_hi:[1,0,1] neg_lo:[1,0,0]
    ds_write2st64_b32 v130, v108, v109 offset0:12 offset1:13
    v_cvt_pk_bf16_f32 v110, v72, v73
    v_pk_mul_f32 v[72:73], v[70:71], v[66:67] op_sel:[0,0] op_sel_hi:[0,1]
    v_pk_fma_f32 v[72:73], v[70:71], v[66:67], v[72:73] op_sel:[1,1,0] op_sel_hi:[1,0,1] neg_lo:[1,0,0]
    v_cvt_pk_bf16_f32 v111, v72, v73
    v_pk_mul_f32 v[68:69], v[70:71], v[50:51] op_sel:[0,0] op_sel_hi:[0,1]
    v_pk_fma_f32 v[68:69], v[70:71], v[50:51], v[68:69] op_sel:[1,1,0] op_sel_hi:[1,0,1] neg_lo:[1,0,0]
    ds_write2st64_b32 v131, v110, v111 offset0:14 offset1:15
    v_cvt_pk_bf16_f32 v112, v68, v69
    v_pk_mul_f32 v[72:73], v[68:69], v[56:57] op_sel:[0,0] op_sel_hi:[0,1]
    v_pk_fma_f32 v[72:73], v[68:69], v[56:57], v[72:73] op_sel:[1,1,0] op_sel_hi:[1,0,1] neg_lo:[1,0,0]
    v_cvt_pk_bf16_f32 v113, v72, v73
    v_pk_mul_f32 v[72:73], v[68:69], v[60:61] op_sel:[0,0] op_sel_hi:[0,1]
    v_pk_fma_f32 v[72:73], v[68:69], v[60:61], v[72:73] op_sel:[1,1,0] op_sel_hi:[1,0,1] neg_lo:[1,0,0]
    v_cvt_pk_bf16_f32 v114, v72, v73
    v_pk_mul_f32 v[72:73], v[68:69], v[64:65] op_sel:[0,0] op_sel_hi:[0,1]
    v_pk_fma_f32 v[72:73], v[68:69], v[64:65], v[72:73] op_sel:[1,1,0] op_sel_hi:[1,0,1] neg_lo:[1,0,0]
    ds_write2st64_b32 v124, v112, v114 offset0:16 offset1:17
    v_cvt_pk_bf16_f32 v115, v72, v73
    v_pk_mul_f32 v[70:71], v[68:69], v[50:51] op_sel:[0,0] op_sel_hi:[0,1]
    v_pk_fma_f32 v[70:71], v[68:69], v[50:51], v[70:71] op_sel:[1,1,0] op_sel_hi:[1,0,1] neg_lo:[1,0,0]
    ds_write2st64_b32 v126, v113, v115 offset0:20 offset1:21
    v_cvt_pk_bf16_f32 v116, v70, v71
    v_pk_mul_f32 v[72:73], v[70:71], v[56:57] op_sel:[0,0] op_sel_hi:[0,1]
    v_pk_fma_f32 v[72:73], v[70:71], v[56:57], v[72:73] op_sel:[1,1,0] op_sel_hi:[1,0,1] neg_lo:[1,0,0]
    v_cvt_pk_bf16_f32 v117, v72, v73
    v_pk_mul_f32 v[72:73], v[70:71], v[60:61] op_sel:[0,0] op_sel_hi:[0,1]
    v_pk_fma_f32 v[72:73], v[70:71], v[60:61], v[72:73] op_sel:[1,1,0] op_sel_hi:[1,0,1] neg_lo:[1,0,0]
    v_cvt_pk_bf16_f32 v118, v72, v73
    v_pk_mul_f32 v[72:73], v[70:71], v[64:65] op_sel:[0,0] op_sel_hi:[0,1]
    v_pk_fma_f32 v[72:73], v[70:71], v[64:65], v[72:73] op_sel:[1,1,0] op_sel_hi:[1,0,1] neg_lo:[1,0,0]
    ds_write2st64_b32 v125, v116, v118 offset0:18 offset1:19
    v_cvt_pk_bf16_f32 v119, v72, v73
    v_pk_mul_f32 v[68:69], v[70:71], v[50:51] op_sel:[0,0] op_sel_hi:[0,1]
    v_pk_fma_f32 v[68:69], v[70:71], v[50:51], v[68:69] op_sel:[1,1,0] op_sel_hi:[1,0,1] neg_lo:[1,0,0]
    ds_write2st64_b32 v127, v117, v119 offset0:22 offset1:23
    v_cvt_pk_bf16_f32 v120, v68, v69
    v_pk_mul_f32 v[72:73], v[68:69], v[60:61] op_sel:[0,0] op_sel_hi:[0,1]
    v_pk_fma_f32 v[72:73], v[68:69], v[60:61], v[72:73] op_sel:[1,1,0] op_sel_hi:[1,0,1] neg_lo:[1,0,0]
    v_cvt_pk_bf16_f32 v121, v72, v73
    v_pk_mul_f32 v[70:71], v[68:69], v[50:51] op_sel:[0,0] op_sel_hi:[0,1]
    v_pk_fma_f32 v[70:71], v[68:69], v[50:51], v[70:71] op_sel:[1,1,0] op_sel_hi:[1,0,1] neg_lo:[1,0,0]
    ds_write2st64_b32 v128, v120, v121 offset0:24 offset1:25
    v_cvt_pk_bf16_f32 v122, v70, v71
    v_pk_mul_f32 v[72:73], v[70:71], v[60:61] op_sel:[0,0] op_sel_hi:[0,1]
    v_pk_fma_f32 v[72:73], v[70:71], v[60:61], v[72:73] op_sel:[1,1,0] op_sel_hi:[1,0,1] neg_lo:[1,0,0]
    v_cvt_pk_bf16_f32 v123, v72, v73
    v_pk_mul_f32 v[68:69], v[70:71], v[50:51] op_sel:[0,0] op_sel_hi:[0,1]
    v_pk_fma_f32 v[68:69], v[70:71], v[50:51], v[68:69] op_sel:[1,1,0] op_sel_hi:[1,0,1] neg_lo:[1,0,0]
    ds_write2st64_b32 v129, v122, v123 offset0:26 offset1:27
    s_add_u32 m0, s64, 0
    s_add_u32 s66, s62, 0
    buffer_load_dwordx4 v10, s[4:7], s66 offen offset:0 lds
    v_cvt_pk_bf16_f32 v80, v68, v69
    v_pk_mul_f32 v[72:73], v[68:69], v[60:61] op_sel:[0,0] op_sel_hi:[0,1]
    v_pk_fma_f32 v[72:73], v[68:69], v[60:61], v[72:73] op_sel:[1,1,0] op_sel_hi:[1,0,1] neg_lo:[1,0,0]
    v_cvt_pk_bf16_f32 v81, v72, v73
    v_pk_mul_f32 v[70:71], v[68:69], v[50:51] op_sel:[0,0] op_sel_hi:[0,1]
    v_pk_fma_f32 v[70:71], v[68:69], v[50:51], v[70:71] op_sel:[1,1,0] op_sel_hi:[1,0,1] neg_lo:[1,0,0]
    ds_write2st64_b32 v130, v80, v81 offset0:28 offset1:29
    s_add_u32 s67, s63, 0
    buffer_load_dwordx4 v11, s[8:11], s67 offen offset:1024 lds
    v_cvt_pk_bf16_f32 v82, v70, v71
    v_pk_mul_f32 v[72:73], v[70:71], v[60:61] op_sel:[0,0] op_sel_hi:[0,1]
    v_pk_fma_f32 v[72:73], v[70:71], v[60:61], v[72:73] op_sel:[1,1,0] op_sel_hi:[1,0,1] neg_lo:[1,0,0]
    v_cvt_pk_bf16_f32 v83, v72, v73
    v_pk_mul_f32 v[68:69], v[70:71], v[50:51] op_sel:[0,0] op_sel_hi:[0,1]
    v_pk_fma_f32 v[68:69], v[70:71], v[50:51], v[68:69] op_sel:[1,1,0] op_sel_hi:[1,0,1] neg_lo:[1,0,0]
    ds_write2st64_b32 v131, v82, v83 offset0:30 offset1:31
    buffer_load_dwordx4 v11, s[8:11], s67 offen offset:2048 lds
    v_cvt_pk_bf16_f32 v84, v68, v69
    v_pk_mul_f32 v[70:71], v[68:69], v[50:51] op_sel:[0,0] op_sel_hi:[0,1]
    v_pk_fma_f32 v[70:71], v[68:69], v[50:51], v[70:71] op_sel:[1,1,0] op_sel_hi:[1,0,1] neg_lo:[1,0,0]
    v_cvt_pk_bf16_f32 v85, v70, v71
    v_pk_mul_f32 v[68:69], v[70:71], v[50:51] op_sel:[0,0] op_sel_hi:[0,1]
    v_pk_fma_f32 v[68:69], v[70:71], v[50:51], v[68:69] op_sel:[1,1,0] op_sel_hi:[1,0,1] neg_lo:[1,0,0]
    ds_write2st64_b32 v124, v84, v85 offset0:32 offset1:33
    buffer_load_dwordx4 v30, s[4:7], s66 offen offset:3072 lds
    v_cvt_pk_bf16_f32 v86, v68, v69
    v_pk_mul_f32 v[70:71], v[68:69], v[50:51] op_sel:[0,0] op_sel_hi:[0,1]
    v_pk_fma_f32 v[70:71], v[68:69], v[50:51], v[70:71] op_sel:[1,1,0] op_sel_hi:[1,0,1] neg_lo:[1,0,0]
    v_cvt_pk_bf16_f32 v87, v70, v71
    v_pk_mul_f32 v[68:69], v[70:71], v[50:51] op_sel:[0,0] op_sel_hi:[0,1]
    v_pk_fma_f32 v[68:69], v[70:71], v[50:51], v[68:69] op_sel:[1,1,0] op_sel_hi:[1,0,1] neg_lo:[1,0,0]
    ds_write2st64_b32 v125, v86, v87 offset0:34 offset1:35
    s_add_u32 m0, s64, 4096
    s_nop 0
    buffer_load_dwordx4 v11, s[8:11], s67 offen offset:0 lds
    v_cvt_pk_bf16_f32 v88, v68, v69
    v_pk_mul_f32 v[70:71], v[68:69], v[50:51] op_sel:[0,0] op_sel_hi:[0,1]
    v_pk_fma_f32 v[70:71], v[68:69], v[50:51], v[70:71] op_sel:[1,1,0] op_sel_hi:[1,0,1] neg_lo:[1,0,0]
    v_cvt_pk_bf16_f32 v89, v70, v71
    v_pk_mul_f32 v[68:69], v[70:71], v[50:51] op_sel:[0,0] op_sel_hi:[0,1]
    v_pk_fma_f32 v[68:69], v[70:71], v[50:51], v[68:69] op_sel:[1,1,0] op_sel_hi:[1,0,1] neg_lo:[1,0,0]
    ds_write2st64_b32 v126, v88, v89 offset0:36 offset1:37
    buffer_load_dwordx4 v31, s[8:11], s67 offen offset:1024 lds
    v_cvt_pk_bf16_f32 v90, v68, v69
    v_pk_mul_f32 v[70:71], v[68:69], v[50:51] op_sel:[0,0] op_sel_hi:[0,1]
    v_pk_fma_f32 v[70:71], v[68:69], v[50:51], v[70:71] op_sel:[1,1,0] op_sel_hi:[1,0,1] neg_lo:[1,0,0]
    v_cvt_pk_bf16_f32 v91, v70, v71
    v_pk_mul_f32 v[68:69], v[70:71], v[50:51] op_sel:[0,0] op_sel_hi:[0,1]
    v_pk_fma_f32 v[68:69], v[70:71], v[50:51], v[68:69] op_sel:[1,1,0] op_sel_hi:[1,0,1] neg_lo:[1,0,0]
    ds_write2st64_b32 v127, v90, v91 offset0:38 offset1:39
    buffer_load_dwordx4 v31, s[8:11], s67 offen offset:2048 lds
    v_cvt_pk_bf16_f32 v92, v68, v69
    v_mov_b32 v93, 0
    ds_write2st64_b32 v128, v92, v93 offset0:40 offset1:41
    s_waitcnt lgkmcnt(0)
    ds_read_b128 v[144:147], v140 offset:12288
    ds_read_b128 v[160:163], v140 offset:0
    ds_read_b128 v[176:179], v140 offset:4096
    ds_read_b128 v[192:195], v140 offset:8192
    ds_read_b128 v[148:151], v141 offset:12288
    ds_read_b128 v[164:167], v141 offset:0
    ds_read_b128 v[180:183], v141 offset:4096
    ds_read_b128 v[196:199], v141 offset:8192
    ds_read_b128 v[152:155], v142 offset:12288
    ds_read_b128 v[168:171], v142 offset:0
    ds_read_b128 v[184:187], v142 offset:4096
    ds_read_b128 v[200:203], v142 offset:8192
    ds_read_b128 v[156:159], v143 offset:12288
    ds_read_b128 v[172:175], v143 offset:0
    ds_read_b128 v[188:191], v143 offset:4096
    ds_read_b128 v[204:207], v143 offset:8192
    buffer_load_dwordx4 v32, s[8:11], s67 offen offset:3072 lds
    s_add_u32 m0, s64, 32768
    s_add_u32 s66, s62, 128
    buffer_load_dwordx4 v10, s[4:7], s66 offen offset:0 lds
    s_add_u32 s67, s63, 196608
    buffer_load_dwordx4 v11, s[8:11], s67 offen offset:1024 lds
    buffer_load_dwordx4 v11, s[8:11], s67 offen offset:2048 lds
    buffer_load_dwordx4 v30, s[4:7], s66 offen offset:3072 lds
    s_add_u32 m0, s64, 36864
    s_nop 0
    buffer_load_dwordx4 v11, s[8:11], s67 offen offset:0 lds
    buffer_load_dwordx4 v31, s[8:11], s67 offen offset:1024 lds
    buffer_load_dwordx4 v31, s[8:11], s67 offen offset:2048 lds
    buffer_load_dwordx4 v32, s[8:11], s67 offen offset:3072 lds
    s_add_u32 m0, s64, 65536
    s_add_u32 s66, s62, 256
    buffer_load_dwordx4 v10, s[4:7], s66 offen offset:0 lds
    s_add_u32 s67, s63, 393216
    buffer_load_dwordx4 v11, s[8:11], s67 offen offset:1024 lds
    buffer_load_dwordx4 v11, s[8:11], s67 offen offset:2048 lds
    buffer_load_dwordx4 v30, s[4:7], s66 offen offset:3072 lds
    s_add_u32 m0, s64, 69632
    s_nop 0
    buffer_load_dwordx4 v11, s[8:11], s67 offen offset:0 lds
    buffer_load_dwordx4 v31, s[8:11], s67 offen offset:1024 lds
    buffer_load_dwordx4 v31, s[8:11], s67 offen offset:2048 lds
    buffer_load_dwordx4 v32, s[8:11], s67 offen offset:3072 lds
    s_waitcnt lgkmcnt(14)
    v_mfma_f32_16x16x32_bf16 v[208:211], v[160:163], v[144:147], 0
    s_waitcnt lgkmcnt(13)
    v_mfma_f32_16x16x32_bf16 v[212:215], v[176:179], v[144:147], 0
    s_waitcnt lgkmcnt(12)
    v_mfma_f32_16x16x32_bf16 v[216:219], v[192:195], v[144:147], 0
    s_waitcnt lgkmcnt(10)
    v_mfma_f32_16x16x32_bf16 v[208:211], v[164:167], v[148:151], v[208:211]
    s_waitcnt lgkmcnt(9)
    v_mfma_f32_16x16x32_bf16 v[212:215], v[180:183], v[148:151], v[212:215]
    s_waitcnt lgkmcnt(8)
    v_mfma_f32_16x16x32_bf16 v[216:219], v[196:199], v[148:151], v[216:219]
    s_waitcnt lgkmcnt(6)
    v_mfma_f32_16x16x32_bf16 v[208:211], v[168:171], v[152:155], v[208:211]
    s_waitcnt lgkmcnt(5)
    v_mfma_f32_16x16x32_bf16 v[212:215], v[184:187], v[152:155], v[212:215]
    s_waitcnt lgkmcnt(4)
    v_mfma_f32_16x16x32_bf16 v[216:219], v[200:203], v[152:155], v[216:219]
    s_waitcnt lgkmcnt(2)
    v_mfma_f32_16x16x32_bf16 v[208:211], v[172:175], v[156:159], v[208:211]
    s_waitcnt lgkmcnt(1)
    v_mfma_f32_16x16x32_bf16 v[212:215], v[188:191], v[156:159], v[212:215]
    s_waitcnt lgkmcnt(0)
    v_mfma_f32_16x16x32_bf16 v[216:219], v[204:207], v[156:159], v[216:219]
    s_nop 3
    buffer_store_dwordx4 v[208:211], v29, s[16:19], s49 offen offset:0 sc1
    s_nop 0
    buffer_store_dwordx4 v[212:215], v29, s[16:19], s49 offen offset:1024 sc1
    s_nop 0
    buffer_store_dwordx4 v[216:219], v29, s[16:19], s49 offen offset:2048 sc1
    s_waitcnt vmcnt(19)
    s_barrier
    ds_read_b128 v[160:163], v20 offset:0
    ds_read_b64_tr_b16 a[0:1], v28 offset:1024
    ds_read_b64_tr_b16 a[2:3], v28 offset:1536
    ds_read_b64_tr_b16 a[4:5], v28 offset:2048
    ds_read_b64_tr_b16 a[6:7], v28 offset:2560
    ds_read_b64_tr_b16 a[8:9], v28 offset:4096
    ds_read_b64_tr_b16 a[10:11], v28 offset:4608
    ds_read_b128 v[164:167], v22 offset:0
    ds_read_b128 v[168:171], v24 offset:0
    ds_read_b128 v[172:175], v26 offset:0
    s_waitcnt lgkmcnt(3)
    v_mfma_f32_16x16x32_bf16 v[88:91], v[160:163], v[240:243], 0
    s_add_u32 m0, s64, 98304
    ds_read_b128 v[176:179], v21 offset:0
    v_mfma_f32_16x16x32_bf16 v[92:95], v[160:163], v[160:163], 0
    s_add_u32 s66, s62, 384
    ds_read_b64_tr_b16 a[12:13], v28 offset:5120
    v_mfma_f32_16x16x32_bf16 v[244:247], v[240:243], a[0:3], 0
    buffer_load_dwordx4 v10, s[4:7], s66 offen offset:0 lds
    ds_read_b64_tr_b16 a[14:15], v28 offset:5632
    v_mfma_f32_16x16x32_bf16 v[248:251], v[240:243], a[4:7], 0
    ds_read_b64_tr_b16 a[16:17], v28 offset:6144
    v_mfma_f32_16x16x32_bf16 v[252:255], a[8:11], v[240:243], 0
    s_add_u32 s67, s63, 589824
    v_mfma_f32_16x16x32_bf16 v[40:43], v[160:163], a[0:3], 0
    buffer_load_dwordx4 v11, s[8:11], s67 offen offset:1024 lds
    v_mfma_f32_16x16x32_bf16 v[56:59], v[160:163], a[4:7], 0
    ds_read_b64_tr_b16 a[18:19], v28 offset:6656
    s_waitcnt lgkmcnt(5)
    v_mfma_f32_16x16x32_bf16 v[44:47], v[164:167], a[0:3], 0
    ds_read_b64_tr_b16 a[20:21], v28 offset:7168
    v_mfma_f32_16x16x32_bf16 v[60:63], v[164:167], a[4:7], 0
    buffer_load_dwordx4 v11, s[8:11], s67 offen offset:2048 lds
    v_mfma_f32_16x16x32_bf16 v[48:51], v[168:171], a[0:3], 0
    ds_read_b64_tr_b16 a[22:23], v28 offset:7680
    v_mfma_f32_16x16x32_bf16 v[64:67], v[168:171], a[4:7], 0
    buffer_load_dwordx4 v30, s[4:7], s66 offen offset:3072 lds
    v_mfma_f32_16x16x32_bf16 v[52:55], v[172:175], a[0:3], 0
    ds_read_b128 v[180:183], v23 offset:0
    v_mfma_f32_16x16x32_bf16 v[68:71], v[172:175], a[4:7], 0
    s_add_u32 m0, s64, 102400
    v_mfma_f32_16x16x32_bf16 v[72:75], a[8:11], v[160:163], 0
    buffer_load_dwordx4 v11, s[8:11], s67 offen offset:0 lds
    v_mfma_f32_16x16x32_bf16 v[76:79], a[8:11], v[164:167], 0
    ds_read_b128 v[184:187], v25 offset:0
    v_mfma_f32_16x16x32_bf16 v[80:83], a[8:11], v[168:171], 0
    ds_read_b128 v[188:191], v27 offset:0
    v_mfma_f32_16x16x32_bf16 v[84:87], a[8:11], v[172:175], 0
    buffer_load_dwordx4 v31, s[8:11], s67 offen offset:1024 lds
    s_waitcnt lgkmcnt(3) vmcnt(17)
    s_barrier
    v_mfma_f32_16x16x32_bf16 v[88:91], v[176:179], v[240:243], v[88:91]
    ds_read_b128 v[160:163], v20 offset:32768
    v_mfma_f32_16x16x32_bf16 v[92:95], v[176:179], v[176:179], v[92:95]
    ds_read_b64_tr_b16 a[24:25], v28 offset:33792
    v_mfma_f32_16x16x32_bf16 v[244:247], v[240:243], a[12:15], v[244:247]
    ds_read_b64_tr_b16 a[26:27], v28 offset:34304
    v_mfma_f32_16x16x32_bf16 v[248:251], v[240:243], a[16:19], v[248:251]
    buffer_load_dwordx4 v31, s[8:11], s67 offen offset:2048 lds
    v_mfma_f32_16x16x32_bf16 v[252:255], a[20:23], v[240:243], v[252:255]
    ds_read_b64_tr_b16 a[28:29], v28 offset:34816
    v_mfma_f32_16x16x32_bf16 v[40:43], v[176:179], a[12:15], v[40:43]
    ds_read_b64_tr_b16 a[30:31], v28 offset:35328
    v_mfma_f32_16x16x32_bf16 v[56:59], v[176:179], a[16:19], v[56:59]
    ds_read_b64_tr_b16 a[32:33], v28 offset:36864
    s_waitcnt lgkmcnt(6)
    v_mfma_f32_16x16x32_bf16 v[44:47], v[180:183], a[12:15], v[44:47]
    ds_read_b64_tr_b16 a[34:35], v28 offset:37376
    v_mfma_f32_16x16x32_bf16 v[60:63], v[180:183], a[16:19], v[60:63]
    ds_read_b128 v[164:167], v22 offset:32768
    v_mfma_f32_16x16x32_bf16 v[48:51], v[184:187], a[12:15], v[48:51]
    buffer_load_dwordx4 v32, s[8:11], s67 offen offset:3072 lds
    v_mfma_f32_16x16x32_bf16 v[64:67], v[184:187], a[16:19], v[64:67]
    ds_read_b128 v[168:171], v24 offset:32768
    v_mfma_f32_16x16x32_bf16 v[52:55], v[188:191], a[12:15], v[52:55]
    ds_read_b128 v[172:175], v26 offset:32768
    v_mfma_f32_16x16x32_bf16 v[68:71], v[188:191], a[16:19], v[68:71]
    v_mfma_f32_16x16x32_bf16 v[72:75], a[20:23], v[176:179], v[72:75]
    v_mfma_f32_16x16x32_bf16 v[76:79], a[20:23], v[180:183], v[76:79]
    v_mfma_f32_16x16x32_bf16 v[80:83], a[20:23], v[184:187], v[80:83]
    v_mov_b32 v16, 1
    buffer_store_dword v16, v14, s[20:23], 0 offen sc1
    v_mfma_f32_16x16x32_bf16 v[84:87], a[20:23], v[188:191], v[84:87]
    s_waitcnt lgkmcnt(3)
    v_mfma_f32_16x16x32_bf16 v[88:91], v[160:163], v[240:243], v[88:91]
    ds_read_b128 v[176:179], v21 offset:32768
    v_mfma_f32_16x16x32_bf16 v[92:95], v[160:163], v[160:163], v[92:95]
    ds_read_b64_tr_b16 a[36:37], v28 offset:37888
    v_mfma_f32_16x16x32_bf16 v[244:247], v[240:243], a[24:27], v[244:247]
    ds_read_b64_tr_b16 a[38:39], v28 offset:38400
    v_mfma_f32_16x16x32_bf16 v[248:251], v[240:243], a[28:31], v[248:251]
    ds_read_b64_tr_b16 a[40:41], v28 offset:38912
    v_mfma_f32_16x16x32_bf16 v[252:255], a[32:35], v[240:243], v[252:255]
    ds_read_b64_tr_b16 a[42:43], v28 offset:39424
    v_mfma_f32_16x16x32_bf16 v[40:43], v[160:163], a[24:27], v[40:43]
    ds_read_b64_tr_b16 a[44:45], v28 offset:39936
    v_mfma_f32_16x16x32_bf16 v[56:59], v[160:163], a[28:31], v[56:59]
    ds_read_b64_tr_b16 a[46:47], v28 offset:40448
    s_waitcnt lgkmcnt(7)
    v_mfma_f32_16x16x32_bf16 v[44:47], v[164:167], a[24:27], v[44:47]
    ds_read_b128 v[180:183], v23 offset:32768
    v_mfma_f32_16x16x32_bf16 v[60:63], v[164:167], a[28:31], v[60:63]
    ds_read_b128 v[184:187], v25 offset:32768
    v_mfma_f32_16x16x32_bf16 v[48:51], v[168:171], a[24:27], v[48:51]
    ds_read_b128 v[188:191], v27 offset:32768
    v_mfma_f32_16x16x32_bf16 v[64:67], v[168:171], a[28:31], v[64:67]
    v_mfma_f32_16x16x32_bf16 v[52:55], v[172:175], a[24:27], v[52:55]
    v_mfma_f32_16x16x32_bf16 v[68:71], v[172:175], a[28:31], v[68:71]
    v_mfma_f32_16x16x32_bf16 v[72:75], a[32:35], v[160:163], v[72:75]
    v_mfma_f32_16x16x32_bf16 v[76:79], a[32:35], v[164:167], v[76:79]
    v_mfma_f32_16x16x32_bf16 v[80:83], a[32:35], v[168:171], v[80:83]
    v_mfma_f32_16x16x32_bf16 v[84:87], a[32:35], v[172:175], v[84:87]
    s_waitcnt lgkmcnt(3) vmcnt(12)
    s_barrier
    v_mfma_f32_16x16x32_bf16 v[88:91], v[176:179], v[240:243], v[88:91]
    v_xor_b32 v20, 0x10000, v20
    v_xor_b32 v21, 0x10000, v21
    v_mfma_f32_16x16x32_bf16 v[92:95], v[176:179], v[176:179], v[92:95]
    s_add_u32 m0, s64, 0
    v_xor_b32 v22, 0x10000, v22
    v_mfma_f32_16x16x32_bf16 v[244:247], v[240:243], a[36:39], v[244:247]
    s_add_u32 s66, s62, 512
    v_xor_b32 v23, 0x10000, v23
    v_mfma_f32_16x16x32_bf16 v[248:251], v[240:243], a[40:43], v[248:251]
    buffer_load_dwordx4 v10, s[4:7], s66 offen offset:0 lds
    v_xor_b32 v24, 0x10000, v24
    v_mfma_f32_16x16x32_bf16 v[252:255], a[44:47], v[240:243], v[252:255]
    v_xor_b32 v25, 0x10000, v25
    v_xor_b32 v26, 0x10000, v26
    v_mfma_f32_16x16x32_bf16 v[40:43], v[176:179], a[36:39], v[40:43]
    v_xor_b32 v27, 0x10000, v27
    v_xor_b32 v28, 0x10000, v28
    v_mfma_f32_16x16x32_bf16 v[56:59], v[176:179], a[40:43], v[56:59]
    s_add_u32 s67, s63, 786432
    ds_read_b128 v[160:163], v20 offset:0
    s_waitcnt lgkmcnt(1)
    v_mfma_f32_16x16x32_bf16 v[44:47], v[180:183], a[36:39], v[44:47]
    buffer_load_dwordx4 v11, s[8:11], s67 offen offset:1024 lds
    ds_read_b64_tr_b16 a[48:49], v28 offset:1024
    v_mfma_f32_16x16x32_bf16 v[60:63], v[180:183], a[40:43], v[60:63]
    ds_read_b64_tr_b16 a[50:51], v28 offset:1536
    ds_read_b64_tr_b16 a[52:53], v28 offset:2048
    v_mfma_f32_16x16x32_bf16 v[48:51], v[184:187], a[36:39], v[48:51]
    ds_read_b64_tr_b16 a[54:55], v28 offset:2560
    ds_read_b64_tr_b16 a[56:57], v28 offset:4096
    v_mfma_f32_16x16x32_bf16 v[64:67], v[184:187], a[40:43], v[64:67]
    ds_read_b64_tr_b16 a[58:59], v28 offset:4608
    v_mfma_f32_16x16x32_bf16 v[52:55], v[188:191], a[36:39], v[52:55]
    buffer_load_dwordx4 v11, s[8:11], s67 offen offset:2048 lds
    v_mfma_f32_16x16x32_bf16 v[68:71], v[188:191], a[40:43], v[68:71]
    ds_read_b128 v[164:167], v22 offset:0
    v_mfma_f32_16x16x32_bf16 v[72:75], a[44:47], v[176:179], v[72:75]
    ds_read_b128 v[168:171], v24 offset:0
    v_mfma_f32_16x16x32_bf16 v[76:79], a[44:47], v[180:183], v[76:79]
    ds_read_b128 v[172:175], v26 offset:0
    v_mfma_f32_16x16x32_bf16 v[80:83], a[44:47], v[184:187], v[80:83]
    buffer_load_dwordx4 v30, s[4:7], s66 offen offset:3072 lds
    v_mfma_f32_16x16x32_bf16 v[84:87], a[44:47], v[188:191], v[84:87]
    s_waitcnt lgkmcnt(3)
    v_mfma_f32_16x16x32_bf16 v[88:91], v[160:163], v[240:243], v[88:91]
    ds_read_b128 v[176:179], v21 offset:0
    v_mfma_f32_16x16x32_bf16 v[92:95], v[160:163], v[160:163], v[92:95]
    ds_read_b64_tr_b16 a[60:61], v28 offset:5120
    v_mfma_f32_16x16x32_bf16 v[244:247], v[240:243], a[48:51], v[244:247]
    s_add_u32 m0, s64, 4096
    v_mfma_f32_16x16x32_bf16 v[248:251], v[240:243], a[52:55], v[248:251]
    buffer_load_dwordx4 v11, s[8:11], s67 offen offset:0 lds
    v_mfma_f32_16x16x32_bf16 v[252:255], a[56:59], v[240:243], v[252:255]
    ds_read_b64_tr_b16 a[62:63], v28 offset:5632
    v_mfma_f32_16x16x32_bf16 v[40:43], v[160:163], a[48:51], v[40:43]
    ds_read_b64_tr_b16 a[64:65], v28 offset:6144
    v_mfma_f32_16x16x32_bf16 v[56:59], v[160:163], a[52:55], v[56:59]
    ds_read_b64_tr_b16 a[66:67], v28 offset:6656
    s_waitcnt lgkmcnt(5)
    v_mfma_f32_16x16x32_bf16 v[44:47], v[164:167], a[48:51], v[44:47]
    buffer_load_dwordx4 v31, s[8:11], s67 offen offset:1024 lds
    v_mfma_f32_16x16x32_bf16 v[60:63], v[164:167], a[52:55], v[60:63]
    ds_read_b64_tr_b16 a[68:69], v28 offset:7168
    v_mfma_f32_16x16x32_bf16 v[48:51], v[168:171], a[48:51], v[48:51]
    ds_read_b64_tr_b16 a[70:71], v28 offset:7680
    v_mfma_f32_16x16x32_bf16 v[64:67], v[168:171], a[52:55], v[64:67]
    ds_read_b128 v[180:183], v23 offset:0
    v_mfma_f32_16x16x32_bf16 v[52:55], v[172:175], a[48:51], v[52:55]
    buffer_load_dwordx4 v31, s[8:11], s67 offen offset:2048 lds
    v_mfma_f32_16x16x32_bf16 v[68:71], v[172:175], a[52:55], v[68:71]
    ds_read_b128 v[184:187], v25 offset:0
    v_mfma_f32_16x16x32_bf16 v[72:75], a[56:59], v[160:163], v[72:75]
    ds_read_b128 v[188:191], v27 offset:0
    v_mfma_f32_16x16x32_bf16 v[76:79], a[56:59], v[164:167], v[76:79]
    v_mfma_f32_16x16x32_bf16 v[80:83], a[56:59], v[168:171], v[80:83]
    buffer_load_dwordx4 v32, s[8:11], s67 offen offset:3072 lds
    v_mfma_f32_16x16x32_bf16 v[84:87], a[56:59], v[172:175], v[84:87]
    s_waitcnt lgkmcnt(3) vmcnt(9)
    s_barrier
    v_mfma_f32_16x16x32_bf16 v[88:91], v[176:179], v[240:243], v[88:91]
    ds_read_b128 v[160:163], v20 offset:32768
    ds_read_b64_tr_b16 a[72:73], v28 offset:33792
    v_mfma_f32_16x16x32_bf16 v[92:95], v[176:179], v[176:179], v[92:95]
    s_add_u32 m0, s64, 32768
    v_mfma_f32_16x16x32_bf16 v[244:247], v[240:243], a[60:63], v[244:247]
    s_add_u32 s66, s62, 640
    v_mfma_f32_16x16x32_bf16 v[248:251], v[240:243], a[64:67], v[248:251]
    buffer_load_dwordx4 v10, s[4:7], s66 offen offset:0 lds
    v_mfma_f32_16x16x32_bf16 v[252:255], a[68:71], v[240:243], v[252:255]
    ds_read_b64_tr_b16 a[74:75], v28 offset:34304
    v_mfma_f32_16x16x32_bf16 v[40:43], v[176:179], a[60:63], v[40:43]
    ds_read_b64_tr_b16 a[76:77], v28 offset:34816
    v_mfma_f32_16x16x32_bf16 v[56:59], v[176:179], a[64:67], v[56:59]
    s_add_u32 s67, s63, 983040
    s_waitcnt lgkmcnt(4)
    v_mfma_f32_16x16x32_bf16 v[44:47], v[180:183], a[60:63], v[44:47]
    buffer_load_dwordx4 v11, s[8:11], s67 offen offset:1024 lds
    v_mfma_f32_16x16x32_bf16 v[60:63], v[180:183], a[64:67], v[60:63]
    ds_read_b64_tr_b16 a[78:79], v28 offset:35328
    v_mfma_f32_16x16x32_bf16 v[48:51], v[184:187], a[60:63], v[48:51]
    ds_read_b64_tr_b16 a[80:81], v28 offset:36864
    v_mfma_f32_16x16x32_bf16 v[64:67], v[184:187], a[64:67], v[64:67]
    ds_read_b64_tr_b16 a[82:83], v28 offset:37376
    v_mfma_f32_16x16x32_bf16 v[52:55], v[188:191], a[60:63], v[52:55]
    buffer_load_dwordx4 v11, s[8:11], s67 offen offset:2048 lds
    v_mfma_f32_16x16x32_bf16 v[68:71], v[188:191], a[64:67], v[68:71]
    ds_read_b128 v[164:167], v22 offset:32768
    v_mfma_f32_16x16x32_bf16 v[72:75], a[68:71], v[176:179], v[72:75]
    ds_read_b128 v[168:171], v24 offset:32768
    v_mfma_f32_16x16x32_bf16 v[76:79], a[68:71], v[180:183], v[76:79]
    ds_read_b128 v[172:175], v26 offset:32768
    v_mfma_f32_16x16x32_bf16 v[80:83], a[68:71], v[184:187], v[80:83]
    buffer_load_dwordx4 v30, s[4:7], s66 offen offset:3072 lds
    v_mfma_f32_16x16x32_bf16 v[84:87], a[68:71], v[188:191], v[84:87]
    s_waitcnt lgkmcnt(3)
    v_mfma_f32_16x16x32_bf16 v[88:91], v[160:163], v[240:243], v[88:91]
    ds_read_b128 v[176:179], v21 offset:32768
    v_mfma_f32_16x16x32_bf16 v[92:95], v[160:163], v[160:163], v[92:95]
    ds_read_b64_tr_b16 a[84:85], v28 offset:37888
    v_mfma_f32_16x16x32_bf16 v[244:247], v[240:243], a[72:75], v[244:247]
    s_add_u32 m0, s64, 36864
    v_mfma_f32_16x16x32_bf16 v[248:251], v[240:243], a[76:79], v[248:251]
    buffer_load_dwordx4 v11, s[8:11], s67 offen offset:0 lds
    v_mfma_f32_16x16x32_bf16 v[252:255], a[80:83], v[240:243], v[252:255]
    ds_read_b64_tr_b16 a[86:87], v28 offset:38400
    v_mfma_f32_16x16x32_bf16 v[40:43], v[160:163], a[72:75], v[40:43]
    ds_read_b64_tr_b16 a[88:89], v28 offset:38912
    v_mfma_f32_16x16x32_bf16 v[56:59], v[160:163], a[76:79], v[56:59]
    ds_read_b64_tr_b16 a[90:91], v28 offset:39424
    s_waitcnt lgkmcnt(5)
    v_mfma_f32_16x16x32_bf16 v[44:47], v[164:167], a[72:75], v[44:47]
    buffer_load_dwordx4 v31, s[8:11], s67 offen offset:1024 lds
    v_mfma_f32_16x16x32_bf16 v[60:63], v[164:167], a[76:79], v[60:63]
    ds_read_b64_tr_b16 a[92:93], v28 offset:39936
    v_mfma_f32_16x16x32_bf16 v[48:51], v[168:171], a[72:75], v[48:51]
    ds_read_b64_tr_b16 a[94:95], v28 offset:40448
    v_mfma_f32_16x16x32_bf16 v[64:67], v[168:171], a[76:79], v[64:67]
    ds_read_b128 v[180:183], v23 offset:32768
    v_mfma_f32_16x16x32_bf16 v[52:55], v[172:175], a[72:75], v[52:55]
    buffer_load_dwordx4 v31, s[8:11], s67 offen offset:2048 lds
    v_mfma_f32_16x16x32_bf16 v[68:71], v[172:175], a[76:79], v[68:71]
    ds_read_b128 v[184:187], v25 offset:32768
    v_mfma_f32_16x16x32_bf16 v[72:75], a[80:83], v[160:163], v[72:75]
    ds_read_b128 v[188:191], v27 offset:32768
    v_mfma_f32_16x16x32_bf16 v[76:79], a[80:83], v[164:167], v[76:79]
    v_mfma_f32_16x16x32_bf16 v[80:83], a[80:83], v[168:171], v[80:83]
    buffer_load_dwordx4 v32, s[8:11], s67 offen offset:3072 lds
    v_mfma_f32_16x16x32_bf16 v[84:87], a[80:83], v[172:175], v[84:87]
    s_waitcnt lgkmcnt(3) vmcnt(8)
    s_barrier
    v_mfma_f32_16x16x32_bf16 v[88:91], v[176:179], v[240:243], v[88:91]
    v_xor_b32 v20, 0x10000, v20
    v_xor_b32 v21, 0x10000, v21
    v_mfma_f32_16x16x32_bf16 v[92:95], v[176:179], v[176:179], v[92:95]
    s_add_u32 m0, s64, 65536
    v_xor_b32 v22, 0x10000, v22
    v_mfma_f32_16x16x32_bf16 v[244:247], v[240:243], a[84:87], v[244:247]
    s_add_u32 s66, s62, 768
    v_xor_b32 v23, 0x10000, v23
    v_mfma_f32_16x16x32_bf16 v[248:251], v[240:243], a[88:91], v[248:251]
    buffer_load_dwordx4 v10, s[4:7], s66 offen offset:0 lds
    v_xor_b32 v24, 0x10000, v24
    v_mfma_f32_16x16x32_bf16 v[252:255], a[92:95], v[240:243], v[252:255]
    v_xor_b32 v25, 0x10000, v25
    v_xor_b32 v26, 0x10000, v26
    v_mfma_f32_16x16x32_bf16 v[40:43], v[176:179], a[84:87], v[40:43]
    v_xor_b32 v27, 0x10000, v27
    v_xor_b32 v28, 0x10000, v28
    v_mfma_f32_16x16x32_bf16 v[56:59], v[176:179], a[88:91], v[56:59]
    s_add_u32 s67, s63, 1179648
    ds_read_b128 v[160:163], v20 offset:0
    s_waitcnt lgkmcnt(1)
    v_mfma_f32_16x16x32_bf16 v[44:47], v[180:183], a[84:87], v[44:47]
    buffer_load_dwordx4 v11, s[8:11], s67 offen offset:1024 lds
    ds_read_b64_tr_b16 a[96:97], v28 offset:1024
    v_mfma_f32_16x16x32_bf16 v[60:63], v[180:183], a[88:91], v[60:63]
    ds_read_b64_tr_b16 a[98:99], v28 offset:1536
    ds_read_b64_tr_b16 a[100:101], v28 offset:2048
    v_mfma_f32_16x16x32_bf16 v[48:51], v[184:187], a[84:87], v[48:51]
    ds_read_b64_tr_b16 a[102:103], v28 offset:2560
    ds_read_b64_tr_b16 a[104:105], v28 offset:4096
    v_mfma_f32_16x16x32_bf16 v[64:67], v[184:187], a[88:91], v[64:67]
    ds_read_b64_tr_b16 a[106:107], v28 offset:4608
    v_mfma_f32_16x16x32_bf16 v[52:55], v[188:191], a[84:87], v[52:55]
    buffer_load_dwordx4 v11, s[8:11], s67 offen offset:2048 lds
    v_mfma_f32_16x16x32_bf16 v[68:71], v[188:191], a[88:91], v[68:71]
    ds_read_b128 v[164:167], v22 offset:0
    v_mfma_f32_16x16x32_bf16 v[72:75], a[92:95], v[176:179], v[72:75]
    ds_read_b128 v[168:171], v24 offset:0
    v_mfma_f32_16x16x32_bf16 v[76:79], a[92:95], v[180:183], v[76:79]
    ds_read_b128 v[172:175], v26 offset:0
    v_mfma_f32_16x16x32_bf16 v[80:83], a[92:95], v[184:187], v[80:83]
    buffer_load_dwordx4 v30, s[4:7], s66 offen offset:3072 lds
    v_mfma_f32_16x16x32_bf16 v[84:87], a[92:95], v[188:191], v[84:87]
    s_waitcnt lgkmcnt(3)
    v_mfma_f32_16x16x32_bf16 v[88:91], v[160:163], v[240:243], v[88:91]
    ds_read_b128 v[176:179], v21 offset:0
    v_mfma_f32_16x16x32_bf16 v[92:95], v[160:163], v[160:163], v[92:95]
    ds_read_b64_tr_b16 a[108:109], v28 offset:5120
    v_mfma_f32_16x16x32_bf16 v[244:247], v[240:243], a[96:99], v[244:247]
    s_add_u32 m0, s64, 69632
    v_mfma_f32_16x16x32_bf16 v[248:251], v[240:243], a[100:103], v[248:251]
    buffer_load_dwordx4 v11, s[8:11], s67 offen offset:0 lds
    v_mfma_f32_16x16x32_bf16 v[252:255], a[104:107], v[240:243], v[252:255]
    ds_read_b64_tr_b16 a[110:111], v28 offset:5632
    v_mfma_f32_16x16x32_bf16 v[40:43], v[160:163], a[96:99], v[40:43]
    ds_read_b64_tr_b16 a[112:113], v28 offset:6144
    v_mfma_f32_16x16x32_bf16 v[56:59], v[160:163], a[100:103], v[56:59]
    ds_read_b64_tr_b16 a[114:115], v28 offset:6656
    s_waitcnt lgkmcnt(5)
    v_mfma_f32_16x16x32_bf16 v[44:47], v[164:167], a[96:99], v[44:47]
    buffer_load_dwordx4 v31, s[8:11], s67 offen offset:1024 lds
    v_mfma_f32_16x16x32_bf16 v[60:63], v[164:167], a[100:103], v[60:63]
    ds_read_b64_tr_b16 a[116:117], v28 offset:7168
    v_mfma_f32_16x16x32_bf16 v[48:51], v[168:171], a[96:99], v[48:51]
    ds_read_b64_tr_b16 a[118:119], v28 offset:7680
    v_mfma_f32_16x16x32_bf16 v[64:67], v[168:171], a[100:103], v[64:67]
    ds_read_b128 v[180:183], v23 offset:0
    v_mfma_f32_16x16x32_bf16 v[52:55], v[172:175], a[96:99], v[52:55]
    buffer_load_dwordx4 v31, s[8:11], s67 offen offset:2048 lds
    v_mfma_f32_16x16x32_bf16 v[68:71], v[172:175], a[100:103], v[68:71]
    ds_read_b128 v[184:187], v25 offset:0
    v_mfma_f32_16x16x32_bf16 v[72:75], a[104:107], v[160:163], v[72:75]
    ds_read_b128 v[188:191], v27 offset:0
    v_mfma_f32_16x16x32_bf16 v[76:79], a[104:107], v[164:167], v[76:79]
    v_mfma_f32_16x16x32_bf16 v[80:83], a[104:107], v[168:171], v[80:83]
    buffer_load_dwordx4 v32, s[8:11], s67 offen offset:3072 lds
    v_mfma_f32_16x16x32_bf16 v[84:87], a[104:107], v[172:175], v[84:87]
    s_waitcnt lgkmcnt(3) vmcnt(8)
    s_barrier
    v_mfma_f32_16x16x32_bf16 v[88:91], v[176:179], v[240:243], v[88:91]
    ds_read_b128 v[96:99], v20 offset:32768
    ds_read_b64_tr_b16 a[120:121], v28 offset:33792
    v_mfma_f32_16x16x32_bf16 v[92:95], v[176:179], v[176:179], v[92:95]
    s_add_u32 m0, s64, 98304
    v_mfma_f32_16x16x32_bf16 v[244:247], v[240:243], a[108:111], v[244:247]
    s_add_u32 s66, s62, 896
    v_mfma_f32_16x16x32_bf16 v[248:251], v[240:243], a[112:115], v[248:251]
    buffer_load_dwordx4 v10, s[4:7], s66 offen offset:0 lds
    v_mfma_f32_16x16x32_bf16 v[252:255], a[116:119], v[240:243], v[252:255]
    ds_read_b64_tr_b16 a[122:123], v28 offset:34304
    v_mfma_f32_16x16x32_bf16 v[40:43], v[176:179], a[108:111], v[40:43]
    ds_read_b64_tr_b16 a[124:125], v28 offset:34816
    v_mfma_f32_16x16x32_bf16 v[56:59], v[176:179], a[112:115], v[56:59]
    s_add_u32 s67, s63, 1376256
    s_waitcnt lgkmcnt(4)
    v_mfma_f32_16x16x32_bf16 v[44:47], v[180:183], a[108:111], v[44:47]
    buffer_load_dwordx4 v11, s[8:11], s67 offen offset:1024 lds
    v_mfma_f32_16x16x32_bf16 v[60:63], v[180:183], a[112:115], v[60:63]
    ds_read_b64_tr_b16 a[126:127], v28 offset:35328
    v_mfma_f32_16x16x32_bf16 v[48:51], v[184:187], a[108:111], v[48:51]
    ds_read_b64_tr_b16 a[128:129], v28 offset:36864
    v_mfma_f32_16x16x32_bf16 v[64:67], v[184:187], a[112:115], v[64:67]
    ds_read_b64_tr_b16 a[130:131], v28 offset:37376
    v_mfma_f32_16x16x32_bf16 v[52:55], v[188:191], a[108:111], v[52:55]
    buffer_load_dwordx4 v11, s[8:11], s67 offen offset:2048 lds
    v_mfma_f32_16x16x32_bf16 v[68:71], v[188:191], a[112:115], v[68:71]
    ds_read_b128 v[100:103], v22 offset:32768
    v_mfma_f32_16x16x32_bf16 v[72:75], a[116:119], v[176:179], v[72:75]
    ds_read_b128 v[104:107], v24 offset:32768
    v_mfma_f32_16x16x32_bf16 v[76:79], a[116:119], v[180:183], v[76:79]
    ds_read_b128 v[108:111], v26 offset:32768
    v_mfma_f32_16x16x32_bf16 v[80:83], a[116:119], v[184:187], v[80:83]
    buffer_load_dwordx4 v30, s[4:7], s66 offen offset:3072 lds
    v_mfma_f32_16x16x32_bf16 v[84:87], a[116:119], v[188:191], v[84:87]
    s_waitcnt lgkmcnt(3)
    v_mfma_f32_16x16x32_bf16 v[88:91], v[96:99], v[240:243], v[88:91]
    ds_read_b128 v[112:115], v21 offset:32768
    ds_read_b64_tr_b16 a[132:133], v28 offset:37888
    v_mfma_f32_16x16x32_bf16 v[92:95], v[96:99], v[96:99], v[92:95]
    s_add_u32 m0, s64, 102400
    ds_read_b64_tr_b16 a[134:135], v28 offset:38400
    v_mfma_f32_16x16x32_bf16 v[244:247], v[240:243], a[120:123], v[244:247]
    buffer_load_dwordx4 v11, s[8:11], s67 offen offset:0 lds
    v_mfma_f32_16x16x32_bf16 v[248:251], v[240:243], a[124:127], v[248:251]
    ds_read_b64_tr_b16 a[136:137], v28 offset:38912
    v_mfma_f32_16x16x32_bf16 v[252:255], a[128:131], v[240:243], v[252:255]
    ds_read_b64_tr_b16 a[138:139], v28 offset:39424
    v_mfma_f32_16x16x32_bf16 v[40:43], v[96:99], a[120:123], v[40:43]
    buffer_load_dwordx4 v31, s[8:11], s67 offen offset:1024 lds
    v_mfma_f32_16x16x32_bf16 v[56:59], v[96:99], a[124:127], v[56:59]
    ds_read_b64_tr_b16 a[140:141], v28 offset:39936
    s_waitcnt lgkmcnt(6)
    v_mfma_f32_16x16x32_bf16 v[44:47], v[100:103], a[120:123], v[44:47]
    ds_read_b64_tr_b16 a[142:143], v28 offset:40448
    v_mfma_f32_16x16x32_bf16 v[60:63], v[100:103], a[124:127], v[60:63]
    ds_read_b128 v[116:119], v23 offset:32768
    v_mfma_f32_16x16x32_bf16 v[48:51], v[104:107], a[120:123], v[48:51]
    buffer_load_dwordx4 v31, s[8:11], s67 offen offset:2048 lds
    v_mfma_f32_16x16x32_bf16 v[64:67], v[104:107], a[124:127], v[64:67]
    ds_read_b128 v[120:123], v25 offset:32768
    v_mfma_f32_16x16x32_bf16 v[52:55], v[108:111], a[120:123], v[52:55]
    ds_read_b128 v[124:127], v27 offset:32768
    v_mfma_f32_16x16x32_bf16 v[68:71], v[108:111], a[124:127], v[68:71]
    buffer_load_dwordx4 v32, s[8:11], s67 offen offset:3072 lds
    s_waitcnt lgkmcnt(3) vmcnt(8)
    s_barrier
    v_mfma_f32_16x16x32_bf16 v[88:91], v[112:115], v[240:243], v[88:91]
    v_xor_b32 v20, 0x10000, v20
    v_xor_b32 v21, 0x10000, v21
    v_mfma_f32_16x16x32_bf16 v[92:95], v[112:115], v[112:115], v[92:95]
    v_xor_b32 v22, 0x10000, v22
    v_xor_b32 v23, 0x10000, v23
    v_mfma_f32_16x16x32_bf16 v[244:247], v[240:243], a[132:135], v[244:247]
    v_xor_b32 v24, 0x10000, v24
    v_xor_b32 v25, 0x10000, v25
    v_mfma_f32_16x16x32_bf16 v[248:251], v[240:243], a[136:139], v[248:251]
    v_lshlrev_b32 v5, 20, v0
    v_add_u32 v5, 0x80000, v5
    buffer_load_dword v230, v5, s[16:19], 0 offen
    v_xor_b32 v26, 0x10000, v26
    v_mfma_f32_16x16x32_bf16 v[252:255], a[140:143], v[240:243], v[252:255]
    v_xor_b32 v27, 0x10000, v27
    v_xor_b32 v28, 0x10000, v28
    v_mfma_f32_16x16x32_bf16 v[40:43], v[112:115], a[132:135], v[40:43]
    ds_read_b128 v[128:131], v20 offset:0
    ds_read_b64_tr_b16 a[144:145], v28 offset:1024
    v_mfma_f32_16x16x32_bf16 v[56:59], v[112:115], a[136:139], v[56:59]
    ds_read_b64_tr_b16 a[146:147], v28 offset:1536
    ds_read_b64_tr_b16 a[148:149], v28 offset:2048
    s_waitcnt lgkmcnt(4)
    v_mfma_f32_16x16x32_bf16 v[44:47], v[116:119], a[132:135], v[44:47]
    v_lshlrev_b32 v5, 20, v0
    buffer_load_dword v231, v5, s[24:27], 0 offen
    ds_read_b64_tr_b16 a[150:151], v28 offset:2560
    v_mfma_f32_16x16x32_bf16 v[60:63], v[116:119], a[136:139], v[60:63]
    ds_read_b64_tr_b16 a[152:153], v28 offset:4096
    ds_read_b64_tr_b16 a[154:155], v28 offset:4608
    v_mfma_f32_16x16x32_bf16 v[48:51], v[120:123], a[132:135], v[48:51]
    ds_read_b128 v[132:135], v22 offset:0
    ds_read_b128 v[136:139], v24 offset:0
    v_mfma_f32_16x16x32_bf16 v[64:67], v[120:123], a[136:139], v[64:67]
    ds_read_b128 v[140:143], v26 offset:0
    v_mfma_f32_16x16x32_bf16 v[52:55], v[124:127], a[132:135], v[52:55]
    s_lshr_b32 s44, s2, 3
    s_lshl_b32 s44, s44, 14
    v_lshlrev_b32 v5, 6, v0
    buffer_load_dword v221, v5, s[12:15], s44 offen
    v_mfma_f32_16x16x32_bf16 v[68:71], v[124:127], a[136:139], v[68:71]
    s_waitcnt lgkmcnt(3)
    v_mfma_f32_16x16x32_bf16 v[88:91], v[128:131], v[240:243], v[88:91]
    ds_read_b128 v[144:147], v21 offset:0
    v_mfma_f32_16x16x32_bf16 v[92:95], v[128:131], v[128:131], v[92:95]
    ds_read_b64_tr_b16 a[156:157], v28 offset:5120
    v_mfma_f32_16x16x32_bf16 v[244:247], v[240:243], a[144:147], v[244:247]
    ds_read_b64_tr_b16 a[158:159], v28 offset:5632
    v_mfma_f32_16x16x32_bf16 v[248:251], v[240:243], a[148:151], v[248:251]
    ds_read_b64_tr_b16 a[160:161], v28 offset:6144
    v_mfma_f32_16x16x32_bf16 v[252:255], a[152:155], v[240:243], v[252:255]
    ds_read_b64_tr_b16 a[162:163], v28 offset:6656
    v_mfma_f32_16x16x32_bf16 v[40:43], v[128:131], a[144:147], v[40:43]
    ds_read_b64_tr_b16 a[164:165], v28 offset:7168
    v_mfma_f32_16x16x32_bf16 v[56:59], v[128:131], a[148:151], v[56:59]
    ds_read_b64_tr_b16 a[166:167], v28 offset:7680
    s_waitcnt lgkmcnt(7)
    v_mfma_f32_16x16x32_bf16 v[44:47], v[132:135], a[144:147], v[44:47]
    ds_read_b128 v[148:151], v23 offset:0
    v_mfma_f32_16x16x32_bf16 v[60:63], v[132:135], a[148:151], v[60:63]
    ds_read_b128 v[152:155], v25 offset:0
    v_mfma_f32_16x16x32_bf16 v[48:51], v[136:139], a[144:147], v[48:51]
    ds_read_b128 v[156:159], v27 offset:0
    v_mfma_f32_16x16x32_bf16 v[64:67], v[136:139], a[148:151], v[64:67]
    v_mfma_f32_16x16x32_bf16 v[52:55], v[140:143], a[144:147], v[52:55]
    v_mfma_f32_16x16x32_bf16 v[68:71], v[140:143], a[148:151], v[68:71]
    s_waitcnt lgkmcnt(3) vmcnt(3)
    s_barrier
    v_mfma_f32_16x16x32_bf16 v[88:91], v[144:147], v[240:243], v[88:91]
    ds_read_b128 v[160:163], v20 offset:32768
    v_mfma_f32_16x16x32_bf16 v[92:95], v[144:147], v[144:147], v[92:95]
    ds_read_b64_tr_b16 a[168:169], v28 offset:33792
    v_mfma_f32_16x16x32_bf16 v[244:247], v[240:243], a[156:159], v[244:247]
    ds_read_b64_tr_b16 a[170:171], v28 offset:34304
    v_mfma_f32_16x16x32_bf16 v[248:251], v[240:243], a[160:163], v[248:251]
    ds_read_b64_tr_b16 a[172:173], v28 offset:34816
    v_mfma_f32_16x16x32_bf16 v[252:255], a[164:167], v[240:243], v[252:255]
    ds_read_b64_tr_b16 a[174:175], v28 offset:35328
    v_mfma_f32_16x16x32_bf16 v[40:43], v[144:147], a[156:159], v[40:43]
    ds_read_b64_tr_b16 a[176:177], v28 offset:36864
    v_mfma_f32_16x16x32_bf16 v[56:59], v[144:147], a[160:163], v[56:59]
    ds_read_b64_tr_b16 a[178:179], v28 offset:37376
    s_waitcnt lgkmcnt(7)
    v_mfma_f32_16x16x32_bf16 v[44:47], v[148:151], a[156:159], v[44:47]
    buffer_load_dword v17, v15, s[20:23], 0 offen sc1
    v_mfma_f32_16x16x32_bf16 v[60:63], v[148:151], a[160:163], v[60:63]
    ds_read_b128 v[164:167], v22 offset:32768
    v_mfma_f32_16x16x32_bf16 v[48:51], v[152:155], a[156:159], v[48:51]
    ds_read_b128 v[168:171], v24 offset:32768
    v_mfma_f32_16x16x32_bf16 v[64:67], v[152:155], a[160:163], v[64:67]
    ds_read_b128 v[172:175], v26 offset:32768
    v_mfma_f32_16x16x32_bf16 v[52:55], v[156:159], a[156:159], v[52:55]
    v_mfma_f32_16x16x32_bf16 v[68:71], v[156:159], a[160:163], v[68:71]
    s_waitcnt lgkmcnt(3)
    v_mfma_f32_16x16x32_bf16 v[88:91], v[160:163], v[240:243], v[88:91]
    ds_read_b128 v[176:179], v21 offset:32768
    v_mfma_f32_16x16x32_bf16 v[92:95], v[160:163], v[160:163], v[92:95]
    ds_read_b64_tr_b16 a[180:181], v28 offset:37888
    v_mfma_f32_16x16x32_bf16 v[244:247], v[240:243], a[168:171], v[244:247]
    ds_read_b64_tr_b16 a[182:183], v28 offset:38400
    v_mfma_f32_16x16x32_bf16 v[248:251], v[240:243], a[172:175], v[248:251]
    ds_read_b64_tr_b16 a[184:185], v28 offset:38912
    v_mfma_f32_16x16x32_bf16 v[252:255], a[176:179], v[240:243], v[252:255]
    ds_read_b64_tr_b16 a[186:187], v28 offset:39424
    v_mfma_f32_16x16x32_bf16 v[40:43], v[160:163], a[168:171], v[40:43]
    ds_read_b64_tr_b16 a[188:189], v28 offset:39936
    v_mfma_f32_16x16x32_bf16 v[56:59], v[160:163], a[172:175], v[56:59]
    ds_read_b64_tr_b16 a[190:191], v28 offset:40448
    s_waitcnt lgkmcnt(7)
    v_mfma_f32_16x16x32_bf16 v[44:47], v[164:167], a[168:171], v[44:47]
    ds_read_b128 v[180:183], v23 offset:32768
    v_mfma_f32_16x16x32_bf16 v[60:63], v[164:167], a[172:175], v[60:63]
    ds_read_b128 v[184:187], v25 offset:32768
    v_mfma_f32_16x16x32_bf16 v[48:51], v[168:171], a[168:171], v[48:51]
    ds_read_b128 v[188:191], v27 offset:32768
    v_mfma_f32_16x16x32_bf16 v[64:67], v[168:171], a[172:175], v[64:67]
    v_mfma_f32_16x16x32_bf16 v[52:55], v[172:175], a[168:171], v[52:55]
    v_mfma_f32_16x16x32_bf16 v[68:71], v[172:175], a[172:175], v[68:71]
    s_waitcnt lgkmcnt(3)
    v_mfma_f32_16x16x32_bf16 v[88:91], v[176:179], v[240:243], v[88:91]
    v_mfma_f32_16x16x32_bf16 v[92:95], v[176:179], v[176:179], v[92:95]
    v_mfma_f32_16x16x32_bf16 v[244:247], v[240:243], a[180:183], v[244:247]
    v_mfma_f32_16x16x32_bf16 v[248:251], v[240:243], a[184:187], v[248:251]
    v_mfma_f32_16x16x32_bf16 v[252:255], a[188:191], v[240:243], v[252:255]
    v_mfma_f32_16x16x32_bf16 v[40:43], v[176:179], a[180:183], v[40:43]
    v_mfma_f32_16x16x32_bf16 v[56:59], v[176:179], a[184:187], v[56:59]
    s_waitcnt lgkmcnt(0)
    v_mfma_f32_16x16x32_bf16 v[44:47], v[180:183], a[180:183], v[44:47]
    v_mfma_f32_16x16x32_bf16 v[60:63], v[180:183], a[184:187], v[60:63]
    v_mfma_f32_16x16x32_bf16 v[48:51], v[184:187], a[180:183], v[48:51]
    v_mfma_f32_16x16x32_bf16 v[64:67], v[184:187], a[184:187], v[64:67]
    v_mfma_f32_16x16x32_bf16 v[52:55], v[188:191], a[180:183], v[52:55]
    v_mfma_f32_16x16x32_bf16 v[68:71], v[188:191], a[184:187], v[68:71]
    v_and_b32 v5, 3, v2
    v_cmp_eq_u32 s[48:49], 1, v5
    v_cmp_eq_u32 s[50:51], 2, v5
    v_cmp_eq_u32 s[52:53], 3, v5
    v_lshrrev_b32 v5, 2, v2
    v_cmp_eq_u32 s[54:55], v5, v3
    v_cndmask_b32 v6, v88, v89, s[48:49]
    v_cndmask_b32 v6, v6, v90, s[50:51]
    v_cndmask_b32 v6, v6, v91, s[52:53]
    v_cndmask_b32 v7, v92, v93, s[48:49]
    v_cndmask_b32 v7, v7, v94, s[50:51]
    v_cndmask_b32 v7, v7, v95, s[52:53]
    v_mul_f32 v6, 0x3b000000, v6
    v_mul_f32 v7, 0x3b000000, v7
    v_fma_f32 v7, -v6, v6, v7
    v_max_f32 v7, 0, v7
    v_cvt_pk_bf16_f32 v7, v6, v7
    v_lshlrev_b32 v6, 16, v7
    v_and_b32 v7, 0xffff0000, v7
    v_add_f32 v7, 0x3727c5ac, v7
    v_cvt_pk_bf16_f32 v7, v7, v7
    v_and_b32 v7, 0xffff0000, v7
    v_sqrt_f32 v7, v7
    s_nop 0
    v_cvt_pk_bf16_f32 v7, v7, v7
    v_and_b32 v7, 0xffff0000, v7
    v_rcp_f32 v7, v7
    s_nop 0
    v_mul_f32 v6, -v6, v7
    s_lshl_b32 s44, s28, 6
    s_add_u32 s44, s44, 131072
    v_lshl_add_u32 v8, v2, 2, s44
    s_mov_b64 s[56:57], exec
    s_mov_b64 exec, s[54:55]
    ds_write2_b32 v8, v7, v6 offset0:0 offset1:64
    s_mov_b64 exec, s[56:57]
    v_lshl_add_u32 v9, v3, 4, s44
    s_waitcnt lgkmcnt(0)
    s_barrier
    v_mfma_f32_16x16x32_bf16 v[72:75], a[128:131], v[96:99], v[72:75]
    v_xor_b32 v5, 0, v9
    ds_read_b128 v[192:195], v5
    ds_read_b128 v[208:211], v5 offset:256
    v_xor_b32 v5, 64, v9
    ds_read_b128 v[196:199], v5
    ds_read_b128 v[212:215], v5 offset:256
    v_mfma_f32_16x16x32_bf16 v[76:79], a[128:131], v[100:103], v[76:79]
    v_xor_b32 v5, 128, v9
    ds_read_b128 v[200:203], v5
    ds_read_b128 v[216:219], v5 offset:256
    v_xor_b32 v5, 192, v9
    ds_read_b128 v[204:207], v5
    s_waitcnt vmcnt(1)
    ds_read_b128 v[220:223], v5 offset:256
    v_mfma_f32_16x16x32_bf16 v[80:83], a[128:131], v[104:107], v[80:83]
    s_mov_b32 s58, 0x3fb8aa3b
    s_mov_b32 s59, s58
    v_mov_b32 v36, 0x358637bd
    v_mov_b32 v37, 0xb5c1a2a0
    v_mfma_f32_16x16x32_bf16 v[84:87], a[128:131], v[108:111], v[84:87]
    v_mfma_f32_16x16x32_bf16 v[72:75], a[140:143], v[112:115], v[72:75]
    v_mfma_f32_16x16x32_bf16 v[76:79], a[140:143], v[116:119], v[76:79]
    s_waitcnt lgkmcnt(6)
    v_pk_fma_f32 v[30:31], v[208:209], v[244:245], v[36:37] op_sel_hi:[1,1,0]
    v_pk_fma_f32 v[40:41], v[40:41], v[192:193], v[30:31]
    v_pk_fma_f32 v[32:33], v[40:41], s[58:59], v[36:37] op_sel:[0,0,1] op_sel_hi:[1,1,1]
    v_exp_f32 v32, v32 clamp
    v_exp_f32 v33, v33 clamp
    v_max_f32 v40, v40, v36
    v_max_f32 v41, v41, v36
    v_pk_add_f32 v[40:41], v[40:41], v[32:33]
    v_pk_mul_f32 v[34:35], v[208:209], v[248:249]
    v_pk_fma_f32 v[56:57], v[56:57], v[192:193], v[34:35]
    v_cvt_pk_bf16_f32 v40, v40, v41
    v_cvt_pk_bf16_f32 v56, v56, v57
    v_pk_fma_f32 v[30:31], v[210:211], v[244:245], v[36:37] op_sel_hi:[1,1,0]
    v_pk_fma_f32 v[42:43], v[42:43], v[194:195], v[30:31]
    v_pk_fma_f32 v[32:33], v[42:43], s[58:59], v[36:37] op_sel:[0,0,1] op_sel_hi:[1,1,1]
    v_exp_f32 v32, v32 clamp
    v_exp_f32 v33, v33 clamp
    v_max_f32 v42, v42, v36
    v_max_f32 v43, v43, v36
    v_pk_add_f32 v[42:43], v[42:43], v[32:33]
    v_pk_mul_f32 v[34:35], v[210:211], v[248:249]
    v_pk_fma_f32 v[58:59], v[58:59], v[194:195], v[34:35]
    v_cvt_pk_bf16_f32 v41, v42, v43
    v_cvt_pk_bf16_f32 v57, v58, v59
    s_waitcnt lgkmcnt(4)
    v_pk_fma_f32 v[30:31], v[212:213], v[244:245], v[36:37] op_sel_hi:[1,1,0]
    v_pk_fma_f32 v[44:45], v[44:45], v[196:197], v[30:31]
    v_pk_fma_f32 v[32:33], v[44:45], s[58:59], v[36:37] op_sel:[0,0,1] op_sel_hi:[1,1,1]
    v_exp_f32 v32, v32 clamp
    v_exp_f32 v33, v33 clamp
    v_max_f32 v44, v44, v36
    v_max_f32 v45, v45, v36
    v_pk_add_f32 v[44:45], v[44:45], v[32:33]
    v_pk_mul_f32 v[34:35], v[212:213], v[248:249]
    v_pk_fma_f32 v[60:61], v[60:61], v[196:197], v[34:35]
    v_cvt_pk_bf16_f32 v42, v44, v45
    v_cvt_pk_bf16_f32 v58, v60, v61
    v_pk_fma_f32 v[30:31], v[214:215], v[244:245], v[36:37] op_sel_hi:[1,1,0]
    v_pk_fma_f32 v[46:47], v[46:47], v[198:199], v[30:31]
    v_pk_fma_f32 v[32:33], v[46:47], s[58:59], v[36:37] op_sel:[0,0,1] op_sel_hi:[1,1,1]
    v_exp_f32 v32, v32 clamp
    v_exp_f32 v33, v33 clamp
    v_max_f32 v46, v46, v36
    v_max_f32 v47, v47, v36
    v_pk_add_f32 v[46:47], v[46:47], v[32:33]
    v_pk_mul_f32 v[34:35], v[214:215], v[248:249]
    v_pk_fma_f32 v[62:63], v[62:63], v[198:199], v[34:35]
    v_cvt_pk_bf16_f32 v43, v46, v47
    v_cvt_pk_bf16_f32 v59, v62, v63
    s_waitcnt lgkmcnt(2)
    v_pk_fma_f32 v[30:31], v[216:217], v[244:245], v[36:37] op_sel_hi:[1,1,0]
    v_pk_fma_f32 v[48:49], v[48:49], v[200:201], v[30:31]
    v_pk_fma_f32 v[32:33], v[48:49], s[58:59], v[36:37] op_sel:[0,0,1] op_sel_hi:[1,1,1]
    v_exp_f32 v32, v32 clamp
    v_exp_f32 v33, v33 clamp
    v_max_f32 v48, v48, v36
    v_max_f32 v49, v49, v36
    v_pk_add_f32 v[48:49], v[48:49], v[32:33]
    v_pk_mul_f32 v[34:35], v[216:217], v[248:249]
    v_pk_fma_f32 v[64:65], v[64:65], v[200:201], v[34:35]
    v_cvt_pk_bf16_f32 v44, v48, v49
    v_cvt_pk_bf16_f32 v60, v64, v65
    v_pk_fma_f32 v[30:31], v[218:219], v[244:245], v[36:37] op_sel_hi:[1,1,0]
    v_pk_fma_f32 v[50:51], v[50:51], v[202:203], v[30:31]
    v_pk_fma_f32 v[32:33], v[50:51], s[58:59], v[36:37] op_sel:[0,0,1] op_sel_hi:[1,1,1]
    v_exp_f32 v32, v32 clamp
    v_exp_f32 v33, v33 clamp
    v_max_f32 v50, v50, v36
    v_max_f32 v51, v51, v36
    v_pk_add_f32 v[50:51], v[50:51], v[32:33]
    v_pk_mul_f32 v[34:35], v[218:219], v[248:249]
    v_pk_fma_f32 v[66:67], v[66:67], v[202:203], v[34:35]
    v_cvt_pk_bf16_f32 v45, v50, v51
    v_cvt_pk_bf16_f32 v61, v66, v67
    s_waitcnt lgkmcnt(0)
    v_pk_fma_f32 v[30:31], v[220:221], v[244:245], v[36:37] op_sel_hi:[1,1,0]
    v_pk_fma_f32 v[52:53], v[52:53], v[204:205], v[30:31]
    v_pk_fma_f32 v[32:33], v[52:53], s[58:59], v[36:37] op_sel:[0,0,1] op_sel_hi:[1,1,1]
    v_exp_f32 v32, v32 clamp
    v_exp_f32 v33, v33 clamp
    v_max_f32 v52, v52, v36
    v_max_f32 v53, v53, v36
    v_pk_add_f32 v[52:53], v[52:53], v[32:33]
    v_pk_mul_f32 v[34:35], v[220:221], v[248:249]
    v_pk_fma_f32 v[68:69], v[68:69], v[204:205], v[34:35]
    v_cvt_pk_bf16_f32 v46, v52, v53
    v_cvt_pk_bf16_f32 v62, v68, v69
    v_pk_fma_f32 v[30:31], v[222:223], v[244:245], v[36:37] op_sel_hi:[1,1,0]
    v_pk_fma_f32 v[54:55], v[54:55], v[206:207], v[30:31]
    v_pk_fma_f32 v[32:33], v[54:55], s[58:59], v[36:37] op_sel:[0,0,1] op_sel_hi:[1,1,1]
    v_exp_f32 v32, v32 clamp
    v_exp_f32 v33, v33 clamp
    v_max_f32 v54, v54, v36
    v_max_f32 v55, v55, v36
    v_pk_add_f32 v[54:55], v[54:55], v[32:33]
    v_pk_mul_f32 v[34:35], v[222:223], v[248:249]
    v_pk_fma_f32 v[70:71], v[70:71], v[206:207], v[34:35]
    v_cvt_pk_bf16_f32 v47, v54, v55
    v_cvt_pk_bf16_f32 v63, v70, v71
    v_mfma_f32_16x16x32_bf16 v[88:91], v[56:59], v[40:43], 0
    v_lshlrev_b32 v6, 2, v2
    v_lshl_add_u32 v7, v3, 8, v6
    v_mfma_f32_16x16x32_bf16 v[88:91], v[60:63], v[44:47], v[88:91]
    v_add_u32 v6, 1024, v6
    v_cmp_gt_u32 vcc, 16, v1
    v_mfma_f32_16x16x32_bf16 v[92:95], v[240:243], v[40:43], 0
    s_add_u32 s44, s36, 0x00f00000
    v_cndmask_b32 v6, v4, v6, vcc
    v_mfma_f32_16x16x32_bf16 v[92:95], v[240:243], v[44:47], v[92:95]
    s_waitcnt vmcnt(0)
    v_cmp_eq_u32 vcc, 0, v17
    s_mov_b32 s46, 0x80000
    s_cbranch_vccnz L_fl_spin
L_fl_ok:
    v_mfma_f32_16x16x32_bf16 v[80:83], a[140:143], v[120:123], v[80:83]
    v_mfma_f32_16x16x32_bf16 v[84:87], a[140:143], v[124:127], v[84:87]
    v_mfma_f32_16x16x32_bf16 v[72:75], a[152:155], v[128:131], v[72:75]
    buffer_atomic_add_f32 v88, v7, s[16:19], s44 offen offset:0
    buffer_atomic_add_f32 v89, v7, s[16:19], s44 offen offset:64
    buffer_atomic_add_f32 v90, v7, s[16:19], s44 offen offset:128
    v_mfma_f32_16x16x32_bf16 v[76:79], a[152:155], v[132:135], v[76:79]
    buffer_atomic_add_f32 v91, v7, s[16:19], s44 offen offset:192
    buffer_atomic_add_f32 v92, v6, s[16:19], s44 offen
    v_xor_b32 v5, 0, v8
    v_mfma_f32_16x16x32_bf16 v[80:83], a[152:155], v[136:139], v[80:83]
    ds_read2_b32 v[224:225], v5 offset0:0 offset1:64
    v_xor_b32 v5, 64, v8
    v_mfma_f32_16x16x32_bf16 v[84:87], a[152:155], v[140:143], v[84:87]
    ds_read2_b32 v[226:227], v5 offset0:0 offset1:64
    v_xor_b32 v5, 128, v8
    ds_read2_b32 v[228:229], v5 offset0:0 offset1:64
    v_mfma_f32_16x16x32_bf16 v[72:75], a[164:167], v[144:147], v[72:75]
    v_xor_b32 v5, 192, v8
    ds_read2_b32 v[230:231], v5 offset0:0 offset1:64
    v_mfma_f32_16x16x32_bf16 v[76:79], a[164:167], v[148:151], v[76:79]
    s_and_b32 s45, s28, 1
    v_and_b32 v5, 1, v3
    v_xor_b32 v5, s45, v5
    v_mfma_f32_16x16x32_bf16 v[80:83], a[164:167], v[152:155], v[80:83]
    v_lshrrev_b32 v9, 1, v2
    v_lshl_add_u32 v5, v5, 3, v9
    v_mfma_f32_16x16x32_bf16 v[84:87], a[164:167], v[156:159], v[84:87]
    v_and_b32 v9, 1, v2
    v_lshl_add_u32 v5, v9, 4, v5
    v_lshrrev_b32 v9, 1, v3
    v_mfma_f32_16x16x32_bf16 v[72:75], a[176:179], v[160:163], v[72:75]
    v_lshl_add_u32 v5, v9, 5, v5
    v_lshlrev_b32 v8, 4, v5
    s_lshl_b32 s48, s29, 16
    v_mfma_f32_16x16x32_bf16 v[76:79], a[176:179], v[164:167], v[76:79]
    s_lshl_b32 s45, s35, 10
    s_add_u32 s48, s48, s45
    v_mfma_f32_16x16x32_bf16 v[80:83], a[176:179], v[168:171], v[80:83]
    s_add_u32 s48, s48, 0x00000000
    s_lshr_b32 s45, s28, 1
    s_lshl_b32 s45, s45, 15
    v_mfma_f32_16x16x32_bf16 v[84:87], a[176:179], v[172:175], v[84:87]
    s_add_u32 s46, s48, s45
    s_xor_b32 s45, s45, 32768
    v_mfma_f32_16x16x32_bf16 v[72:75], a[188:191], v[176:179], v[72:75]
    s_add_u32 s47, s48, s45
    s_getreg_b32 s42, hwreg(HW_REG_XCC_ID)
    s_and_b32 s42, s42, 7
    v_mfma_f32_16x16x32_bf16 v[76:79], a[188:191], v[180:183], v[76:79]
    s_lshl_b32 s42, s42, 8
    s_add_u32 s42, s42, 0x00f1c000
    v_mfma_f32_16x16x32_bf16 v[80:83], a[188:191], v[184:187], v[80:83]
    v_mov_b32 v38, 1
    v_mov_b32 v39, 0
    v_cmp_eq_u32 vcc, 0, v0
    v_mfma_f32_16x16x32_bf16 v[84:87], a[188:191], v[188:191], v[84:87]
    s_nop 0
    v_cndmask_b32 v39, v4, v39, vcc
    buffer_atomic_add v38, v39, s[16:19], s42 offen offset:2048 sc0 sc1
    s_waitcnt lgkmcnt(3)
    v_pk_fma_f32 v[30:31], v[252:253], v[224:225], v[36:37] op_sel:[0,1,0] op_sel_hi:[1,1,0]
    v_pk_fma_f32 v[72:73], v[72:73], v[224:225], v[30:31] op_sel_hi:[1,0,1]
    v_pk_fma_f32 v[32:33], v[72:73], s[58:59], v[36:37] op_sel:[0,0,1] op_sel_hi:[1,1,1]
    v_exp_f32 v32, v32 clamp
    v_exp_f32 v33, v33 clamp
    v_max_f32 v72, v72, v36
    v_max_f32 v73, v73, v36
    v_pk_add_f32 v[72:73], v[72:73], v[32:33]
    v_cvt_pk_bf16_f32 v120, v72, v73
    v_pk_fma_f32 v[30:31], v[254:255], v[224:225], v[36:37] op_sel:[0,1,0] op_sel_hi:[1,1,0]
    v_pk_fma_f32 v[74:75], v[74:75], v[224:225], v[30:31] op_sel_hi:[1,0,1]
    v_pk_fma_f32 v[32:33], v[74:75], s[58:59], v[36:37] op_sel:[0,0,1] op_sel_hi:[1,1,1]
    v_exp_f32 v32, v32 clamp
    v_exp_f32 v33, v33 clamp
    v_max_f32 v74, v74, v36
    v_max_f32 v75, v75, v36
    v_pk_add_f32 v[74:75], v[74:75], v[32:33]
    v_cvt_pk_bf16_f32 v121, v74, v75
    s_waitcnt lgkmcnt(2)
    v_pk_fma_f32 v[30:31], v[252:253], v[226:227], v[36:37] op_sel:[0,1,0] op_sel_hi:[1,1,0]
    v_pk_fma_f32 v[76:77], v[76:77], v[226:227], v[30:31] op_sel_hi:[1,0,1]
    v_pk_fma_f32 v[32:33], v[76:77], s[58:59], v[36:37] op_sel:[0,0,1] op_sel_hi:[1,1,1]
    v_exp_f32 v32, v32 clamp
    v_exp_f32 v33, v33 clamp
    v_max_f32 v76, v76, v36
    v_max_f32 v77, v77, v36
    v_pk_add_f32 v[76:77], v[76:77], v[32:33]
    v_cvt_pk_bf16_f32 v122, v76, v77
    v_pk_fma_f32 v[30:31], v[254:255], v[226:227], v[36:37] op_sel:[0,1,0] op_sel_hi:[1,1,0]
    v_pk_fma_f32 v[78:79], v[78:79], v[226:227], v[30:31] op_sel_hi:[1,0,1]
    v_pk_fma_f32 v[32:33], v[78:79], s[58:59], v[36:37] op_sel:[0,0,1] op_sel_hi:[1,1,1]
    v_exp_f32 v32, v32 clamp
    v_exp_f32 v33, v33 clamp
    v_max_f32 v78, v78, v36
    v_max_f32 v79, v79, v36
    v_pk_add_f32 v[78:79], v[78:79], v[32:33]
    v_cvt_pk_bf16_f32 v123, v78, v79
    v_permlane16_swap_b32 v120, v122
    s_nop 0
    v_permlane16_swap_b32 v121, v123
    buffer_store_dwordx4 v[120:123], v8, s[16:19], s46 offen sc1
    s_waitcnt lgkmcnt(1)
    v_pk_fma_f32 v[30:31], v[252:253], v[228:229], v[36:37] op_sel:[0,1,0] op_sel_hi:[1,1,0]
    v_pk_fma_f32 v[80:81], v[80:81], v[228:229], v[30:31] op_sel_hi:[1,0,1]
    v_pk_fma_f32 v[32:33], v[80:81], s[58:59], v[36:37] op_sel:[0,0,1] op_sel_hi:[1,1,1]
    v_exp_f32 v32, v32 clamp
    v_exp_f32 v33, v33 clamp
    v_max_f32 v80, v80, v36
    v_max_f32 v81, v81, v36
    v_pk_add_f32 v[80:81], v[80:81], v[32:33]
    v_cvt_pk_bf16_f32 v124, v80, v81
    v_pk_fma_f32 v[30:31], v[254:255], v[228:229], v[36:37] op_sel:[0,1,0] op_sel_hi:[1,1,0]
    v_pk_fma_f32 v[82:83], v[82:83], v[228:229], v[30:31] op_sel_hi:[1,0,1]
    v_pk_fma_f32 v[32:33], v[82:83], s[58:59], v[36:37] op_sel:[0,0,1] op_sel_hi:[1,1,1]
    v_exp_f32 v32, v32 clamp
    v_exp_f32 v33, v33 clamp
    v_max_f32 v82, v82, v36
    v_max_f32 v83, v83, v36
    v_pk_add_f32 v[82:83], v[82:83], v[32:33]
    v_cvt_pk_bf16_f32 v125, v82, v83
    s_waitcnt lgkmcnt(0)
    v_pk_fma_f32 v[30:31], v[252:253], v[230:231], v[36:37] op_sel:[0,1,0] op_sel_hi:[1,1,0]
    v_pk_fma_f32 v[84:85], v[84:85], v[230:231], v[30:31] op_sel_hi:[1,0,1]
    v_pk_fma_f32 v[32:33], v[84:85], s[58:59], v[36:37] op_sel:[0,0,1] op_sel_hi:[1,1,1]
    v_exp_f32 v32, v32 clamp
    v_exp_f32 v33, v33 clamp
    v_max_f32 v84, v84, v36
    v_max_f32 v85, v85, v36
    v_pk_add_f32 v[84:85], v[84:85], v[32:33]
    v_cvt_pk_bf16_f32 v126, v84, v85
    v_pk_fma_f32 v[30:31], v[254:255], v[230:231], v[36:37] op_sel:[0,1,0] op_sel_hi:[1,1,0]
    v_pk_fma_f32 v[86:87], v[86:87], v[230:231], v[30:31] op_sel_hi:[1,0,1]
    v_pk_fma_f32 v[32:33], v[86:87], s[58:59], v[36:37] op_sel:[0,0,1] op_sel_hi:[1,1,1]
    v_exp_f32 v32, v32 clamp
    v_exp_f32 v33, v33 clamp
    v_max_f32 v86, v86, v36
    v_max_f32 v87, v87, v36
    v_pk_add_f32 v[86:87], v[86:87], v[32:33]
    v_cvt_pk_bf16_f32 v127, v86, v87
    v_permlane16_swap_b32 v124, v126
    s_nop 0
    v_permlane16_swap_b32 v125, v127
    buffer_store_dwordx4 v[124:127], v8, s[16:19], s47 offen sc1
    v_lshrrev_b32 v5, 3, v1
    v_and_b32 v6, 7, v1
    v_and_b32 v7, 2, v5
    v_lshlrev_b32 v7, 1, v7
    v_xor_b32 v7, v7, v6
    v_lshlrev_b32 v7, 4, v7
    v_lshl_add_u32 v222, v5, 10, v7
    s_lshl_b32 s62, s28, 17
    s_lshl_b32 s61, s32, 7
    s_add_u32 s62, s62, s61
    s_lshl_b32 s64, s28, 14
    v_lshrrev_b32 v5, 5, v1
    v_bfe_u32 v7, v1, 2, 2
    v_lshl_add_u32 v8, v5, 2, v7
    v_lshlrev_b32 v8, 7, v8
    v_lshrrev_b32 v7, 1, v7
    s_and_b32 s61, s28, 1
    v_xor_b32 v7, s61, v7
    v_lshl_add_u32 v8, v7, 6, v8
    v_bfe_u32 v7, v1, 4, 1
    v_lshl_add_u32 v8, v7, 5, v8
    v_and_b32 v7, 3, v1
    v_lshl_add_u32 v8, v7, 3, v8
    v_add_u32 v237, s64, v8
    v_xor_b32 v238, 64, v237
    s_add_u32 m0, s64, 0
    s_add_u32 s65, s62, 0
    buffer_load_dwordx4 v222, s[12:15], s65 offen lds
    s_add_u32 m0, s64, 1024
    s_add_u32 s65, s62, 8192
    buffer_load_dwordx4 v222, s[12:15], s65 offen lds
    s_add_u32 m0, s64, 2048
    s_add_u32 s65, s62, 16384
    buffer_load_dwordx4 v222, s[12:15], s65 offen lds
    s_add_u32 m0, s64, 3072
    s_add_u32 s65, s62, 24576
    buffer_load_dwordx4 v222, s[12:15], s65 offen lds
    s_add_u32 m0, s64, 4096
    s_add_u32 s65, s62, 32768
    buffer_load_dwordx4 v222, s[12:15], s65 offen lds
    s_add_u32 m0, s64, 5120
    s_add_u32 s65, s62, 40960
    buffer_load_dwordx4 v222, s[12:15], s65 offen lds
    s_add_u32 m0, s64, 6144
    s_add_u32 s65, s62, 49152
    buffer_load_dwordx4 v222, s[12:15], s65 offen lds
    s_add_u32 m0, s64, 7168
    s_add_u32 s65, s62, 57344
    buffer_load_dwordx4 v222, s[12:15], s65 offen lds
    s_add_u32 m0, s64, 8192
    s_add_u32 s65, s62, 65536
    buffer_load_dwordx4 v222, s[12:15], s65 offen lds
    s_add_u32 m0, s64, 9216
    s_add_u32 s65, s62, 73728
    buffer_load_dwordx4 v222, s[12:15], s65 offen lds
    s_add_u32 m0, s64, 10240
    s_add_u32 s65, s62, 81920
    buffer_load_dwordx4 v222, s[12:15], s65 offen lds
    s_add_u32 m0, s64, 11264
    s_add_u32 s65, s62, 90112
    buffer_load_dwordx4 v222, s[12:15], s65 offen lds
    s_and_b32 s40, s2, 15
    s_lshl_b32 s40, s40, 8
    s_add_u32 s40, s40, 0x00f1b000
    v_mov_b32 v236, 0
    v_cmp_eq_u32 vcc, 0, v0
    s_nop 1
    v_cndmask_b32 v232, v4, v236, vcc
    v_mov_b32 v236, 1
    s_waitcnt vmcnt(12)
    s_barrier
    buffer_atomic_add v236, v232, s[16:19], s40 offen sc1
    v_readfirstlane_b32 s43, v38
    s_add_u32 m0, s64, 12288
    s_add_u32 s65, s62, 98304
    buffer_load_dwordx4 v222, s[12:15], s65 offen lds
    s_add_u32 m0, s64, 13312
    s_add_u32 s65, s62, 106496
    buffer_load_dwordx4 v222, s[12:15], s65 offen lds
    s_add_u32 m0, s64, 14336
    s_add_u32 s65, s62, 114688
    buffer_load_dwordx4 v222, s[12:15], s65 offen lds
    s_add_u32 m0, s64, 15360
    s_add_u32 s65, s62, 122880
    buffer_load_dwordx4 v222, s[12:15], s65 offen lds
    s_waitcnt vmcnt(15)
    ds_read_b64_tr_b16 a[192:193], v237 offset:0
    ds_read_b64_tr_b16 a[194:195], v237 offset:1024
    ds_read_b64_tr_b16 a[196:197], v238 offset:0
    ds_read_b64_tr_b16 a[198:199], v238 offset:1024
    s_waitcnt vmcnt(13)
    ds_read_b64_tr_b16 a[200:201], v237 offset:2048
    ds_read_b64_tr_b16 a[202:203], v237 offset:3072
    ds_read_b64_tr_b16 a[204:205], v238 offset:2048
    ds_read_b64_tr_b16 a[206:207], v238 offset:3072
    s_waitcnt vmcnt(11)
    ds_read_b64_tr_b16 a[208:209], v237 offset:4096
    ds_read_b64_tr_b16 a[210:211], v237 offset:5120
    ds_read_b64_tr_b16 a[212:213], v238 offset:4096
    ds_read_b64_tr_b16 a[214:215], v238 offset:5120
    s_waitcnt vmcnt(9)
    ds_read_b64_tr_b16 a[216:217], v237 offset:6144
    ds_read_b64_tr_b16 a[218:219], v237 offset:7168
    ds_read_b64_tr_b16 a[220:221], v238 offset:6144
    ds_read_b64_tr_b16 a[222:223], v238 offset:7168
    s_waitcnt vmcnt(7)
    ds_read_b64_tr_b16 a[224:225], v237 offset:8192
    ds_read_b64_tr_b16 a[226:227], v237 offset:9216
    ds_read_b64_tr_b16 a[228:229], v238 offset:8192
    ds_read_b64_tr_b16 a[230:231], v238 offset:9216
    s_waitcnt vmcnt(5)
    ds_read_b64_tr_b16 a[232:233], v237 offset:10240
    ds_read_b64_tr_b16 a[234:235], v237 offset:11264
    ds_read_b64_tr_b16 a[236:237], v238 offset:10240
    ds_read_b64_tr_b16 a[238:239], v238 offset:11264
    s_waitcnt vmcnt(2)
    ds_read_b64_tr_b16 a[240:241], v237 offset:12288
    ds_read_b64_tr_b16 a[242:243], v237 offset:13312
    ds_read_b64_tr_b16 a[244:245], v238 offset:12288
    ds_read_b64_tr_b16 a[246:247], v238 offset:13312
    s_waitcnt vmcnt(0)
    ds_read_b64_tr_b16 a[248:249], v237 offset:14336
    ds_read_b64_tr_b16 a[250:251], v237 offset:15360
    ds_read_b64_tr_b16 a[252:253], v238 offset:14336
    ds_read_b64_tr_b16 a[254:255], v238 offset:15360
    v_lshlrev_b32 v10, 4, v1
    v_and_b32 v5, 31, v1
    v_lshrrev_b32 v6, 5, v1
    v_lshrrev_b32 v7, 4, v5
    v_lshl_add_u32 v12, v2, 1, v7
    s_lshr_b32 s45, s28, 1
    s_lshl_b32 s45, s45, 5
    s_lshl_b32 s46, s31, 6
    s_add_u32 s52, s45, s46
    s_and_b32 s45, s28, 1
    s_lshl_b32 s45, s45, 3
    s_lshl_b32 s46, s32, 4
    s_add_u32 s53, s45, s46
    s_mov_b32 s55, s52
    v_lshlrev_b32 v13, 10, v12
    v_lshl_add_u32 v13, v6, 3, v13
    s_lshl_b32 s54, s55, 10
    s_lshl_b32 s45, s53, 3
    s_add_u32 s54, s54, s45
    buffer_load_dwordx2 v[216:217], v13, s[4:7], s54 offen offset:0
    buffer_load_dwordx2 v[218:219], v13, s[4:7], s54 offen offset:16
    buffer_load_dwordx2 v[220:221], v13, s[4:7], s54 offen offset:32
    buffer_load_dwordx2 v[222:223], v13, s[4:7], s54 offen offset:48
    s_mul_i32 s64, s28, 9216
    s_add_u32 s64, s64, 66560
    v_min_u32 v7, 16, v5
    v_lshlrev_b32 v7, 6, v7
    v_lshl_add_u32 v7, v6, 5, v7
    v_add_u32 v11, s64, v7
    s_mul_i32 s62, s28, 8704
    s_add_u32 s62, s62, 0x00f00000
    s_lshl_b32 s44, s31, 16
    s_lshl_b32 s45, s28, 13
    s_add_u32 s44, s44, s45
    s_add_u32 s44, s44, 0x00000000
    s_lshr_b32 s45, s28, 1
    s_lshl_b32 s45, s45, 15
    s_add_u32 s50, s44, s45
    s_add_u32 s51, s50, 4096
    s_xor_b32 s45, s45, 32768
    s_add_u32 s48, s44, s45
    s_add_u32 s49, s48, 4096
    v_mov_b32 v14, 0x358637bd
    s_mul_i32 s45, s28, 12288
    s_add_u32 s45, s45, 103424
    v_add_u32 v15, s45, v10
    s_xor_b32 s45, s28, 2
    s_mul_i32 s45, s45, 12288
    s_add_u32 s45, s45, 103424
    v_add_u32 v233, s45, v10
    s_xor_b32 s45, s28, 1
    s_mul_i32 s45, s45, 12288
    s_add_u32 s45, s45, 103424
    v_add_u32 v234, s45, v10
    s_xor_b32 s45, s28, 3
    s_mul_i32 s45, s45, 12288
    s_add_u32 s45, s45, 103424
    v_add_u32 v13, s45, v10
    v_bfe_u32 v7, v1, 4, 1
    v_lshl_add_u32 v7, v7, 1, v6
    v_lshlrev_b32 v7, 14, v7
    v_lshl_add_u32 v235, v2, 4, v7
    s_lshl_b32 s56, s53, 14
    s_lshl_b32 s45, s52, 3
    s_add_u32 s56, s56, s45
    s_add_u32 s56, s56, 0x00400000
    s_add_u32 s57, s56, 65536
    s_add_u32 s58, s45, 0x00f12000
    v_lshlrev_b32 v12, 4, v2
    v_lshl_add_u32 v12, v3, 2, v12
    v_mov_b32 v8, 0
    v_mov_b32 v9, 0
    s_lshl_b32 s59, s33, 2
    s_add_u32 s59, s59, s28
    s_mul_i32 s59, s59, 6144
    s_add_u32 s59, s59, 0x00a00000
    s_add_u32 s60, s59, 3072
    s_waitcnt vmcnt(3)
    v_lshlrev_b32 v16, 16, v216
    v_and_b32 v17, 0xffff0000, v216
    v_lshlrev_b32 v18, 16, v217
    v_and_b32 v19, 0xffff0000, v217
    s_waitcnt vmcnt(2)
    v_lshlrev_b32 v20, 16, v218
    v_and_b32 v21, 0xffff0000, v218
    v_lshlrev_b32 v22, 16, v219
    v_and_b32 v23, 0xffff0000, v219
    s_waitcnt vmcnt(1)
    v_lshlrev_b32 v24, 16, v220
    v_and_b32 v25, 0xffff0000, v220
    v_lshlrev_b32 v26, 16, v221
    v_and_b32 v27, 0xffff0000, v221
    s_waitcnt vmcnt(0)
    v_lshlrev_b32 v28, 16, v222
    v_and_b32 v29, 0xffff0000, v222
    v_lshlrev_b32 v30, 16, v223
    v_and_b32 v31, 0xffff0000, v223
    s_mov_b32 m0, s64
    s_cmp_lg_u32 s28, 0
    s_cbranch_scc1 L_gw0_done
    v_mov_b32 v232, 0
    s_mov_b32 s46, 0x80000
    s_cmp_lg_u32 s43, 0
    s_cbranch_scc1 L_gw0_poll
    s_mov_b32 s45, 0x00f1b000
    v_lshlrev_b32 v237, 8, v1
    v_cmp_gt_u32 vcc, 16, v1
    s_nop 1
    v_cndmask_b32 v237, v4, v237, vcc
L_gw0_mp:
    v_mov_b32 v236, 0
    buffer_atomic_add v236, v237, s[16:19], s45 offen sc0 sc1
    s_waitcnt vmcnt(0)
    v_cmp_gt_u32 vcc, 16, v236
    s_sub_u32 s46, s46, 1
    s_cbranch_scc1 L_gw0_done
    s_and_b32 s40, vcc_lo, 0xffff
    s_cbranch_scc1 L_gw0_mp
    v_mov_b32 v237, 1
    buffer_store_dword v237, v232, s[16:19], s42 offen
    s_branch L_gw0_done
L_gw0_poll:
    buffer_load_dword v236, v232, s[16:19], s42 offen sc1
    s_waitcnt vmcnt(0)
    v_readfirstlane_b32 s45, v236
    s_sub_u32 s46, s46, 1
    s_cbranch_scc1 L_gw0_done
    s_cmp_lt_u32 s45, 1
    s_cbranch_scc1 L_gw0_poll
L_gw0_done:
    s_waitcnt lgkmcnt(0)
    s_barrier
    buffer_load_dwordx4 v10, s[16:19], s62 offen offset:0 sc1 lds
    buffer_load_dwordx4 v10, s[16:19], s62 offen offset:1024 sc1 lds
    buffer_load_dwordx4 v[144:147], v10, s[16:19], s48 offen offset:0 sc1
    buffer_load_dwordx4 v10, s[16:19], s62 offen offset:2048 sc1 lds
    buffer_load_dwordx4 v[148:151], v10, s[16:19], s48 offen offset:1024 sc1
    buffer_load_dwordx4 v10, s[16:19], s62 offen offset:3072 sc1 lds
    buffer_load_dwordx4 v[152:155], v10, s[16:19], s48 offen offset:2048 sc1
    s_add_u32 m0, s64, 4096
    s_add_u32 s62, s62, 4096
    buffer_load_dwordx4 v10, s[16:19], s62 offen offset:0 sc1 lds
    buffer_load_dwordx4 v[156:159], v10, s[16:19], s48 offen offset:3072 sc1
    buffer_load_dwordx4 v10, s[16:19], s62 offen offset:1024 sc1 lds
    buffer_load_dwordx4 v[160:163], v10, s[16:19], s49 offen offset:0 sc1
    buffer_load_dwordx4 v10, s[16:19], s62 offen offset:2048 sc1 lds
    buffer_load_dwordx4 v[164:167], v10, s[16:19], s49 offen offset:1024 sc1
    s_waitcnt vmcnt(11)
    ds_read_b128 v[224:227], v11 offset:0
    ds_read_b128 v[228:231], v11 offset:16
    s_waitcnt lgkmcnt(1)
    v_cvt_pk_bf16_f32 v112, v224, v225
    v_cvt_pk_bf16_f32 v113, v226, v227
    s_waitcnt lgkmcnt(0)
    v_cvt_pk_bf16_f32 v114, v228, v229
    v_cvt_pk_bf16_f32 v115, v230, v231
    s_waitcnt vmcnt(10)
    s_nop 0
    v_mfma_f32_32x32x16_bf16 v[80:95], v[112:115], v[144:147], 0
    s_waitcnt vmcnt(9)
    ds_read_b128 v[224:227], v11 offset:1088
    ds_read_b128 v[228:231], v11 offset:1104
    s_waitcnt lgkmcnt(1)
    v_cvt_pk_bf16_f32 v116, v224, v225
    v_cvt_pk_bf16_f32 v117, v226, v227
    s_waitcnt lgkmcnt(0)
    v_cvt_pk_bf16_f32 v118, v228, v229
    v_cvt_pk_bf16_f32 v119, v230, v231
    s_waitcnt vmcnt(8)
    s_nop 0
    v_mfma_f32_32x32x16_bf16 v[96:111], v[116:119], v[148:151], 0
    buffer_load_dwordx4 v10, s[16:19], s62 offen offset:3072 sc1 lds
    v_add_f32 v88, v88, v14
    v_rcp_f32 v88, v88
    s_nop 0
    v_mul_f32 v80, v80, v88
    v_mul_f32 v81, v81, v88
    v_cvt_pk_bf16_f32 v208, v80, v81
    buffer_load_dwordx4 v[168:171], v10, s[16:19], s49 offen offset:2048 sc1
    s_waitcnt vmcnt(9)
    ds_read_b128 v[224:227], v11 offset:2176
    ds_read_b128 v[228:231], v11 offset:2192
    v_mul_f32 v82, v82, v88
    v_mul_f32 v83, v83, v88
    v_cvt_pk_bf16_f32 v209, v82, v83
    v_mul_f32 v84, v84, v88
    v_mul_f32 v85, v85, v88
    v_cvt_pk_bf16_f32 v210, v84, v85
    v_mul_f32 v86, v86, v88
    v_mul_f32 v87, v87, v88
    v_cvt_pk_bf16_f32 v211, v86, v87
    s_waitcnt lgkmcnt(1)
    v_cvt_pk_bf16_f32 v120, v224, v225
    v_cvt_pk_bf16_f32 v121, v226, v227
    s_waitcnt lgkmcnt(0)
    v_cvt_pk_bf16_f32 v122, v228, v229
    v_cvt_pk_bf16_f32 v123, v230, v231
    s_waitcnt vmcnt(8)
    s_nop 0
    v_mfma_f32_32x32x16_bf16 v[80:95], v[120:123], v[152:155], 0
    s_add_u32 m0, s64, 8192
    s_add_u32 s62, s62, 4096
    buffer_load_dwordx4 v10, s[16:19], s62 offen offset:0 sc1 lds
    v_add_f32 v104, v104, v14
    v_rcp_f32 v104, v104
    s_nop 0
    v_mul_f32 v96, v96, v104
    v_mul_f32 v97, v97, v104
    v_cvt_pk_bf16_f32 v212, v96, v97
    v_mfma_f32_32x32x16_bf16 v[64:79], a[196:199], v[208:211], 0
    buffer_load_dwordx4 v[172:175], v10, s[16:19], s49 offen offset:3072 sc1
    s_waitcnt vmcnt(9)
    ds_read_b128 v[224:227], v11 offset:3264
    ds_read_b128 v[228:231], v11 offset:3280
    v_mul_f32 v98, v98, v104
    v_mul_f32 v99, v99, v104
    v_cvt_pk_bf16_f32 v213, v98, v99
    v_mul_f32 v100, v100, v104
    v_mul_f32 v101, v101, v104
    v_mfma_f32_32x32x16_bf16 v[48:63], a[192:195], v[208:211], 0
    v_cvt_pk_bf16_f32 v214, v100, v101
    v_mul_f32 v102, v102, v104
    v_mul_f32 v103, v103, v104
    v_cvt_pk_bf16_f32 v215, v102, v103
    s_waitcnt lgkmcnt(1)
    v_cvt_pk_bf16_f32 v124, v224, v225
    v_cvt_pk_bf16_f32 v125, v226, v227
    s_waitcnt lgkmcnt(0)
    v_cvt_pk_bf16_f32 v126, v228, v229
    v_cvt_pk_bf16_f32 v127, v230, v231
    s_waitcnt vmcnt(8)
    s_nop 0
    v_mfma_f32_32x32x16_bf16 v[96:111], v[124:127], v[156:159], 0
    buffer_load_dwordx4 v[176:179], v10, s[16:19], s50 offen offset:0 sc1
    v_add_f32 v88, v88, v14
    v_rcp_f32 v88, v88
    s_nop 0
    v_mul_f32 v80, v80, v88
    v_mul_f32 v81, v81, v88
    v_cvt_pk_bf16_f32 v208, v80, v81
    v_mfma_f32_32x32x16_bf16 v[64:79], a[204:207], v[212:215], v[64:79]
    buffer_load_dwordx4 v[180:183], v10, s[16:19], s50 offen offset:1024 sc1
    s_waitcnt vmcnt(9)
    ds_read_b128 v[224:227], v11 offset:4352
    ds_read_b128 v[228:231], v11 offset:4368
    v_mul_f32 v82, v82, v88
    v_mul_f32 v83, v83, v88
    v_cvt_pk_bf16_f32 v209, v82, v83
    v_mul_f32 v84, v84, v88
    v_mul_f32 v85, v85, v88
    v_mfma_f32_32x32x16_bf16 v[48:63], a[200:203], v[212:215], v[48:63]
    v_cvt_pk_bf16_f32 v210, v84, v85
    v_mul_f32 v86, v86, v88
    v_mul_f32 v87, v87, v88
    v_cvt_pk_bf16_f32 v211, v86, v87
    s_waitcnt lgkmcnt(1)
    v_cvt_pk_bf16_f32 v128, v224, v225
    v_cvt_pk_bf16_f32 v129, v226, v227
    s_waitcnt lgkmcnt(0)
    v_cvt_pk_bf16_f32 v130, v228, v229
    v_cvt_pk_bf16_f32 v131, v230, v231
    s_waitcnt vmcnt(8)
    s_nop 0
    v_mfma_f32_32x32x16_bf16 v[80:95], v[128:131], v[160:163], 0
    buffer_load_dwordx4 v[184:187], v10, s[16:19], s50 offen offset:2048 sc1
    v_add_f32 v104, v104, v14
    v_rcp_f32 v104, v104
    s_nop 0
    v_mul_f32 v96, v96, v104
    v_mul_f32 v97, v97, v104
    v_cvt_pk_bf16_f32 v212, v96, v97
    v_mfma_f32_32x32x16_bf16 v[64:79], a[212:215], v[208:211], v[64:79]
    buffer_load_dwordx4 v[188:191], v10, s[16:19], s50 offen offset:3072 sc1
    s_waitcnt vmcnt(9)
    ds_read_b128 v[224:227], v11 offset:5440
    ds_read_b128 v[228:231], v11 offset:5456
    v_mul_f32 v98, v98, v104
    v_mul_f32 v99, v99, v104
    v_cvt_pk_bf16_f32 v213, v98, v99
    v_mul_f32 v100, v100, v104
    v_mul_f32 v101, v101, v104
    v_mfma_f32_32x32x16_bf16 v[48:63], a[208:211], v[208:211], v[48:63]
    v_cvt_pk_bf16_f32 v214, v100, v101
    v_mul_f32 v102, v102, v104
    v_mul_f32 v103, v103, v104
    v_cvt_pk_bf16_f32 v215, v102, v103
    s_waitcnt lgkmcnt(1)
    v_cvt_pk_bf16_f32 v132, v224, v225
    v_cvt_pk_bf16_f32 v133, v226, v227
    s_waitcnt lgkmcnt(0)
    v_cvt_pk_bf16_f32 v134, v228, v229
    v_cvt_pk_bf16_f32 v135, v230, v231
    s_waitcnt vmcnt(8)
    s_nop 0
    v_mfma_f32_32x32x16_bf16 v[96:111], v[132:135], v[164:167], 0
    buffer_load_dwordx4 v[192:195], v10, s[16:19], s51 offen offset:0 sc1
    v_add_f32 v88, v88, v14
    v_rcp_f32 v88, v88
    s_nop 0
    v_mul_f32 v80, v80, v88
    v_mul_f32 v81, v81, v88
    v_cvt_pk_bf16_f32 v208, v80, v81
    v_mfma_f32_32x32x16_bf16 v[64:79], a[220:223], v[212:215], v[64:79]
    buffer_load_dwordx4 v[196:199], v10, s[16:19], s51 offen offset:1024 sc1
    s_waitcnt vmcnt(9)
    ds_read_b128 v[224:227], v11 offset:6528
    ds_read_b128 v[228:231], v11 offset:6544
    v_mul_f32 v82, v82, v88
    v_mul_f32 v83, v83, v88
    v_cvt_pk_bf16_f32 v209, v82, v83
    v_mul_f32 v84, v84, v88
    v_mul_f32 v85, v85, v88
    v_mfma_f32_32x32x16_bf16 v[48:63], a[216:219], v[212:215], v[48:63]
    v_cvt_pk_bf16_f32 v210, v84, v85
    v_mul_f32 v86, v86, v88
    v_mul_f32 v87, v87, v88
    v_cvt_pk_bf16_f32 v211, v86, v87
    s_waitcnt lgkmcnt(1)
    v_cvt_pk_bf16_f32 v136, v224, v225
    v_cvt_pk_bf16_f32 v137, v226, v227
    s_waitcnt lgkmcnt(0)
    v_cvt_pk_bf16_f32 v138, v228, v229
    v_cvt_pk_bf16_f32 v139, v230, v231
    s_waitcnt vmcnt(8)
    s_nop 0
    v_mfma_f32_32x32x16_bf16 v[80:95], v[136:139], v[168:171], 0
    buffer_load_dwordx4 v[200:203], v10, s[16:19], s51 offen offset:2048 sc1
    v_add_f32 v104, v104, v14
    v_rcp_f32 v104, v104
    s_nop 0
    v_mul_f32 v96, v96, v104
    v_mul_f32 v97, v97, v104
    v_cvt_pk_bf16_f32 v212, v96, v97
    v_mfma_f32_32x32x16_bf16 v[64:79], a[228:231], v[208:211], v[64:79]
    buffer_load_dwordx4 v[204:207], v10, s[16:19], s51 offen offset:3072 sc1
    s_waitcnt vmcnt(9)
    ds_read_b128 v[224:227], v11 offset:7616
    ds_read_b128 v[228:231], v11 offset:7632
    v_mul_f32 v98, v98, v104
    v_mul_f32 v99, v99, v104
    v_cvt_pk_bf16_f32 v213, v98, v99
    v_mul_f32 v100, v100, v104
    v_mul_f32 v101, v101, v104
    v_mfma_f32_32x32x16_bf16 v[48:63], a[224:227], v[208:211], v[48:63]
    v_cvt_pk_bf16_f32 v214, v100, v101
    v_mul_f32 v102, v102, v104
    v_mul_f32 v103, v103, v104
    v_cvt_pk_bf16_f32 v215, v102, v103
    s_waitcnt lgkmcnt(1)
    v_cvt_pk_bf16_f32 v140, v224, v225
    v_cvt_pk_bf16_f32 v141, v226, v227
    s_waitcnt lgkmcnt(0)
    v_cvt_pk_bf16_f32 v142, v228, v229
    v_cvt_pk_bf16_f32 v143, v230, v231
    s_waitcnt vmcnt(8)
    s_nop 0
    v_mfma_f32_32x32x16_bf16 v[96:111], v[140:143], v[172:175], 0
    v_add_f32 v88, v88, v14
    v_rcp_f32 v88, v88
    s_nop 0
    v_mul_f32 v80, v80, v88
    v_mul_f32 v81, v81, v88
    v_cvt_pk_bf16_f32 v208, v80, v81
    v_mfma_f32_32x32x16_bf16 v[64:79], a[236:239], v[212:215], v[64:79]
    v_mul_f32 v82, v82, v88
    v_mul_f32 v83, v83, v88
    v_cvt_pk_bf16_f32 v209, v82, v83
    v_mul_f32 v84, v84, v88
    v_mul_f32 v85, v85, v88
    v_mfma_f32_32x32x16_bf16 v[48:63], a[232:235], v[212:215], v[48:63]
    v_cvt_pk_bf16_f32 v210, v84, v85
    v_mul_f32 v86, v86, v88
    v_mul_f32 v87, v87, v88
    v_cvt_pk_bf16_f32 v211, v86, v87
    s_waitcnt vmcnt(7)
    v_mfma_f32_32x32x16_bf16 v[80:95], v[112:115], v[176:179], 0
    v_add_f32 v104, v104, v14
    v_rcp_f32 v104, v104
    s_nop 0
    v_mul_f32 v96, v96, v104
    v_mul_f32 v97, v97, v104
    v_cvt_pk_bf16_f32 v212, v96, v97
    v_mfma_f32_32x32x16_bf16 v[64:79], a[244:247], v[208:211], v[64:79]
    v_mul_f32 v98, v98, v104
    v_mul_f32 v99, v99, v104
    v_cvt_pk_bf16_f32 v213, v98, v99
    v_mul_f32 v100, v100, v104
    v_mul_f32 v101, v101, v104
    v_mfma_f32_32x32x16_bf16 v[48:63], a[240:243], v[208:211], v[48:63]
    v_cvt_pk_bf16_f32 v214, v100, v101
    v_mul_f32 v102, v102, v104
    v_mul_f32 v103, v103, v104
    v_cvt_pk_bf16_f32 v215, v102, v103
    s_waitcnt vmcnt(6)
    v_mfma_f32_32x32x16_bf16 v[96:111], v[116:119], v[180:183], 0
    v_add_f32 v88, v88, v14
    v_rcp_f32 v88, v88
    s_nop 0
    v_mul_f32 v80, v80, v88
    v_mul_f32 v81, v81, v88
    v_cvt_pk_bf16_f32 v208, v80, v81
    v_mfma_f32_32x32x16_bf16 v[64:79], a[252:255], v[212:215], v[64:79]
    v_mul_f32 v82, v82, v88
    v_mul_f32 v83, v83, v88
    v_cvt_pk_bf16_f32 v209, v82, v83
    v_mul_f32 v84, v84, v88
    v_mul_f32 v85, v85, v88
    v_mfma_f32_32x32x16_bf16 v[48:63], a[248:251], v[212:215], v[48:63]
    v_cvt_pk_bf16_f32 v210, v84, v85
    v_mul_f32 v86, v86, v88
    v_mul_f32 v87, v87, v88
    v_cvt_pk_bf16_f32 v211, v86, v87
    s_waitcnt vmcnt(5)
    v_mfma_f32_32x32x16_bf16 v[80:95], v[120:123], v[184:187], 0
    v_add_f32 v104, v104, v14
    v_rcp_f32 v104, v104
    s_nop 0
    v_mul_f32 v96, v96, v104
    v_mul_f32 v97, v97, v104
    v_cvt_pk_bf16_f32 v212, v96, v97
    v_mfma_f32_32x32x16_bf16 v[32:47], a[196:199], v[208:211], 0
    ds_write_b128 v15, v[64:67] offset:4096
    v_mul_f32 v98, v98, v104
    v_mul_f32 v99, v99, v104
    v_cvt_pk_bf16_f32 v213, v98, v99
    v_mul_f32 v100, v100, v104
    v_mul_f32 v101, v101, v104
    v_mfma_f32_32x32x16_bf16 v[16:31], a[192:195], v[208:211], v[16:31]
    ds_write_b128 v15, v[68:71] offset:5120
    v_cvt_pk_bf16_f32 v214, v100, v101
    v_mul_f32 v102, v102, v104
    v_mul_f32 v103, v103, v104
    v_cvt_pk_bf16_f32 v215, v102, v103
    s_waitcnt vmcnt(4)
    v_mfma_f32_32x32x16_bf16 v[96:111], v[124:127], v[188:191], 0
    v_add_f32 v88, v88, v14
    v_rcp_f32 v88, v88
    s_nop 0
    v_mul_f32 v80, v80, v88
    v_mul_f32 v81, v81, v88
    v_cvt_pk_bf16_f32 v208, v80, v81
    v_mfma_f32_32x32x16_bf16 v[32:47], a[204:207], v[212:215], v[32:47]
    ds_write_b128 v15, v[72:75] offset:6144
    v_mul_f32 v82, v82, v88
    v_mul_f32 v83, v83, v88
    v_cvt_pk_bf16_f32 v209, v82, v83
    v_mul_f32 v84, v84, v88
    v_mul_f32 v85, v85, v88
    v_mfma_f32_32x32x16_bf16 v[16:31], a[200:203], v[212:215], v[16:31]
    ds_write_b128 v15, v[76:79] offset:7168
    v_cvt_pk_bf16_f32 v210, v84, v85
    v_mul_f32 v86, v86, v88
    v_mul_f32 v87, v87, v88
    v_cvt_pk_bf16_f32 v211, v86, v87
    s_waitcnt vmcnt(3)
    v_mfma_f32_32x32x16_bf16 v[80:95], v[128:131], v[192:195], 0
    v_add_f32 v104, v104, v14
    v_rcp_f32 v104, v104
    s_nop 0
    v_mul_f32 v96, v96, v104
    v_mul_f32 v97, v97, v104
    v_cvt_pk_bf16_f32 v212, v96, v97
    v_mfma_f32_32x32x16_bf16 v[32:47], a[212:215], v[208:211], v[32:47]
    ds_write_b128 v15, v[48:51] offset:0
    v_mul_f32 v98, v98, v104
    v_mul_f32 v99, v99, v104
    v_cvt_pk_bf16_f32 v213, v98, v99
    v_mul_f32 v100, v100, v104
    v_mul_f32 v101, v101, v104
    v_mfma_f32_32x32x16_bf16 v[16:31], a[208:211], v[208:211], v[16:31]
    ds_write_b128 v15, v[52:55] offset:1024
    v_cvt_pk_bf16_f32 v214, v100, v101
    v_mul_f32 v102, v102, v104
    v_mul_f32 v103, v103, v104
    v_cvt_pk_bf16_f32 v215, v102, v103
    s_waitcnt vmcnt(2)
    v_mfma_f32_32x32x16_bf16 v[96:111], v[132:135], v[196:199], 0
    v_add_f32 v88, v88, v14
    v_rcp_f32 v88, v88
    s_nop 0
    v_mul_f32 v80, v80, v88
    v_mul_f32 v81, v81, v88
    v_cvt_pk_bf16_f32 v208, v80, v81
    v_mfma_f32_32x32x16_bf16 v[32:47], a[220:223], v[212:215], v[32:47]
    ds_write_b128 v15, v[56:59] offset:2048
    v_mul_f32 v82, v82, v88
    v_mul_f32 v83, v83, v88
    v_cvt_pk_bf16_f32 v209, v82, v83
    v_mul_f32 v84, v84, v88
    v_mul_f32 v85, v85, v88
    v_mfma_f32_32x32x16_bf16 v[16:31], a[216:219], v[212:215], v[16:31]
    ds_write_b128 v15, v[60:63] offset:3072
    v_cvt_pk_bf16_f32 v210, v84, v85
    v_mul_f32 v86, v86, v88
    v_mul_f32 v87, v87, v88
    v_cvt_pk_bf16_f32 v211, v86, v87
    s_waitcnt vmcnt(1)
    v_mfma_f32_32x32x16_bf16 v[80:95], v[136:139], v[200:203], 0
    v_add_f32 v104, v104, v14
    v_rcp_f32 v104, v104
    s_nop 0
    v_mul_f32 v96, v96, v104
    v_mul_f32 v97, v97, v104
    v_cvt_pk_bf16_f32 v212, v96, v97
    v_mfma_f32_32x32x16_bf16 v[32:47], a[228:231], v[208:211], v[32:47]
    v_mul_f32 v98, v98, v104
    v_mul_f32 v99, v99, v104
    v_cvt_pk_bf16_f32 v213, v98, v99
    v_mul_f32 v100, v100, v104
    v_mul_f32 v101, v101, v104
    v_mfma_f32_32x32x16_bf16 v[16:31], a[224:227], v[208:211], v[16:31]
    v_cvt_pk_bf16_f32 v214, v100, v101
    v_mul_f32 v102, v102, v104
    v_mul_f32 v103, v103, v104
    v_cvt_pk_bf16_f32 v215, v102, v103
    s_waitcnt lgkmcnt(0)
    s_barrier
    s_waitcnt vmcnt(0)
    v_mfma_f32_32x32x16_bf16 v[96:111], v[140:143], v[204:207], 0
    v_add_f32 v88, v88, v14
    v_rcp_f32 v88, v88
    s_nop 0
    v_mul_f32 v80, v80, v88
    v_mul_f32 v81, v81, v88
    v_cvt_pk_bf16_f32 v208, v80, v81
    v_mfma_f32_32x32x16_bf16 v[32:47], a[236:239], v[212:215], v[32:47]
    ds_read_b128 v[144:147], v233 offset:0
    ds_read_b128 v[148:151], v233 offset:1024
    v_mul_f32 v82, v82, v88
    v_mul_f32 v83, v83, v88
    v_cvt_pk_bf16_f32 v209, v82, v83
    v_mul_f32 v84, v84, v88
    v_mul_f32 v85, v85, v88
    v_mfma_f32_32x32x16_bf16 v[16:31], a[232:235], v[212:215], v[16:31]
    ds_read_b128 v[152:155], v233 offset:2048
    ds_read_b128 v[156:159], v233 offset:3072
    v_cvt_pk_bf16_f32 v210, v84, v85
    v_mul_f32 v86, v86, v88
    v_mul_f32 v87, v87, v88
    v_cvt_pk_bf16_f32 v211, v86, v87
    v_add_f32 v104, v104, v14
    v_rcp_f32 v104, v104
    s_nop 0
    v_mul_f32 v96, v96, v104
    v_mul_f32 v97, v97, v104
    v_cvt_pk_bf16_f32 v212, v96, v97
    v_mfma_f32_32x32x16_bf16 v[32:47], a[244:247], v[208:211], v[32:47]
    ds_read_b128 v[160:163], v13 offset:4096
    ds_read_b128 v[164:167], v13 offset:5120
    v_mul_f32 v98, v98, v104
    v_mul_f32 v99, v99, v104
    v_cvt_pk_bf16_f32 v213, v98, v99
    v_mul_f32 v100, v100, v104
    v_mul_f32 v101, v101, v104
    v_mfma_f32_32x32x16_bf16 v[16:31], a[240:243], v[208:211], v[16:31]
    ds_read_b128 v[168:171], v13 offset:6144
    ds_read_b128 v[172:175], v13 offset:7168
    v_cvt_pk_bf16_f32 v214, v100, v101
    v_mul_f32 v102, v102, v104
    v_mul_f32 v103, v103, v104
    v_cvt_pk_bf16_f32 v215, v102, v103
    s_nop 1
    v_mfma_f32_32x32x16_bf16 v[32:47], a[252:255], v[212:215], v[32:47]
    buffer_load_dwordx4 v[48:51], v10, s[16:19], s59 offen offset:0 sc1
    v_mfma_f32_32x32x16_bf16 v[16:31], a[248:251], v[212:215], v[16:31]
    buffer_load_dwordx4 v[52:55], v10, s[16:19], s59 offen offset:1024 sc1
    s_waitcnt lgkmcnt(3)
    v_add_f32 v144, v144, v160
    v_add_f32 v145, v145, v161
    v_add_f32 v146, v146, v162
    v_add_f32 v147, v147, v163
    s_waitcnt lgkmcnt(2)
    v_add_f32 v148, v148, v164
    v_add_f32 v149, v149, v165
    s_nop 0
    ds_write_b128 v15, v[32:35] offset:8192
    v_add_f32 v150, v150, v166
    v_add_f32 v151, v151, v167
    ds_write_b128 v15, v[36:39] offset:9216
    s_waitcnt lgkmcnt(3)
    v_add_f32 v152, v152, v168
    v_add_f32 v153, v153, v169
    ds_write_b128 v15, v[40:43] offset:10240
    v_add_f32 v154, v154, v170
    v_add_f32 v155, v155, v171
    ds_write_b128 v15, v[44:47] offset:11264
    s_waitcnt lgkmcnt(4)
    v_add_f32 v156, v156, v172
    v_add_f32 v157, v157, v173
    v_add_f32 v158, v158, v174
    v_add_f32 v159, v159, v175
    buffer_load_dwordx4 v[56:59], v10, s[16:19], s59 offen offset:2048 sc1
    buffer_load_dwordx4 v[60:63], v10, s[16:19], s60 offen offset:0 sc1
    buffer_load_dwordx4 v[64:67], v10, s[16:19], s60 offen offset:1024 sc1
    buffer_load_dwordx4 v[68:71], v10, s[16:19], s60 offen offset:2048 sc1
    v_pk_add_f32 v[16:17], v[16:17], v[144:145]
    v_pk_add_f32 v[18:19], v[18:19], v[146:147]
    v_pk_add_f32 v[20:21], v[20:21], v[148:149]
    v_pk_add_f32 v[22:23], v[22:23], v[150:151]
    v_pk_add_f32 v[24:25], v[24:25], v[152:153]
    v_pk_add_f32 v[26:27], v[26:27], v[154:155]
    v_pk_add_f32 v[28:29], v[28:29], v[156:157]
    v_pk_add_f32 v[30:31], v[30:31], v[158:159]
    s_waitcnt lgkmcnt(0)
    s_barrier
    ds_read_b128 v[80:83], v234 offset:8192
    ds_read_b128 v[84:87], v234 offset:9216
    ds_read_b128 v[88:91], v234 offset:10240
    ds_read_b128 v[92:95], v234 offset:11264
    s_waitcnt lgkmcnt(3)
    v_pk_add_f32 v[16:17], v[16:17], v[80:81]
    v_cvt_pk_bf16_f32 v96, v16, v17
    v_pk_add_f32 v[18:19], v[18:19], v[82:83]
    v_cvt_pk_bf16_f32 v97, v18, v19
    s_waitcnt lgkmcnt(2)
    v_pk_add_f32 v[20:21], v[20:21], v[84:85]
    v_cvt_pk_bf16_f32 v98, v20, v21
    v_pk_add_f32 v[22:23], v[22:23], v[86:87]
    v_cvt_pk_bf16_f32 v99, v22, v23
    s_waitcnt lgkmcnt(1)
    v_pk_add_f32 v[24:25], v[24:25], v[88:89]
    v_cvt_pk_bf16_f32 v100, v24, v25
    v_pk_add_f32 v[26:27], v[26:27], v[90:91]
    v_cvt_pk_bf16_f32 v101, v26, v27
    s_waitcnt lgkmcnt(0)
    v_pk_add_f32 v[28:29], v[28:29], v[92:93]
    v_cvt_pk_bf16_f32 v102, v28, v29
    v_pk_add_f32 v[30:31], v[30:31], v[94:95]
    v_cvt_pk_bf16_f32 v103, v30, v31
    v_dot2_f32_bf16 v8, v96, v240, v8
    v_dot2_f32_bf16 v9, v96, v96, v9
    v_dot2_f32_bf16 v8, v97, v240, v8
    v_dot2_f32_bf16 v9, v97, v97, v9
    v_dot2_f32_bf16 v8, v98, v240, v8
    v_dot2_f32_bf16 v9, v98, v98, v9
    v_dot2_f32_bf16 v8, v99, v240, v8
    v_dot2_f32_bf16 v9, v99, v99, v9
    v_dot2_f32_bf16 v8, v100, v240, v8
    v_dot2_f32_bf16 v9, v100, v100, v9
    v_dot2_f32_bf16 v8, v101, v240, v8
    v_dot2_f32_bf16 v9, v101, v101, v9
    v_dot2_f32_bf16 v8, v102, v240, v8
    v_dot2_f32_bf16 v9, v102, v102, v9
    v_dot2_f32_bf16 v8, v103, v240, v8
    v_dot2_f32_bf16 v9, v103, v103, v9
    v_permlane16_swap_b32 v96, v98
    v_permlane16_swap_b32 v97, v99
    v_permlane16_swap_b32 v100, v102
    v_permlane32_swap_b32 v8, v9
    v_add_f32 v8, v8, v9
    buffer_atomic_add_f32 v8, v12, s[16:19], s58 offen
    v_permlane16_swap_b32 v101, v103
    buffer_store_dwordx4 v[96:99], v235, s[16:19], s56 offen sc1
    buffer_store_dwordx4 v[100:103], v235, s[16:19], s57 offen sc1
    s_mul_i32 s48, s28, 2816
    s_add_u32 s48, s48, 152576
    s_add_u32 s49, s48, 2812
    v_lshrrev_b32 v5, 1, v3
    v_lshlrev_b32 v5, 9, v5
    v_and_b32 v6, 1, v3
    v_lshl_add_u32 v5, v6, 4, v5
    v_lshl_add_u32 v5, v2, 5, v5
    v_add_u32 v10, s48, v5
    v_lshl_add_u32 v5, v2, 2, v3
    v_add_u32 v5, 256, v5
    v_lshlrev_b32 v6, 6, v3
    v_lshl_add_u32 v6, v2, 1, v6
    v_add_u32 v6, 256, v6
    v_cmp_gt_u32 vcc, 2, v3
    s_nop 1
    v_cndmask_b32 v5, v6, v5, vcc
    v_lshl_add_u32 v11, v5, 2, s48
    v_mov_b32 v6, 4
    v_mov_b32 v7, 8
    v_cndmask_b32 v6, v6, v7, vcc
    v_add_u32 v12, v11, v6
    v_lshl_add_u32 v13, v6, 5, v11
    v_add_u32 v14, v13, v6
    v_lshl_add_u32 v5, v3, 6, v2
    v_lshl_add_u32 v5, v5, 2, s48
    v_add_u32 v16, 2048, v5
    v_min_u32 v16, s49, v16
    v_add_u32 v17, 2112, v5
    v_min_u32 v17, s49, v17
    v_add_u32 v18, 2176, v5
    v_min_u32 v18, s49, v18
    v_add_u32 v19, 2240, v5
    v_min_u32 v19, s49, v19
    s_waitcnt vmcnt(5)
    v_pk_add_f32 v[48:49], v[48:49], v[60:61]
    v_pk_add_f32 v[50:51], v[50:51], v[62:63]
    s_waitcnt vmcnt(4)
    v_pk_add_f32 v[52:53], v[52:53], v[64:65]
    v_pk_add_f32 v[54:55], v[54:55], v[66:67]
    s_waitcnt vmcnt(3)
    v_pk_add_f32 v[56:57], v[56:57], v[68:69]
    v_pk_add_f32 v[58:59], v[58:59], v[70:71]
    v_mov_b32 v6, s39
    v_cmp_eq_u32 vcc, 0, v1
    s_nop 1
    v_cndmask_b32 v6, 0, v6, vcc
    v_add_f32 v48, v48, v6
    ds_write_b128 v10, v[48:51]
    ds_write_b32 v11, v52
    ds_write_b32 v16, v56
    ds_write_b32 v12, v53
    ds_write_b32 v17, v57
    ds_write_b32 v13, v54
    ds_write_b32 v18, v58
    ds_write_b32 v14, v55
    ds_write_b32 v19, v59
    s_mul_i32 s47, s28, 16640
    s_mul_i32 s48, s28, 2816
    s_add_u32 s48, s48, 152576
    s_add_u32 s49, s48, 0xfffef600
    v_mov_b32 v10, s49
    v_lshlrev_b32 v5, 3, v1
    v_sub_u32 v5, 2047, v5
    v_cvt_f32_u32 v6, v5
    v_lshl_add_u32 v9, v1, 4, s47
    v_lshl_add_u32 v11, v5, 2, s48
    s_add_u32 s49, s48, 512
    v_subrev_f32 v12, 0x44000000, v6
    v_subrev_f32 v13, 0x4400c000, v6
    v_cvt_pk_bf16_f32 v12, v12, v13
    v_mad_u32_u16 v64, v12, 4, v10
    v_mad_u32_u16 v65, v12, 4, v10 op_sel:[1,0,0,0]
    s_waitcnt lgkmcnt(0)
    ds_read_b32 v16, v64
    ds_read_b32 v17, v65
    v_subrev_f32 v12, 0x44010000, v6
    v_subrev_f32 v13, 0x44028000, v6
    v_cvt_pk_bf16_f32 v12, v12, v13
    v_mad_u32_u16 v66, v12, 4, v10
    v_mad_u32_u16 v67, v12, 4, v10 op_sel:[1,0,0,0]
    ds_read_b32 v18, v66
    ds_read_b32 v19, v67
    v_subrev_f32 v12, 0x44800000, v6
    v_subrev_f32 v13, 0x44804000, v6
    v_cvt_pk_bf16_f32 v12, v12, v13
    v_mad_u32_u16 v68, v12, 4, v10
    v_mad_u32_u16 v69, v12, 4, v10 op_sel:[1,0,0,0]
    ds_read_b32 v20, v68
    ds_read_b32 v21, v69
    v_subrev_f32 v12, 0x4480a000, v6
    v_subrev_f32 v13, 0x44812000, v6
    v_cvt_pk_bf16_f32 v12, v12, v13
    v_mad_u32_u16 v70, v12, 4, v10
    v_mad_u32_u16 v71, v12, 4, v10 op_sel:[1,0,0,0]
    ds_read_b32 v22, v70
    ds_read_b32 v23, v71
    v_subrev_f32 v12, 0x44814000, v6
    v_subrev_f32 v13, 0x44c00000, v6
    v_cvt_pk_bf16_f32 v12, v12, v13
    v_mad_u32_u16 v72, v12, 4, v10
    v_mad_u32_u16 v73, v12, 4, v10 op_sel:[1,0,0,0]
    v_subrev_u32 v14, 6144, v11
    v_med3_i32 v73, v73, v14, s49
    ds_read_b32 v24, v72
    ds_read_b32 v25, v73
    v_subrev_f32 v12, 0x44c02000, v6
    v_subrev_f32 v13, 0x44c04000, v6
    v_cvt_pk_bf16_f32 v12, v12, v13
    v_mad_u32_u16 v74, v12, 4, v10
    v_subrev_u32 v14, 6148, v11
    v_med3_i32 v74, v74, v14, s49
    v_mad_u32_u16 v75, v12, 4, v10 op_sel:[1,0,0,0]
    v_subrev_u32 v14, 6152, v11
    v_med3_i32 v75, v75, v14, s49
    ds_read_b32 v26, v74
    ds_read_b32 v27, v75
    v_subrev_f32 v12, 0x44c06000, v6
    v_subrev_f32 v13, 0x44c08000, v6
    v_cvt_pk_bf16_f32 v12, v12, v13
    v_mad_u32_u16 v76, v12, 4, v10
    v_subrev_u32 v14, 6156, v11
    v_med3_i32 v76, v76, v14, s49
    v_mad_u32_u16 v77, v12, 4, v10 op_sel:[1,0,0,0]
    v_subrev_u32 v14, 6160, v11
    v_med3_i32 v77, v77, v14, s49
    ds_read_b32 v28, v76
    ds_read_b32 v29, v77
    v_subrev_f32 v12, 0x44c0a000, v6
    v_subrev_f32 v13, 0x44c0c000, v6
    v_cvt_pk_bf16_f32 v12, v12, v13
    v_mad_u32_u16 v78, v12, 4, v10
    v_subrev_u32 v14, 6164, v11
    v_med3_i32 v78, v78, v14, s49
    v_mad_u32_u16 v79, v12, 4, v10 op_sel:[1,0,0,0]
    v_subrev_u32 v14, 6168, v11
    v_med3_i32 v79, v79, v14, s49
    ds_read_b32 v30, v78
    ds_read_b32 v31, v79
    v_subrev_f32 v12, 0x44c0e000, v6
    v_subrev_f32 v13, 0x44c10000, v6
    v_max_f32 v13, 0, v13
    v_cvt_pk_bf16_f32 v12, v12, v13
    v_mad_u32_u16 v80, v12, 4, v10
    v_subrev_u32 v14, 6172, v11
    v_med3_i32 v80, v80, v14, s49
    v_mad_u32_u16 v81, v12, 4, v10 op_sel:[1,0,0,0]
    v_subrev_u32 v14, 6176, v11
    v_med3_i32 v81, v81, v14, s49
    ds_read_b32 v32, v80
    ds_read_b32 v33, v81
    v_subrev_f32 v12, 0x44c12000, v6
    v_max_f32 v12, 0, v12
    v_subrev_f32 v13, 0x44c14000, v6
    v_max_f32 v13, 0, v13
    v_cvt_pk_bf16_f32 v12, v12, v13
    v_mad_u32_u16 v82, v12, 4, v10
    v_subrev_u32 v14, 6180, v11
    v_med3_i32 v82, v82, v14, s49
    v_mad_u32_u16 v83, v12, 4, v10 op_sel:[1,0,0,0]
    v_subrev_u32 v14, 6184, v11
    v_med3_i32 v83, v83, v14, s49
    ds_read_b32 v34, v82
    ds_read_b32 v35, v83
    v_mov_b32 v12, 0
    v_mov_b32 v13, 0
    v_mov_b32 v14, 0
    v_mov_b32 v15, 0
    v_lshrrev_b32 v5, 2, v2
    v_mul_u32_u24 v5, 4160, v5
    v_and_b32 v6, 3, v2
    v_lshl_add_u32 v5, v6, 4, v5
    v_add_u32 v5, s47, v5
    ds_write_b128 v5, v[12:15] offset:4096
    s_and_b32 s40, s2, 15
    s_lshl_b32 s40, s40, 8
    s_add_u32 s40, s40, 0x00f1b000
    v_mov_b32 v236, 0
    v_cmp_eq_u32 vcc, 0, v0
    s_nop 1
    v_cndmask_b32 v232, v4, v236, vcc
    v_mov_b32 v236, 1
    s_waitcnt vmcnt(0) lgkmcnt(0)
    s_barrier
    buffer_atomic_add v236, v232, s[16:19], s40 offen sc1
    v_cmp_eq_u32 vcc, 63, v1
    s_nop 1
    v_cndmask_b32 v16, v12, v16, vcc
    v_cndmask_b32 v17, v12, v17, vcc
    v_cmp_le_u32 vcc, 62, v1
    s_nop 1
    v_cndmask_b32 v18, v12, v18, vcc
    v_cndmask_b32 v19, v12, v19, vcc
    v_cvt_pk_bf16_f32 v112, v16, v16
    v_cvt_pk_bf16_f32 v113, v16, v17
    v_cvt_pk_bf16_f32 v114, v18, v18
    v_cvt_pk_bf16_f32 v115, v18, v18
    v_cvt_pk_bf16_f32 v116, v16, v16
    v_cvt_pk_bf16_f32 v117, v17, v18
    ds_write_b128 v9, v[112:115] offset:1024
    v_cvt_pk_bf16_f32 v118, v18, v18
    v_cvt_pk_bf16_f32 v119, v18, v18
    v_cvt_pk_bf16_f32 v120, v16, v17
    v_cvt_pk_bf16_f32 v121, v18, v18
    ds_write_b128 v9, v[116:119] offset:5184
    v_cvt_pk_bf16_f32 v122, v18, v18
    v_cvt_pk_bf16_f32 v123, v18, v18
    v_cvt_pk_bf16_f32 v124, v17, v18
    v_cvt_pk_bf16_f32 v125, v18, v18
    ds_write_b128 v9, v[120:123] offset:9344
    v_cvt_pk_bf16_f32 v126, v18, v18
    v_cvt_pk_bf16_f32 v127, v18, v19
    v_cvt_pk_bf16_f32 v112, v20, v20
    v_cvt_pk_bf16_f32 v113, v21, v21
    ds_write_b128 v9, v[124:127] offset:13504
    v_cvt_pk_bf16_f32 v114, v21, v22
    v_cvt_pk_bf16_f32 v115, v22, v22
    v_cvt_pk_bf16_f32 v116, v20, v21
    v_cvt_pk_bf16_f32 v117, v21, v21
    ds_write_b128 v9, v[112:115] offset:2048
    v_cvt_pk_bf16_f32 v118, v22, v22
    v_cvt_pk_bf16_f32 v119, v22, v22
    v_cvt_pk_bf16_f32 v120, v21, v21
    v_cvt_pk_bf16_f32 v121, v21, v22
    ds_write_b128 v9, v[116:119] offset:6208
    v_cvt_pk_bf16_f32 v122, v22, v22
    v_cvt_pk_bf16_f32 v123, v22, v23
    v_cvt_pk_bf16_f32 v124, v21, v21
    v_cvt_pk_bf16_f32 v125, v22, v22
    ds_write_b128 v9, v[120:123] offset:10368
    v_cvt_pk_bf16_f32 v126, v22, v22
    v_cvt_pk_bf16_f32 v127, v23, v24
    v_cmp_eq_u32 vcc, 63, v1
    s_nop 1
    v_cndmask_b32 v33, v33, v12, vcc
    v_cndmask_b32 v34, v34, v12, vcc
    v_cndmask_b32 v35, v35, v12, vcc
    v_cvt_pk_bf16_f32 v112, v25, v26
    v_cvt_pk_bf16_f32 v113, v27, v28
    ds_write_b128 v9, v[124:127] offset:14528
    v_cvt_pk_bf16_f32 v114, v29, v30
    v_cvt_pk_bf16_f32 v115, v31, v32
    v_cvt_pk_bf16_f32 v116, v26, v27
    v_cvt_pk_bf16_f32 v117, v28, v29
    ds_write_b128 v9, v[112:115] offset:3072
    v_cvt_pk_bf16_f32 v118, v30, v31
    v_cvt_pk_bf16_f32 v119, v32, v33
    v_cvt_pk_bf16_f32 v120, v27, v28
    v_cvt_pk_bf16_f32 v121, v29, v30
    ds_write_b128 v9, v[116:119] offset:7232
    v_cvt_pk_bf16_f32 v122, v31, v32
    v_cvt_pk_bf16_f32 v123, v33, v34
    v_cvt_pk_bf16_f32 v124, v28, v29
    v_cvt_pk_bf16_f32 v125, v30, v31
    ds_write_b128 v9, v[120:123] offset:11392
    v_cvt_pk_bf16_f32 v126, v32, v33
    v_cvt_pk_bf16_f32 v127, v34, v35
    ds_write_b128 v9, v[124:127] offset:15552
    s_mul_i32 s64, s28, 16640
    v_sub_u32 v5, 15, v2
    v_and_b32 v6, 3, v5
    v_sub_u32 v5, v5, v6
    v_lshl_add_u32 v5, v3, 3, v5
    v_lshlrev_b32 v5, 1, v5
    v_mul_u32_u24 v6, 4160, v6
    v_add3_u32 v13, v5, v6, s64
    v_lshl_add_u32 v8, v1, 4, s64
    s_lshr_b32 s56, s28, 1
    s_cmp_eq_u32 s56, s34
    s_cselect_b32 s57, 0, 1
    s_lshl_b32 s56, s57, 12
    v_lshl_add_u32 v10, v0, 4, s56
    v_xor_b32 v233, 0x1000, v10
    s_lshl_b32 s48, s33, 14
    s_add_u32 s49, s48, 0x00400000
    s_add_u32 s51, s49, 8192
    s_mul_i32 s50, s28, 4608
    s_add_u32 s50, s50, 66560
    v_lshlrev_b32 v5, 5, v2
    v_lshl_add_u32 v5, v3, 4, v5
    v_add3_u32 v14, v5, 32, s50
    v_lshrrev_b32 v15, 2, v10
    v_add_u32 v15, 67072, v15
    v_lshrrev_b32 v234, 2, v233
    v_add_u32 v234, 67072, v234
    v_mov_b32 v6, 0
    v_mov_b32 v7, 0
    v_lshl_add_u32 v5, v1, 3, s50
    ds_write_b64 v5, v[6:7]
    s_mov_b32 s52, 0x3b000000
    s_mov_b32 s53, s52
    s_mov_b32 s54, 0x3727c5ac
    s_mov_b32 s55, s54
    s_mov_b32 s60, 0x00f12000
    s_mov_b32 s61, 0x00f14000
    s_mul_i32 s56, s28, 4608
    s_add_u32 s56, s56, 84992
    v_lshrrev_b32 v5, 1, v2
    v_add_u32 v5, v5, v3
    v_lshlrev_b32 v5, 4, v5
    v_lshl_add_u32 v5, v2, 6, v5
    v_add_u32 v11, s56, v5
    v_and_b32 v5, 127, v0
    v_lshrrev_b32 v6, 4, v5
    v_lshlrev_b32 v6, 4, v6
    v_lshl_add_u32 v5, v5, 3, v6
    s_mul_i32 s56, s57, 1152
    s_add_u32 s56, s56, 84992
    v_add_u32 v12, s56, v5
    v_mov_b32 v9, v10
    s_add_u32 s58, s48, 0x00800000
    s_add_u32 s59, s58, 8192
    v_add_u32 v5, 4, v2
    v_mov_b32 v6, 511
    v_lshlrev_b32 v5, v5, v6
    v_lshlrev_b32 v6, 3, v3
    v_lshrrev_b32 v5, v6, v5
    v_bfe_u32 v6, v5, 0, 1
    v_bfe_u32 v7, v5, 1, 1
    v_lshl_or_b32 v6, v7, 16, v6
    v_mul_u32_u24 v104, 0x3f80, v6
    v_bfe_u32 v6, v5, 2, 1
    v_bfe_u32 v7, v5, 3, 1
    v_lshl_or_b32 v6, v7, 16, v6
    v_mul_u32_u24 v105, 0x3f80, v6
    v_bfe_u32 v6, v5, 4, 1
    v_bfe_u32 v7, v5, 5, 1
    v_lshl_or_b32 v6, v7, 16, v6
    v_mul_u32_u24 v106, 0x3f80, v6
    v_bfe_u32 v6, v5, 6, 1
    v_bfe_u32 v7, v5, 7, 1
    v_lshl_or_b32 v6, v7, 16, v6
    v_mul_u32_u24 v107, 0x3f80, v6
    v_add_u32 v5, 5, v2
    v_mov_b32 v6, 127
    v_lshlrev_b32 v5, v5, v6
    v_lshlrev_b32 v6, 3, v3
    v_lshrrev_b32 v5, v6, v5
    v_bfe_u32 v6, v5, 0, 1
    v_bfe_u32 v7, v5, 1, 1
    v_lshl_or_b32 v6, v7, 16, v6
    v_mul_u32_u24 v108, 0x3f80, v6
    v_bfe_u32 v6, v5, 2, 1
    v_bfe_u32 v7, v5, 3, 1
    v_lshl_or_b32 v6, v7, 16, v6
    v_mul_u32_u24 v109, 0x3f80, v6
    v_bfe_u32 v6, v5, 4, 1
    v_bfe_u32 v7, v5, 5, 1
    v_lshl_or_b32 v6, v7, 16, v6
    v_mul_u32_u24 v110, 0x3f80, v6
    v_bfe_u32 v6, v5, 6, 1
    v_bfe_u32 v7, v5, 7, 1
    v_lshl_or_b32 v6, v7, 16, v6
    v_mul_u32_u24 v111, 0x3f80, v6
    s_cmp_lg_u32 s28, 0
    s_cbranch_scc1 L_gw1_done
    v_mov_b32 v232, 0
    s_mov_b32 s46, 0x80000
    s_cmp_lg_u32 s43, 0
    s_cbranch_scc1 L_gw1_poll
    s_mov_b32 s45, 0x00f1b000
    v_lshlrev_b32 v237, 8, v1
    v_cmp_gt_u32 vcc, 16, v1
    s_nop 1
    v_cndmask_b32 v237, v4, v237, vcc
L_gw1_mp:
    v_mov_b32 v236, 0
    buffer_atomic_add v236, v237, s[16:19], s45 offen sc0 sc1
    s_waitcnt vmcnt(0)
    v_cmp_gt_u32 vcc, 32, v236
    s_sub_u32 s46, s46, 1
    s_cbranch_scc1 L_gw1_done
    s_and_b32 s40, vcc_lo, 0xffff
    s_cbranch_scc1 L_gw1_mp
    v_mov_b32 v237, 2
    buffer_store_dword v237, v232, s[16:19], s42 offen
    s_branch L_gw1_done
L_gw1_poll:
    buffer_load_dword v236, v232, s[16:19], s42 offen sc1
    s_waitcnt vmcnt(0)
    v_readfirstlane_b32 s45, v236
    s_sub_u32 s46, s46, 1
    s_cbranch_scc1 L_gw1_done
    s_cmp_lt_u32 s45, 2
    s_cbranch_scc1 L_gw1_poll
L_gw1_done:
    s_waitcnt lgkmcnt(0)
    s_barrier
    buffer_load_dwordx4 v[16:19], v10, s[16:19], s60 offen sc1
    buffer_load_dwordx4 v[32:35], v10, s[16:19], s49 offen sc1
    buffer_load_dwordx4 v[20:23], v233, s[16:19], s60 offen sc1
    buffer_load_dwordx4 v[36:39], v233, s[16:19], s49 offen sc1
    buffer_load_dwordx4 v[24:27], v10, s[16:19], s61 offen sc1
    buffer_load_dwordx4 v[40:43], v10, s[16:19], s51 offen sc1
    buffer_load_dwordx4 v[28:31], v233, s[16:19], s61 offen sc1
    buffer_load_dwordx4 v[44:47], v233, s[16:19], s51 offen sc1
    s_mul_i32 s44, s28, 2816
    s_add_u32 s44, s44, 154608
    v_lshlrev_b32 v5, 2, v3
    v_sub_u32 v5, v2, v5
    v_lshl_add_u32 v6, v5, 3, s44
    v_mov_b32 v7, 0
    ds_read_b64 v[200:201], v6 offset:24
    ds_read_b64 v[202:203], v6 offset:16
    ds_read_b64 v[204:205], v6 offset:8
    ds_read_b64 v[206:207], v6 offset:0
    ds_read_b64 v[208:209], v6 offset:152
    ds_read_b64 v[210:211], v6 offset:144
    ds_read_b64 v[212:213], v6 offset:136
    ds_read_b64 v[214:215], v6 offset:128
    ds_read_b64 v[216:217], v6 offset:280
    ds_read_b64 v[218:219], v6 offset:272
    ds_read_b64 v[220:221], v6 offset:264
    ds_read_b64 v[222:223], v6 offset:256
    ds_read_b64 v[224:225], v6 offset:408
    ds_read_b64 v[226:227], v6 offset:400
    ds_read_b64 v[228:229], v6 offset:392
    ds_read_b64 v[230:231], v6 offset:384
    s_waitcnt lgkmcnt(15)
    v_cvt_pk_bf16_f32 v200, v200, v201
    v_cmp_le_i32 vcc, 0, v5
    s_nop 1
    v_cndmask_b32 v200, v7, v200, vcc
    s_waitcnt lgkmcnt(14)
    v_cvt_pk_bf16_f32 v201, v202, v203
    v_cmp_le_i32 vcc, 1, v5
    s_nop 1
    v_cndmask_b32 v201, v7, v201, vcc
    s_waitcnt lgkmcnt(13)
    v_cvt_pk_bf16_f32 v202, v204, v205
    v_cmp_le_i32 vcc, 2, v5
    s_nop 1
    v_cndmask_b32 v202, v7, v202, vcc
    s_waitcnt lgkmcnt(12)
    v_cvt_pk_bf16_f32 v203, v206, v207
    v_cmp_le_i32 vcc, 3, v5
    s_nop 1
    v_cndmask_b32 v203, v7, v203, vcc
    ds_write_b128 v8, v[200:203] offset:0
    s_waitcnt lgkmcnt(12)
    v_cvt_pk_bf16_f32 v208, v208, v209
    s_waitcnt lgkmcnt(11)
    v_cvt_pk_bf16_f32 v209, v210, v211
    s_waitcnt lgkmcnt(10)
    v_cvt_pk_bf16_f32 v210, v212, v213
    s_waitcnt lgkmcnt(9)
    v_cvt_pk_bf16_f32 v211, v214, v215
    ds_write_b128 v8, v[208:211] offset:4160
    s_waitcnt lgkmcnt(9)
    v_cvt_pk_bf16_f32 v216, v216, v217
    s_waitcnt lgkmcnt(8)
    v_cvt_pk_bf16_f32 v217, v218, v219
    s_waitcnt lgkmcnt(7)
    v_cvt_pk_bf16_f32 v218, v220, v221
    s_waitcnt lgkmcnt(6)
    v_cvt_pk_bf16_f32 v219, v222, v223
    ds_write_b128 v8, v[216:219] offset:8320
    s_waitcnt lgkmcnt(6)
    v_cvt_pk_bf16_f32 v224, v224, v225
    s_waitcnt lgkmcnt(5)
    v_cvt_pk_bf16_f32 v225, v226, v227
    s_waitcnt lgkmcnt(4)
    v_cvt_pk_bf16_f32 v226, v228, v229
    s_waitcnt lgkmcnt(3)
    v_cvt_pk_bf16_f32 v227, v230, v231
    ds_write_b128 v8, v[224:227] offset:12480
    ds_read_b64 v[112:113], v13 offset:4032
    ds_read_b64 v[114:115], v13 offset:4040
    ds_read_b64 v[116:117], v13 offset:3520
    ds_read_b64 v[118:119], v13 offset:3528
    ds_read_b64 v[120:121], v13 offset:3008
    ds_read_b64 v[122:123], v13 offset:3016
    ds_read_b64 v[124:125], v13 offset:2496
    ds_read_b64 v[126:127], v13 offset:2504
    ds_read_b64 v[128:129], v13 offset:1984
    ds_read_b64 v[130:131], v13 offset:1992
    ds_read_b64 v[132:133], v13 offset:3968
    ds_read_b64 v[134:135], v13 offset:3976
    ds_read_b64 v[136:137], v13 offset:3456
    ds_read_b64 v[138:139], v13 offset:3464
    ds_read_b64 v[140:141], v13 offset:2944
    ds_read_b64 v[142:143], v13 offset:2952
    ds_read_b64 v[144:145], v13 offset:2432
    ds_read_b64 v[146:147], v13 offset:2440
    ds_read_b64 v[148:149], v13 offset:3904
    ds_read_b64 v[150:151], v13 offset:3912
    ds_read_b64 v[152:153], v13 offset:3392
    ds_read_b64 v[154:155], v13 offset:3400
    ds_read_b64 v[156:157], v13 offset:2880
    ds_read_b64 v[158:159], v13 offset:2888
    s_waitcnt vmcnt(7)
    v_pk_mul_f32 v[16:17], v[16:17], s[52:53]
    v_pk_mul_f32 v[18:19], v[18:19], s[52:53]
    v_pk_fma_f32 v[18:19], v[16:17], v[16:17], v[18:19] neg_lo:[1,0,0] neg_hi:[1,0,0]
    v_cvt_pk_bf16_f32 v17, v16, v17
    v_cvt_pk_bf16_f32 v19, v18, v19
    v_pk_max_i16 v19, v19, 0
    v_lshlrev_b32 v16, 16, v17
    v_and_b32 v17, 0xffff0000, v17
    v_lshlrev_b32 v18, 16, v19
    v_and_b32 v19, 0xffff0000, v19
    v_pk_add_f32 v[18:19], v[18:19], s[54:55]
    v_cvt_pk_bf16_f32 v19, v18, v19
    v_lshlrev_b32 v18, 16, v19
    v_and_b32 v19, 0xffff0000, v19
    v_sqrt_f32 v18, v18
    v_sqrt_f32 v19, v19
    s_waitcnt vmcnt(6)
    v_lshlrev_b32 v64, 16, v32
    v_cvt_pk_bf16_f32 v19, v18, v19
    v_lshlrev_b32 v18, 16, v19
    v_and_b32 v19, 0xffff0000, v19
    v_rcp_f32 v18, v18
    v_rcp_f32 v19, v19
    v_lshlrev_b32 v68, 16, v33
    v_lshlrev_b32 v65, 16, v34
    v_lshlrev_b32 v69, 16, v35
    v_and_b32 v66, 0xffff0000, v32
    v_and_b32 v70, 0xffff0000, v33
    v_and_b32 v67, 0xffff0000, v34
    v_and_b32 v71, 0xffff0000, v35
    v_pk_mul_f32 v[16:17], v[16:17], v[18:19] neg_lo:[1,0] neg_hi:[1,0]
    v_pk_fma_f32 v[80:81], v[64:65], v[18:19], v[16:17]
    v_pk_fma_f32 v[82:83], v[66:67], v[18:19], v[16:17]
    v_pk_fma_f32 v[84:85], v[68:69], v[18:19], v[16:17]
    v_pk_fma_f32 v[86:87], v[70:71], v[18:19], v[16:17]
    v_cvt_pk_bf16_f32 v88, v80, v81
    v_cvt_pk_bf16_f32 v89, v82, v83
    v_cvt_pk_bf16_f32 v90, v84, v85
    v_cvt_pk_bf16_f32 v91, v86, v87
    ds_write2st64_b32 v15, v88, v89 offset0:0 offset1:18
    ds_write2st64_b32 v15, v90, v91 offset0:36 offset1:54
    s_waitcnt vmcnt(5)
    v_pk_mul_f32 v[20:21], v[20:21], s[52:53]
    v_pk_mul_f32 v[22:23], v[22:23], s[52:53]
    v_pk_fma_f32 v[22:23], v[20:21], v[20:21], v[22:23] neg_lo:[1,0,0] neg_hi:[1,0,0]
    v_cvt_pk_bf16_f32 v21, v20, v21
    v_cvt_pk_bf16_f32 v23, v22, v23
    v_pk_max_i16 v23, v23, 0
    v_lshlrev_b32 v20, 16, v21
    v_and_b32 v21, 0xffff0000, v21
    v_lshlrev_b32 v22, 16, v23
    v_and_b32 v23, 0xffff0000, v23
    v_pk_add_f32 v[22:23], v[22:23], s[54:55]
    v_cvt_pk_bf16_f32 v23, v22, v23
    v_lshlrev_b32 v22, 16, v23
    v_and_b32 v23, 0xffff0000, v23
    v_sqrt_f32 v22, v22
    v_sqrt_f32 v23, v23
    s_waitcnt vmcnt(4)
    v_lshlrev_b32 v80, 16, v36
    v_cvt_pk_bf16_f32 v23, v22, v23
    v_lshlrev_b32 v22, 16, v23
    v_and_b32 v23, 0xffff0000, v23
    v_rcp_f32 v22, v22
    v_rcp_f32 v23, v23
    v_lshlrev_b32 v84, 16, v37
    v_lshlrev_b32 v81, 16, v38
    v_lshlrev_b32 v85, 16, v39
    v_and_b32 v82, 0xffff0000, v36
    v_and_b32 v86, 0xffff0000, v37
    v_and_b32 v83, 0xffff0000, v38
    v_and_b32 v87, 0xffff0000, v39
    v_pk_mul_f32 v[20:21], v[20:21], v[22:23] neg_lo:[1,0] neg_hi:[1,0]
    v_pk_fma_f32 v[80:81], v[80:81], v[22:23], v[20:21]
    v_pk_fma_f32 v[82:83], v[82:83], v[22:23], v[20:21]
    v_pk_fma_f32 v[84:85], v[84:85], v[22:23], v[20:21]
    v_pk_fma_f32 v[86:87], v[86:87], v[22:23], v[20:21]
    v_cvt_pk_bf16_f32 v88, v80, v81
    v_cvt_pk_bf16_f32 v89, v82, v83
    v_cvt_pk_bf16_f32 v90, v84, v85
    v_cvt_pk_bf16_f32 v91, v86, v87
    ds_write2st64_b32 v234, v88, v89 offset0:0 offset1:18
    ds_write2st64_b32 v234, v90, v91 offset0:36 offset1:54
    s_waitcnt vmcnt(3)
    v_pk_mul_f32 v[24:25], v[24:25], s[52:53]
    v_pk_mul_f32 v[26:27], v[26:27], s[52:53]
    v_pk_fma_f32 v[26:27], v[24:25], v[24:25], v[26:27] neg_lo:[1,0,0] neg_hi:[1,0,0]
    v_cvt_pk_bf16_f32 v25, v24, v25
    v_cvt_pk_bf16_f32 v27, v26, v27
    v_pk_max_i16 v27, v27, 0
    v_lshlrev_b32 v24, 16, v25
    v_and_b32 v25, 0xffff0000, v25
    v_lshlrev_b32 v26, 16, v27
    v_and_b32 v27, 0xffff0000, v27
    v_pk_add_f32 v[26:27], v[26:27], s[54:55]
    v_cvt_pk_bf16_f32 v27, v26, v27
    v_lshlrev_b32 v26, 16, v27
    v_and_b32 v27, 0xffff0000, v27
    v_sqrt_f32 v26, v26
    v_sqrt_f32 v27, v27
    s_waitcnt vmcnt(2)
    v_lshlrev_b32 v72, 16, v40
    v_cvt_pk_bf16_f32 v27, v26, v27
    v_lshlrev_b32 v26, 16, v27
    v_and_b32 v27, 0xffff0000, v27
    v_rcp_f32 v26, v26
    v_rcp_f32 v27, v27
    v_lshlrev_b32 v76, 16, v41
    v_lshlrev_b32 v73, 16, v42
    v_lshlrev_b32 v77, 16, v43
    v_and_b32 v74, 0xffff0000, v40
    v_and_b32 v78, 0xffff0000, v41
    v_and_b32 v75, 0xffff0000, v42
    v_and_b32 v79, 0xffff0000, v43
    v_pk_mul_f32 v[24:25], v[24:25], v[26:27] neg_lo:[1,0] neg_hi:[1,0]
    v_pk_fma_f32 v[80:81], v[72:73], v[26:27], v[24:25]
    v_pk_fma_f32 v[82:83], v[74:75], v[26:27], v[24:25]
    v_pk_fma_f32 v[84:85], v[76:77], v[26:27], v[24:25]
    v_pk_fma_f32 v[86:87], v[78:79], v[26:27], v[24:25]
    v_cvt_pk_bf16_f32 v88, v80, v81
    v_cvt_pk_bf16_f32 v89, v82, v83
    v_cvt_pk_bf16_f32 v90, v84, v85
    v_cvt_pk_bf16_f32 v91, v86, v87
    ds_write2st64_b32 v15, v88, v89 offset0:8 offset1:26
    ds_write2st64_b32 v15, v90, v91 offset0:44 offset1:62
    s_waitcnt vmcnt(1)
    v_pk_mul_f32 v[28:29], v[28:29], s[52:53]
    v_pk_mul_f32 v[30:31], v[30:31], s[52:53]
    v_pk_fma_f32 v[30:31], v[28:29], v[28:29], v[30:31] neg_lo:[1,0,0] neg_hi:[1,0,0]
    v_cvt_pk_bf16_f32 v29, v28, v29
    v_cvt_pk_bf16_f32 v31, v30, v31
    v_pk_max_i16 v31, v31, 0
    v_lshlrev_b32 v28, 16, v29
    v_and_b32 v29, 0xffff0000, v29
    v_lshlrev_b32 v30, 16, v31
    v_and_b32 v31, 0xffff0000, v31
    v_pk_add_f32 v[30:31], v[30:31], s[54:55]
    v_cvt_pk_bf16_f32 v31, v30, v31
    v_lshlrev_b32 v30, 16, v31
    v_and_b32 v31, 0xffff0000, v31
    v_sqrt_f32 v30, v30
    v_sqrt_f32 v31, v31
    s_waitcnt vmcnt(0)
    v_lshlrev_b32 v80, 16, v44
    v_cvt_pk_bf16_f32 v31, v30, v31
    v_lshlrev_b32 v30, 16, v31
    v_and_b32 v31, 0xffff0000, v31
    v_rcp_f32 v30, v30
    v_rcp_f32 v31, v31
    v_lshlrev_b32 v84, 16, v45
    v_lshlrev_b32 v81, 16, v46
    v_lshlrev_b32 v85, 16, v47
    v_and_b32 v82, 0xffff0000, v44
    v_and_b32 v86, 0xffff0000, v45
    v_and_b32 v83, 0xffff0000, v46
    v_and_b32 v87, 0xffff0000, v47
    v_pk_mul_f32 v[28:29], v[28:29], v[30:31] neg_lo:[1,0] neg_hi:[1,0]
    v_pk_fma_f32 v[80:81], v[80:81], v[30:31], v[28:29]
    v_pk_fma_f32 v[82:83], v[82:83], v[30:31], v[28:29]
    v_pk_fma_f32 v[84:85], v[84:85], v[30:31], v[28:29]
    v_pk_fma_f32 v[86:87], v[86:87], v[30:31], v[28:29]
    v_cvt_pk_bf16_f32 v88, v80, v81
    v_cvt_pk_bf16_f32 v89, v82, v83
    v_cvt_pk_bf16_f32 v90, v84, v85
    v_cvt_pk_bf16_f32 v91, v86, v87
    ds_write2st64_b32 v234, v88, v89 offset0:8 offset1:26
    ds_write2st64_b32 v234, v90, v91 offset0:44 offset1:62
    s_waitcnt lgkmcnt(0)
    s_barrier
    s_cmp_lg_u32 s34, 0
    s_cbranch_scc1 L_c0_p1
    ds_read_b128 v[160:163], v14 offset:448
    ds_read_b128 v[164:167], v14 offset:1984
    ds_read_b128 v[168:171], v14 offset:2496
    ds_read_b128 v[172:175], v14 offset:4032
    s_waitcnt lgkmcnt(3)
    v_mfma_f32_16x16x32_bf16 v[48:51], v[112:115], v[160:163], 0
    ds_read_b128 v[176:179], v14 offset:1472
    s_waitcnt lgkmcnt(3)
    v_mfma_f32_16x16x32_bf16 v[52:55], v[112:115], v[164:167], 0
    ds_read_b128 v[180:183], v14 offset:3520
    s_waitcnt lgkmcnt(3)
    v_mfma_f32_16x16x32_bf16 v[56:59], v[112:115], v[168:171], 0
    ds_read_b128 v[184:187], v14 offset:960
    s_waitcnt lgkmcnt(3)
    v_mfma_f32_16x16x32_bf16 v[60:63], v[112:115], v[172:175], 0
    ds_read_b128 v[188:191], v14 offset:3008
    s_waitcnt lgkmcnt(3)
    v_mfma_f32_16x16x32_bf16 v[52:55], v[116:119], v[176:179], v[52:55]
    ds_read_b128 v[192:195], v14 offset:384
    v_mfma_f32_16x16x32_bf16 v[56:59], v[116:119], v[164:167], v[56:59]
    ds_read_b128 v[196:199], v14 offset:1920
    s_waitcnt lgkmcnt(4)
    v_mfma_f32_16x16x32_bf16 v[60:63], v[116:119], v[180:183], v[60:63]
    ds_read_b128 v[200:203], v14 offset:2432
    s_waitcnt lgkmcnt(4)
    v_mfma_f32_16x16x32_bf16 v[52:55], v[120:123], v[184:187], v[52:55]
    ds_read_b128 v[204:207], v14 offset:3968
    v_mfma_f32_16x16x32_bf16 v[56:59], v[120:123], v[176:179], v[56:59]
    ds_read_b128 v[208:211], v14 offset:1408
    s_waitcnt lgkmcnt(5)
    v_mfma_f32_16x16x32_bf16 v[60:63], v[120:123], v[188:191], v[60:63]
    ds_read_b128 v[212:215], v14 offset:3456
    v_mfma_f32_16x16x32_bf16 v[52:55], v[124:127], v[160:163], v[52:55]
    ds_read_b128 v[216:219], v14 offset:896
    v_mfma_f32_16x16x32_bf16 v[56:59], v[124:127], v[184:187], v[56:59]
    ds_read_b128 v[220:223], v14 offset:2944
    v_mfma_f32_16x16x32_bf16 v[60:63], v[124:127], v[168:171], v[60:63]
    ds_read_b128 v[224:227], v14 offset:320
    v_mfma_f32_16x16x32_bf16 v[56:59], v[128:131], v[160:163], v[56:59]
    ds_read_b128 v[228:231], v14 offset:1856
    v_mfma_f32_16x16x32_bf16 v[60:63], v[128:131], v[164:167], v[60:63]
    ds_read_b128 v[16:19], v14 offset:2368
    s_waitcnt lgkmcnt(6)
    v_mfma_f32_16x16x32_bf16 v[48:51], v[132:135], v[192:195], v[48:51]
    ds_read_b128 v[20:23], v14 offset:3904
    v_mfma_f32_16x16x32_bf16 v[52:55], v[132:135], v[196:199], v[52:55]
    ds_read_b128 v[24:27], v14 offset:1344
    v_mfma_f32_16x16x32_bf16 v[56:59], v[132:135], v[200:203], v[56:59]
    ds_read_b128 v[28:31], v14 offset:3392
    v_mfma_f32_16x16x32_bf16 v[60:63], v[132:135], v[204:207], v[60:63]
    ds_read_b128 v[32:35], v14 offset:832
    v_mfma_f32_16x16x32_bf16 v[52:55], v[136:139], v[208:211], v[52:55]
    ds_read_b128 v[36:39], v14 offset:2880
    v_mfma_f32_16x16x32_bf16 v[56:59], v[136:139], v[196:199], v[56:59]
    ds_read_b64 v[40:41], v13 offset:2368
    ds_read_b64 v[42:43], v13 offset:2376
    s_waitcnt lgkmcnt(7)
    v_mfma_f32_16x16x32_bf16 v[60:63], v[136:139], v[212:215], v[60:63]
    ds_read_b64 v[44:45], v13 offset:3840
    ds_read_b64 v[46:47], v13 offset:3848
    v_mfma_f32_16x16x32_bf16 v[52:55], v[140:143], v[216:219], v[52:55]
    ds_read_b128 v[112:115], v14 offset:256
    v_mfma_f32_16x16x32_bf16 v[56:59], v[140:143], v[208:211], v[56:59]
    ds_read_b128 v[172:175], v14 offset:1792
    v_mfma_f32_16x16x32_bf16 v[60:63], v[140:143], v[220:223], v[60:63]
    ds_read_b128 v[116:119], v14 offset:2304
    v_mfma_f32_16x16x32_bf16 v[52:55], v[144:147], v[192:195], v[52:55]
    ds_read_b128 v[180:183], v14 offset:3840
    v_mfma_f32_16x16x32_bf16 v[56:59], v[144:147], v[216:219], v[56:59]
    ds_read_b64 v[176:177], v13 offset:3328
    ds_read_b64 v[178:179], v13 offset:3336
    v_mfma_f32_16x16x32_bf16 v[60:63], v[144:147], v[200:203], v[60:63]
    ds_read_b128 v[120:123], v14 offset:1280
    v_mfma_f32_16x16x32_bf16 v[48:51], v[148:151], v[224:227], v[48:51]
    ds_read_b128 v[188:191], v14 offset:3328
    v_mfma_f32_16x16x32_bf16 v[52:55], v[148:151], v[228:231], v[52:55]
    ds_read_b64 v[184:185], v13 offset:2816
    ds_read_b64 v[186:187], v13 offset:2824
    v_mfma_f32_16x16x32_bf16 v[56:59], v[148:151], v[16:19], v[56:59]
    ds_read_b128 v[124:127], v14 offset:768
    s_waitcnt lgkmcnt(8)
    v_mfma_f32_16x16x32_bf16 v[60:63], v[148:151], v[20:23], v[60:63]
    ds_read_b128 v[168:171], v14 offset:432
    v_mfma_f32_16x16x32_bf16 v[52:55], v[152:155], v[24:27], v[52:55]
    ds_read_b128 v[160:163], v14 offset:416
    v_mfma_f32_16x16x32_bf16 v[56:59], v[152:155], v[228:231], v[56:59]
    ds_read_b128 v[128:131], v14 offset:2816
    v_mfma_f32_16x16x32_bf16 v[60:63], v[152:155], v[28:31], v[60:63]
    ds_read_b64 v[164:165], v13 offset:2304
    ds_read_b64 v[166:167], v13 offset:2312
    v_mfma_f32_16x16x32_bf16 v[52:55], v[156:159], v[32:35], v[52:55]
    ds_read_b128 v[132:135], v14 offset:944
    v_mfma_f32_16x16x32_bf16 v[56:59], v[156:159], v[24:27], v[56:59]
    ds_read_b128 v[204:207], v14 offset:928
    v_mfma_f32_16x16x32_bf16 v[60:63], v[156:159], v[36:39], v[60:63]
    ds_read_b64 v[196:197], v13 offset:3776
    ds_read_b64 v[198:199], v13 offset:3784
    v_mfma_f32_16x16x32_bf16 v[52:55], v[40:43], v[224:227], v[52:55]
    ds_read_b128 v[136:139], v14 offset:192
    v_mfma_f32_16x16x32_bf16 v[56:59], v[40:43], v[32:35], v[56:59]
    ds_read_b128 v[212:215], v14 offset:1728
    v_mfma_f32_16x16x32_bf16 v[60:63], v[40:43], v[16:19], v[60:63]
    ds_read_b128 v[208:211], v14 offset:2240
    v_mfma_f32_16x16x32_bf16 v[48:51], v[44:47], v[112:115], v[48:51]
    ds_read_b128 v[140:143], v14 offset:3776
    v_mfma_f32_16x16x32_bf16 v[52:55], v[44:47], v[172:175], v[52:55]
    ds_read_b128 v[220:223], v14 offset:1456
    v_mfma_f32_16x16x32_bf16 v[56:59], v[44:47], v[116:119], v[56:59]
    ds_read_b128 v[192:195], v14 offset:1440
    s_waitcnt lgkmcnt(6)
    v_mfma_f32_16x16x32_bf16 v[60:63], v[44:47], v[180:183], v[60:63]
    ds_read_b64 v[216:217], v13 offset:3264
    ds_read_b64 v[218:219], v13 offset:3272
    v_mfma_f32_16x16x32_bf16 v[52:55], v[176:179], v[120:123], v[52:55]
    ds_read_b128 v[144:147], v14 offset:1216
    v_mfma_f32_16x16x32_bf16 v[56:59], v[176:179], v[172:175], v[56:59]
    ds_read_b128 v[200:203], v14 offset:3264
    v_mfma_f32_16x16x32_bf16 v[60:63], v[176:179], v[188:191], v[60:63]
    ds_read_b64 v[148:149], v13 offset:2752
    ds_read_b64 v[150:151], v13 offset:2760
    v_mfma_f32_16x16x32_bf16 v[52:55], v[184:187], v[124:127], v[52:55]
    ds_read_b128 v[20:23], v14 offset:704
    v_mfma_f32_16x16x32_bf16 v[56:59], v[184:187], v[120:123], v[56:59]
    ds_read_b128 v[228:231], v14 offset:1968
    v_mfma_f32_16x16x32_bf16 v[80:83], v[168:171], v[104:107], 0
    ds_read_b128 v[152:155], v14 offset:1952
    v_mfma_f32_16x16x32_bf16 v[84:87], v[160:163], v[108:111], 0
    ds_read_b128 v[24:27], v14 offset:2752
    v_mfma_f32_16x16x32_bf16 v[60:63], v[184:187], v[128:131], v[60:63]
    ds_read_b64 v[156:157], v13 offset:2240
    ds_read_b64 v[158:159], v13 offset:2248
    v_mfma_f32_16x16x32_bf16 v[52:55], v[164:167], v[112:115], v[52:55]
    ds_read_b64 v[36:37], v13 offset:3712
    ds_read_b64 v[38:39], v13 offset:3720
    v_mfma_f32_16x16x32_bf16 v[56:59], v[164:167], v[124:127], v[56:59]
    v_cvt_pk_bf16_f32 v28, v80, v84
    v_cvt_pk_bf16_f32 v29, v81, v85
    ds_read_b128 v[224:227], v14 offset:128
    v_mfma_f32_16x16x32_bf16 v[60:63], v[164:167], v[116:119], v[60:63]
    v_cvt_pk_bf16_f32 v30, v82, v86
    v_cvt_pk_bf16_f32 v31, v83, v87
    ds_read_b128 v[32:35], v14 offset:1664
    v_mfma_f32_16x16x32_bf16 v[80:83], v[132:135], v[104:107], 0
    ds_read_b128 v[40:43], v14 offset:2176
    v_mfma_f32_16x16x32_bf16 v[84:87], v[204:207], v[108:111], 0
    ds_read_b128 v[44:47], v14 offset:3712
    s_waitcnt lgkmcnt(8)
    v_mfma_f32_16x16x32_bf16 v[48:51], v[196:199], v[136:139], v[48:51]
    ds_read_b64 v[180:181], v13 offset:3200
    ds_read_b64 v[182:183], v13 offset:3208
    v_mfma_f32_16x16x32_bf16 v[52:55], v[196:199], v[212:215], v[52:55]
    ds_read_b128 v[172:175], v14 offset:1152
    v_mfma_f32_16x16x32_bf16 v[56:59], v[196:199], v[208:211], v[56:59]
    v_cvt_pk_bf16_f32 v16, v80, v84
    v_cvt_pk_bf16_f32 v17, v81, v85
    ds_read_b128 v[176:179], v8 offset:0
    v_mfma_f32_16x16x32_bf16 v[60:63], v[196:199], v[140:143], v[60:63]
    v_cvt_pk_bf16_f32 v18, v82, v86
    v_cvt_pk_bf16_f32 v19, v83, v87
    ds_read_b128 v[188:191], v8 offset:12480
    v_mfma_f32_16x16x32_bf16 v[80:83], v[220:223], v[104:107], 0
    ds_read_b128 v[120:123], v14 offset:3200
    v_mfma_f32_16x16x32_bf16 v[84:87], v[192:195], v[108:111], 0
    ds_read_b128 v[160:163], v8 offset:8320
    v_mfma_f32_16x16x32_bf16 v[52:55], v[216:219], v[144:147], v[52:55]
    ds_read_b64 v[184:185], v13 offset:2688
    ds_read_b64 v[186:187], v13 offset:2696
    v_mfma_f32_16x16x32_bf16 v[56:59], v[216:219], v[212:215], v[56:59]
    ds_read_b128 v[128:131], v14 offset:640
    v_mfma_f32_16x16x32_bf16 v[60:63], v[216:219], v[200:203], v[60:63]
    s_nop 0
    v_cvt_pk_bf16_f32 v168, v80, v84
    v_cvt_pk_bf16_f32 v169, v81, v85
    ds_read_b128 v[112:115], v8 offset:4160
    v_mfma_f32_16x16x32_bf16 v[52:55], v[148:151], v[20:23], v[52:55]
    v_cvt_pk_bf16_f32 v170, v82, v86
    v_cvt_pk_bf16_f32 v171, v83, v87
    ds_read_b128 v[124:127], v14 offset:2688
    v_mfma_f32_16x16x32_bf16 v[80:83], v[228:231], v[104:107], 0
    ds_read_b64 v[164:165], v13 offset:2176
    ds_read_b64 v[166:167], v13 offset:2184
    v_mfma_f32_16x16x32_bf16 v[84:87], v[152:155], v[108:111], 0
    ds_read_b64 v[132:133], v13 offset:3648
    ds_read_b64 v[134:135], v13 offset:3656
    v_mfma_f32_16x16x32_bf16 v[56:59], v[148:151], v[144:147], v[56:59]
    ds_read_b128 v[204:207], v14 offset:64
    v_mfma_f32_16x16x32_bf16 v[60:63], v[148:151], v[24:27], v[60:63]
    ds_read_b128 v[196:199], v14 offset:1600
    s_waitcnt lgkmcnt(8)
    v_mfma_f32_16x16x32_bf16 v[52:55], v[156:159], v[136:139], v[52:55]
    v_cvt_pk_bf16_f32 v116, v80, v84
    v_cvt_pk_bf16_f32 v117, v81, v85
    ds_read_b128 v[140:143], v14 offset:2112
    v_mfma_f32_16x16x32_bf16 v[56:59], v[156:159], v[20:23], v[56:59]
    v_cvt_pk_bf16_f32 v118, v82, v86
    v_cvt_pk_bf16_f32 v119, v83, v87
    ds_read_b128 v[220:223], v14 offset:3648
    v_mfma_f32_16x16x32_bf16 v[60:63], v[156:159], v[208:211], v[60:63]
    ds_read_b64 v[192:193], v13 offset:3136
    ds_read_b64 v[194:195], v13 offset:3144
    v_mfma_f32_16x16x32_bf16 v[48:51], v[36:39], v[224:227], v[48:51]
    ds_read_b128 v[212:215], v14 offset:1088
    v_mfma_f32_16x16x32_bf16 v[52:55], v[36:39], v[32:35], v[52:55]
    ds_read_b128 v[216:219], v14 offset:3136
    v_mfma_f32_16x16x32_bf16 v[56:59], v[36:39], v[40:43], v[56:59]
    ds_read_b64 v[200:201], v13 offset:2624
    ds_read_b64 v[202:203], v13 offset:2632
    v_mfma_f32_16x16x32_bf16 v[60:63], v[36:39], v[44:47], v[60:63]
    ds_read_b128 v[228:231], v14 offset:576
    v_mfma_f32_16x16x32_bf16 v[52:55], v[180:183], v[172:175], v[52:55]
    ds_read_b128 v[152:155], v14 offset:2624
    v_mfma_f32_16x16x32_bf16 v[56:59], v[28:31], v[176:179], v[56:59]
    ds_read_b64 v[144:145], v13 offset:2112
    ds_read_b64 v[146:147], v13 offset:2120
    v_mfma_f32_16x16x32_bf16 v[56:59], v[180:183], v[32:35], v[56:59]
    ds_read_b64 v[148:149], v13 offset:3584
    ds_read_b64 v[150:151], v13 offset:3592
    v_mfma_f32_16x16x32_bf16 v[60:63], v[28:31], v[188:191], v[60:63]
    ds_read_b128 v[24:27], v14 offset:0
    v_mfma_f32_16x16x32_bf16 v[60:63], v[180:183], v[120:123], v[60:63]
    ds_read_b128 v[136:139], v14 offset:1536
    v_mfma_f32_16x16x32_bf16 v[60:63], v[16:19], v[160:163], v[60:63]
    ds_read_b64 v[20:21], v13 offset:3072
    ds_read_b64 v[22:23], v13 offset:3080
    v_mfma_f32_16x16x32_bf16 v[52:55], v[184:187], v[128:131], v[52:55]
    ds_read_b128 v[156:159], v14 offset:1024
    s_waitcnt lgkmcnt(9)
    v_mfma_f32_16x16x32_bf16 v[60:63], v[168:171], v[112:115], v[60:63]
    ds_read_b64 v[208:209], v13 offset:2560
    ds_read_b64 v[210:211], v13 offset:2568
    v_mfma_f32_16x16x32_bf16 v[56:59], v[184:187], v[172:175], v[56:59]
    ds_read_b128 v[36:39], v14 offset:512
    v_mfma_f32_16x16x32_bf16 v[60:63], v[116:119], v[176:179], v[60:63]
    ds_read_b64 v[44:45], v13 offset:2048
    ds_read_b64 v[46:47], v13 offset:2056
    v_mfma_f32_16x16x32_bf16 v[60:63], v[184:187], v[124:127], v[60:63]
    ds_read_b128 v[32:35], v14 offset:2048
    v_mfma_f32_16x16x32_bf16 v[52:55], v[164:167], v[224:227], v[52:55]
    ds_read_b128 v[28:31], v14 offset:3584
    v_mfma_f32_16x16x32_bf16 v[56:59], v[164:167], v[128:131], v[56:59]
    ds_read_b128 v[188:191], v14 offset:3072
    v_mfma_f32_16x16x32_bf16 v[60:63], v[164:167], v[40:43], v[60:63]
    ds_read_b128 v[180:183], v14 offset:2560
    v_mfma_f32_16x16x32_bf16 v[48:51], v[132:135], v[204:207], v[48:51]
    v_mfma_f32_16x16x32_bf16 v[52:55], v[132:135], v[196:199], v[52:55]
    v_mfma_f32_16x16x32_bf16 v[56:59], v[132:135], v[140:143], v[56:59]
    v_mfma_f32_16x16x32_bf16 v[60:63], v[132:135], v[220:223], v[60:63]
    v_mfma_f32_16x16x32_bf16 v[52:55], v[192:195], v[212:215], v[52:55]
    v_mfma_f32_16x16x32_bf16 v[56:59], v[192:195], v[196:199], v[56:59]
    v_mfma_f32_16x16x32_bf16 v[60:63], v[192:195], v[216:219], v[60:63]
    v_mfma_f32_16x16x32_bf16 v[52:55], v[200:203], v[228:231], v[52:55]
    v_mfma_f32_16x16x32_bf16 v[56:59], v[200:203], v[212:215], v[56:59]
    v_mfma_f32_16x16x32_bf16 v[60:63], v[200:203], v[152:155], v[60:63]
    s_waitcnt lgkmcnt(0)
    v_mfma_f32_16x16x32_bf16 v[52:55], v[144:147], v[204:207], v[52:55]
    v_mfma_f32_16x16x32_bf16 v[56:59], v[144:147], v[228:231], v[56:59]
    v_mfma_f32_16x16x32_bf16 v[60:63], v[144:147], v[140:143], v[60:63]
    v_mfma_f32_16x16x32_bf16 v[48:51], v[148:151], v[24:27], v[48:51]
    v_mfma_f32_16x16x32_bf16 v[52:55], v[148:151], v[136:139], v[52:55]
    v_mfma_f32_16x16x32_bf16 v[52:55], v[20:23], v[156:159], v[52:55]
    v_mfma_f32_16x16x32_bf16 v[52:55], v[208:211], v[36:39], v[52:55]
    v_mfma_f32_16x16x32_bf16 v[52:55], v[44:47], v[24:27], v[52:55]
    v_mfma_f32_16x16x32_bf16 v[56:59], v[148:151], v[32:35], v[56:59]
    v_mfma_f32_16x16x32_bf16 v[60:63], v[148:151], v[28:31], v[60:63]
    v_mfma_f32_16x16x32_bf16 v[56:59], v[20:23], v[136:139], v[56:59]
    s_nop 0
    ds_write_b128 v11, v[48:51]
    v_mfma_f32_16x16x32_bf16 v[60:63], v[20:23], v[188:191], v[60:63]
    s_nop 1
    ds_write_b128 v11, v[52:55] offset:1152
    v_mfma_f32_16x16x32_bf16 v[56:59], v[208:211], v[156:159], v[56:59]
    v_mfma_f32_16x16x32_bf16 v[60:63], v[208:211], v[180:183], v[60:63]
    v_mfma_f32_16x16x32_bf16 v[56:59], v[44:47], v[36:39], v[56:59]
    v_mfma_f32_16x16x32_bf16 v[60:63], v[44:47], v[32:35], v[60:63]
    s_branch L_c0_epi
L_c0_p1:
    ds_read_b128 v[160:163], v14 offset:960
    ds_read_b128 v[164:167], v14 offset:1472
    ds_read_b128 v[168:171], v14 offset:3008
    ds_read_b128 v[172:175], v14 offset:3520
    s_waitcnt lgkmcnt(3)
    v_mfma_f32_16x16x32_bf16 v[48:51], v[112:115], v[160:163], 0
    ds_read_b128 v[176:179], v14 offset:448
    s_waitcnt lgkmcnt(3)
    v_mfma_f32_16x16x32_bf16 v[52:55], v[112:115], v[164:167], 0
    ds_read_b128 v[180:183], v14 offset:2496
    s_waitcnt lgkmcnt(3)
    v_mfma_f32_16x16x32_bf16 v[56:59], v[112:115], v[168:171], 0
    ds_read_b128 v[184:187], v14 offset:1984
    s_waitcnt lgkmcnt(3)
    v_mfma_f32_16x16x32_bf16 v[60:63], v[112:115], v[172:175], 0
    ds_read_b128 v[188:191], v14 offset:896
    s_waitcnt lgkmcnt(3)
    v_mfma_f32_16x16x32_bf16 v[48:51], v[116:119], v[176:179], v[48:51]
    ds_read_b128 v[192:195], v14 offset:1408
    v_mfma_f32_16x16x32_bf16 v[52:55], v[116:119], v[160:163], v[52:55]
    ds_read_b128 v[196:199], v14 offset:2944
    s_waitcnt lgkmcnt(4)
    v_mfma_f32_16x16x32_bf16 v[56:59], v[116:119], v[180:183], v[56:59]
    ds_read_b128 v[200:203], v14 offset:3456
    v_mfma_f32_16x16x32_bf16 v[60:63], v[116:119], v[168:171], v[60:63]
    ds_read_b128 v[204:207], v14 offset:384
    v_mfma_f32_16x16x32_bf16 v[52:55], v[120:123], v[176:179], v[52:55]
    ds_read_b128 v[208:211], v14 offset:2432
    s_waitcnt lgkmcnt(6)
    v_mfma_f32_16x16x32_bf16 v[56:59], v[120:123], v[184:187], v[56:59]
    ds_read_b128 v[212:215], v14 offset:1920
    v_mfma_f32_16x16x32_bf16 v[60:63], v[120:123], v[180:183], v[60:63]
    ds_read_b128 v[216:219], v14 offset:832
    v_mfma_f32_16x16x32_bf16 v[56:59], v[124:127], v[164:167], v[56:59]
    ds_read_b128 v[220:223], v14 offset:1344
    v_mfma_f32_16x16x32_bf16 v[60:63], v[124:127], v[184:187], v[60:63]
    ds_read_b128 v[224:227], v14 offset:2880
    v_mfma_f32_16x16x32_bf16 v[56:59], v[128:131], v[160:163], v[56:59]
    ds_read_b128 v[228:231], v14 offset:3392
    v_mfma_f32_16x16x32_bf16 v[60:63], v[128:131], v[164:167], v[60:63]
    ds_read_b128 v[16:19], v14 offset:320
    s_waitcnt lgkmcnt(6)
    v_mfma_f32_16x16x32_bf16 v[48:51], v[132:135], v[188:191], v[48:51]
    ds_read_b128 v[20:23], v14 offset:2368
    v_mfma_f32_16x16x32_bf16 v[52:55], v[132:135], v[192:195], v[52:55]
    ds_read_b128 v[24:27], v14 offset:1856
    v_mfma_f32_16x16x32_bf16 v[56:59], v[132:135], v[196:199], v[56:59]
    ds_read_b64 v[28:29], v13 offset:2368
    ds_read_b64 v[30:31], v13 offset:2376
    v_mfma_f32_16x16x32_bf16 v[60:63], v[132:135], v[200:203], v[60:63]
    ds_read_b64 v[32:33], v13 offset:3840
    ds_read_b64 v[34:35], v13 offset:3848
    v_mfma_f32_16x16x32_bf16 v[48:51], v[136:139], v[204:207], v[48:51]
    ds_read_b128 v[36:39], v14 offset:768
    v_mfma_f32_16x16x32_bf16 v[52:55], v[136:139], v[188:191], v[52:55]
    ds_read_b128 v[40:43], v14 offset:1280
    v_mfma_f32_16x16x32_bf16 v[56:59], v[136:139], v[208:211], v[56:59]
    ds_read_b128 v[44:47], v14 offset:2816
    v_mfma_f32_16x16x32_bf16 v[60:63], v[136:139], v[196:199], v[60:63]
    ds_read_b128 v[112:115], v14 offset:3328
    v_mfma_f32_16x16x32_bf16 v[52:55], v[140:143], v[204:207], v[52:55]
    ds_read_b64 v[172:173], v13 offset:3328
    ds_read_b64 v[174:175], v13 offset:3336
    s_waitcnt lgkmcnt(8)
    v_mfma_f32_16x16x32_bf16 v[56:59], v[140:143], v[212:215], v[56:59]
    ds_read_b128 v[116:119], v14 offset:256
    v_mfma_f32_16x16x32_bf16 v[60:63], v[140:143], v[208:211], v[60:63]
    ds_read_b128 v[168:171], v14 offset:2304
    v_mfma_f32_16x16x32_bf16 v[56:59], v[144:147], v[192:195], v[56:59]
    ds_read_b64 v[176:177], v13 offset:2816
    ds_read_b64 v[178:179], v13 offset:2824
    v_mfma_f32_16x16x32_bf16 v[60:63], v[144:147], v[212:215], v[60:63]
    ds_read_b128 v[120:123], v14 offset:432
    v_mfma_f32_16x16x32_bf16 v[48:51], v[148:151], v[216:219], v[48:51]
    ds_read_b128 v[180:183], v14 offset:416
    v_mfma_f32_16x16x32_bf16 v[52:55], v[148:151], v[220:223], v[52:55]
    ds_read_b128 v[124:127], v14 offset:1792
    v_mfma_f32_16x16x32_bf16 v[56:59], v[148:151], v[224:227], v[56:59]
    ds_read_b64 v[184:185], v13 offset:2304
    ds_read_b64 v[186:187], v13 offset:2312
    v_mfma_f32_16x16x32_bf16 v[60:63], v[148:151], v[228:231], v[60:63]
    ds_read_b128 v[160:163], v14 offset:944
    v_mfma_f32_16x16x32_bf16 v[48:51], v[152:155], v[16:19], v[48:51]
    ds_read_b128 v[128:131], v14 offset:928
    v_mfma_f32_16x16x32_bf16 v[52:55], v[152:155], v[216:219], v[52:55]
    ds_read_b64 v[164:165], v13 offset:3776
    ds_read_b64 v[166:167], v13 offset:3784
    v_mfma_f32_16x16x32_bf16 v[56:59], v[152:155], v[20:23], v[56:59]
    ds_read_b128 v[132:135], v14 offset:704
    v_mfma_f32_16x16x32_bf16 v[60:63], v[152:155], v[224:227], v[60:63]
    ds_read_b128 v[200:203], v14 offset:1216
    v_mfma_f32_16x16x32_bf16 v[52:55], v[156:159], v[16:19], v[52:55]
    ds_read_b128 v[188:191], v14 offset:2752
    v_mfma_f32_16x16x32_bf16 v[56:59], v[156:159], v[24:27], v[56:59]
    ds_read_b128 v[136:139], v14 offset:3264
    v_mfma_f32_16x16x32_bf16 v[60:63], v[156:159], v[20:23], v[60:63]
    ds_read_b128 v[196:199], v14 offset:1456
    v_mfma_f32_16x16x32_bf16 v[56:59], v[28:31], v[220:223], v[56:59]
    ds_read_b128 v[204:207], v14 offset:1440
    v_mfma_f32_16x16x32_bf16 v[60:63], v[28:31], v[24:27], v[60:63]
    ds_read_b64 v[140:141], v13 offset:3264
    ds_read_b64 v[142:143], v13 offset:3272
    s_waitcnt lgkmcnt(7)
    v_mfma_f32_16x16x32_bf16 v[48:51], v[32:35], v[36:39], v[48:51]
    ds_read_b128 v[208:211], v14 offset:192
    v_mfma_f32_16x16x32_bf16 v[52:55], v[32:35], v[40:43], v[52:55]
    ds_read_b128 v[192:195], v14 offset:2240
    v_mfma_f32_16x16x32_bf16 v[56:59], v[32:35], v[44:47], v[56:59]
    ds_read_b64 v[144:145], v13 offset:2752
    ds_read_b64 v[146:147], v13 offset:2760
    v_mfma_f32_16x16x32_bf16 v[60:63], v[32:35], v[112:115], v[60:63]
    ds_read_b128 v[212:215], v14 offset:1728
    v_mfma_f32_16x16x32_bf16 v[48:51], v[172:175], v[116:119], v[48:51]
    ds_read_b64 v[148:149], v13 offset:2240
    ds_read_b64 v[150:151], v13 offset:2248
    v_mfma_f32_16x16x32_bf16 v[52:55], v[172:175], v[36:39], v[52:55]
    ds_read_b64 v[228:229], v13 offset:3712
    ds_read_b64 v[230:231], v13 offset:3720
    v_mfma_f32_16x16x32_bf16 v[56:59], v[172:175], v[168:171], v[56:59]
    ds_read_b128 v[216:219], v14 offset:640
    v_mfma_f32_16x16x32_bf16 v[60:63], v[172:175], v[44:47], v[60:63]
    ds_read_b128 v[152:155], v8 offset:4160
    v_mfma_f32_16x16x32_bf16 v[52:55], v[176:179], v[116:119], v[52:55]
    ds_read_b128 v[224:227], v14 offset:1152
    v_mfma_f32_16x16x32_bf16 v[80:83], v[120:123], v[104:107], 0
    ds_read_b128 v[16:19], v8 offset:8320
    v_mfma_f32_16x16x32_bf16 v[84:87], v[180:183], v[108:111], 0
    ds_read_b128 v[20:23], v14 offset:2688
    v_mfma_f32_16x16x32_bf16 v[56:59], v[176:179], v[124:127], v[56:59]
    ds_read_b128 v[220:223], v8 offset:0
    v_mfma_f32_16x16x32_bf16 v[60:63], v[176:179], v[168:171], v[60:63]
    ds_read_b128 v[28:31], v14 offset:3200
    v_mfma_f32_16x16x32_bf16 v[56:59], v[184:187], v[40:43], v[56:59]
    s_nop 1
    v_cvt_pk_bf16_f32 v156, v80, v84
    v_cvt_pk_bf16_f32 v157, v81, v85
    ds_read_b64 v[24:25], v13 offset:3200
    ds_read_b64 v[26:27], v13 offset:3208
    v_mfma_f32_16x16x32_bf16 v[60:63], v[184:187], v[124:127], v[60:63]
    v_cvt_pk_bf16_f32 v158, v82, v86
    v_cvt_pk_bf16_f32 v159, v83, v87
    ds_read_b128 v[32:35], v14 offset:128
    v_mfma_f32_16x16x32_bf16 v[80:83], v[160:163], v[104:107], 0
    ds_read_b128 v[112:115], v14 offset:2176
    v_mfma_f32_16x16x32_bf16 v[84:87], v[128:131], v[108:111], 0
    ds_read_b64 v[172:173], v13 offset:2688
    ds_read_b64 v[174:175], v13 offset:2696
    v_mfma_f32_16x16x32_bf16 v[48:51], v[164:167], v[132:135], v[48:51]
    ds_read_b128 v[44:47], v14 offset:1664
    s_waitcnt lgkmcnt(8)
    v_mfma_f32_16x16x32_bf16 v[52:55], v[164:167], v[200:203], v[52:55]
    ds_read_b64 v[116:117], v13 offset:2176
    ds_read_b64 v[118:119], v13 offset:2184
    v_mfma_f32_16x16x32_bf16 v[56:59], v[164:167], v[188:191], v[56:59]
    v_cvt_pk_bf16_f32 v36, v80, v84
    v_cvt_pk_bf16_f32 v37, v81, v85
    ds_read_b64 v[120:121], v13 offset:3648
    ds_read_b64 v[122:123], v13 offset:3656
    v_mfma_f32_16x16x32_bf16 v[60:63], v[164:167], v[136:139], v[60:63]
    v_cvt_pk_bf16_f32 v38, v82, v86
    v_cvt_pk_bf16_f32 v39, v83, v87
    ds_read_b128 v[180:183], v14 offset:576
    v_mfma_f32_16x16x32_bf16 v[80:83], v[196:199], v[104:107], 0
    ds_read_b128 v[176:179], v14 offset:1088
    v_mfma_f32_16x16x32_bf16 v[84:87], v[204:207], v[108:111], 0
    ds_read_b128 v[40:43], v14 offset:2624
    v_mfma_f32_16x16x32_bf16 v[48:51], v[140:143], v[208:211], v[48:51]
    ds_read_b128 v[184:187], v14 offset:3136
    v_mfma_f32_16x16x32_bf16 v[52:55], v[140:143], v[132:135], v[52:55]
    ds_read_b64 v[124:125], v13 offset:3136
    ds_read_b64 v[126:127], v13 offset:3144
    v_mfma_f32_16x16x32_bf16 v[56:59], v[140:143], v[192:195], v[56:59]
    s_nop 0
    v_cvt_pk_bf16_f32 v168, v80, v84
    v_cvt_pk_bf16_f32 v169, v81, v85
    ds_read_b128 v[160:163], v14 offset:64
    v_mfma_f32_16x16x32_bf16 v[60:63], v[140:143], v[188:191], v[60:63]
    v_cvt_pk_bf16_f32 v170, v82, v86
    v_cvt_pk_bf16_f32 v171, v83, v87
    ds_read_b128 v[128:131], v14 offset:2112
    v_mfma_f32_16x16x32_bf16 v[52:55], v[144:147], v[208:211], v[52:55]
    ds_read_b64 v[164:165], v13 offset:2624
    ds_read_b64 v[166:167], v13 offset:2632
    v_mfma_f32_16x16x32_bf16 v[56:59], v[144:147], v[212:215], v[56:59]
    ds_read_b128 v[136:139], v14 offset:1600
    v_mfma_f32_16x16x32_bf16 v[60:63], v[144:147], v[192:195], v[60:63]
    ds_read_b64 v[196:197], v13 offset:2112
    ds_read_b64 v[198:199], v13 offset:2120
    v_mfma_f32_16x16x32_bf16 v[56:59], v[148:151], v[200:203], v[56:59]
    ds_read_b64 v[204:205], v13 offset:3584
    ds_read_b64 v[206:207], v13 offset:3592
    v_mfma_f32_16x16x32_bf16 v[60:63], v[148:151], v[212:215], v[60:63]
    ds_read_b128 v[132:135], v14 offset:512
    v_mfma_f32_16x16x32_bf16 v[48:51], v[228:231], v[216:219], v[48:51]
    ds_read_b128 v[140:143], v14 offset:1024
    v_mfma_f32_16x16x32_bf16 v[56:59], v[156:159], v[152:155], v[56:59]
    ds_read_b64 v[188:189], v13 offset:3072
    ds_read_b64 v[190:191], v13 offset:3080
    v_mfma_f32_16x16x32_bf16 v[52:55], v[228:231], v[224:227], v[52:55]
    ds_read_b128 v[208:211], v14 offset:0
    v_mfma_f32_16x16x32_bf16 v[60:63], v[156:159], v[16:19], v[60:63]
    ds_read_b64 v[144:145], v13 offset:2560
    ds_read_b64 v[146:147], v13 offset:2568
    v_mfma_f32_16x16x32_bf16 v[56:59], v[228:231], v[20:23], v[56:59]
    ds_read_b128 v[192:195], v14 offset:2560
    v_mfma_f32_16x16x32_bf16 v[56:59], v[36:39], v[220:223], v[56:59]
    ds_read_b128 v[200:203], v14 offset:3072
    s_waitcnt lgkmcnt(8)
    v_mfma_f32_16x16x32_bf16 v[60:63], v[228:231], v[28:31], v[60:63]
    ds_read_b128 v[148:151], v14 offset:2048
    v_mfma_f32_16x16x32_bf16 v[60:63], v[36:39], v[152:155], v[60:63]
    ds_read_b128 v[212:215], v14 offset:1536
    v_mfma_f32_16x16x32_bf16 v[48:51], v[24:27], v[32:35], v[48:51]
    ds_read_b64 v[156:157], v13 offset:2048
    ds_read_b64 v[158:159], v13 offset:2056
    v_mfma_f32_16x16x32_bf16 v[60:63], v[168:171], v[220:223], v[60:63]
    v_mfma_f32_16x16x32_bf16 v[52:55], v[24:27], v[216:219], v[52:55]
    v_mfma_f32_16x16x32_bf16 v[56:59], v[24:27], v[112:115], v[56:59]
    v_mfma_f32_16x16x32_bf16 v[60:63], v[24:27], v[20:23], v[60:63]
    v_mfma_f32_16x16x32_bf16 v[52:55], v[172:175], v[32:35], v[52:55]
    v_mfma_f32_16x16x32_bf16 v[56:59], v[172:175], v[44:47], v[56:59]
    v_mfma_f32_16x16x32_bf16 v[60:63], v[172:175], v[112:115], v[60:63]
    v_mfma_f32_16x16x32_bf16 v[56:59], v[116:119], v[224:227], v[56:59]
    v_mfma_f32_16x16x32_bf16 v[60:63], v[116:119], v[44:47], v[60:63]
    v_mfma_f32_16x16x32_bf16 v[48:51], v[120:123], v[180:183], v[48:51]
    v_mfma_f32_16x16x32_bf16 v[52:55], v[120:123], v[176:179], v[52:55]
    v_mfma_f32_16x16x32_bf16 v[56:59], v[120:123], v[40:43], v[56:59]
    v_mfma_f32_16x16x32_bf16 v[60:63], v[120:123], v[184:187], v[60:63]
    v_mfma_f32_16x16x32_bf16 v[48:51], v[124:127], v[160:163], v[48:51]
    v_mfma_f32_16x16x32_bf16 v[52:55], v[124:127], v[180:183], v[52:55]
    v_mfma_f32_16x16x32_bf16 v[56:59], v[124:127], v[128:131], v[56:59]
    v_mfma_f32_16x16x32_bf16 v[60:63], v[124:127], v[40:43], v[60:63]
    v_mfma_f32_16x16x32_bf16 v[52:55], v[164:167], v[160:163], v[52:55]
    v_mfma_f32_16x16x32_bf16 v[56:59], v[164:167], v[136:139], v[56:59]
    v_mfma_f32_16x16x32_bf16 v[60:63], v[164:167], v[128:131], v[60:63]
    v_mfma_f32_16x16x32_bf16 v[56:59], v[196:199], v[176:179], v[56:59]
    v_mfma_f32_16x16x32_bf16 v[60:63], v[196:199], v[136:139], v[60:63]
    v_mfma_f32_16x16x32_bf16 v[48:51], v[204:207], v[132:135], v[48:51]
    s_waitcnt lgkmcnt(0)
    v_mfma_f32_16x16x32_bf16 v[52:55], v[204:207], v[140:143], v[52:55]
    v_mfma_f32_16x16x32_bf16 v[48:51], v[188:191], v[208:211], v[48:51]
    v_mfma_f32_16x16x32_bf16 v[52:55], v[188:191], v[132:135], v[52:55]
    v_mfma_f32_16x16x32_bf16 v[52:55], v[144:147], v[208:211], v[52:55]
    v_mfma_f32_16x16x32_bf16 v[56:59], v[204:207], v[192:195], v[56:59]
    v_mfma_f32_16x16x32_bf16 v[60:63], v[204:207], v[200:203], v[60:63]
    v_mfma_f32_16x16x32_bf16 v[56:59], v[188:191], v[148:151], v[56:59]
    s_nop 2
    ds_write_b128 v11, v[48:51]
    v_mfma_f32_16x16x32_bf16 v[60:63], v[188:191], v[192:195], v[60:63]
    ds_write_b128 v11, v[52:55] offset:1152
    v_mfma_f32_16x16x32_bf16 v[56:59], v[144:147], v[212:215], v[56:59]
    v_mfma_f32_16x16x32_bf16 v[60:63], v[144:147], v[148:151], v[60:63]
    v_mfma_f32_16x16x32_bf16 v[56:59], v[156:159], v[140:143], v[56:59]
    v_mfma_f32_16x16x32_bf16 v[60:63], v[156:159], v[212:215], v[60:63]
L_c0_epi:
    s_nop 6
    ds_write_b128 v11, v[56:59] offset:2304
    ds_write_b128 v11, v[60:63] offset:3456
    s_waitcnt lgkmcnt(0)
    s_barrier
    ds_read_b64 v[92:93], v12 offset:0
    ds_read_b64 v[94:95], v12 offset:4608
    ds_read_b64 v[96:97], v12 offset:9216
    ds_read_b64 v[98:99], v12 offset:13824
    ds_read_b64 v[104:105], v12 offset:2304
    ds_read_b64 v[106:107], v12 offset:6912
    ds_read_b64 v[108:109], v12 offset:11520
    ds_read_b64 v[110:111], v12 offset:16128
    s_waitcnt lgkmcnt(7)
    v_pk_add_f32 v[92:93], v[92:93], v[64:65]
    s_waitcnt lgkmcnt(6)
    v_pk_add_f32 v[94:95], v[94:95], v[66:67]
    s_waitcnt lgkmcnt(5)
    v_pk_add_f32 v[96:97], v[96:97], v[68:69]
    s_waitcnt lgkmcnt(4)
    v_pk_add_f32 v[98:99], v[98:99], v[70:71]
    v_cvt_pk_bf16_f32 v100, v92, v94
    v_cvt_pk_bf16_f32 v101, v96, v98
    v_cvt_pk_bf16_f32 v102, v93, v95
    v_cvt_pk_bf16_f32 v103, v97, v99
    buffer_store_dwordx4 v[100:103], v9, s[16:19], s58 offen sc1
    s_waitcnt lgkmcnt(3)
    v_pk_add_f32 v[104:105], v[104:105], v[72:73]
    s_waitcnt lgkmcnt(2)
    v_pk_add_f32 v[106:107], v[106:107], v[74:75]
    s_waitcnt lgkmcnt(1)
    v_pk_add_f32 v[108:109], v[108:109], v[76:77]
    s_waitcnt lgkmcnt(0)
    v_pk_add_f32 v[110:111], v[110:111], v[78:79]
    v_cvt_pk_bf16_f32 v112, v104, v106
    v_cvt_pk_bf16_f32 v113, v108, v110
    v_cvt_pk_bf16_f32 v114, v105, v107
    v_cvt_pk_bf16_f32 v115, v109, v111
    buffer_store_dwordx4 v[112:115], v9, s[16:19], s59 offen sc1
    s_and_b32 s40, s2, 15
    s_lshl_b32 s40, s40, 8
    s_add_u32 s40, s40, 0x00f1b000
    v_mov_b32 v236, 0
    v_cmp_eq_u32 vcc, 0, v0
    s_nop 1
    v_cndmask_b32 v232, v4, v236, vcc
    v_mov_b32 v236, 1
    s_waitcnt vmcnt(0)
    s_barrier
    buffer_atomic_add v236, v232, s[16:19], s40 offen sc1
    v_lshrrev_b32 v5, 5, v1
    v_lshlrev_b32 v5, 14, v5
    v_and_b32 v6, 31, v1
    v_lshl_add_u32 v10, v6, 4, v5
    s_lshl_b32 s62, s28, 15
    s_lshl_b32 s61, s29, 9
    s_add_u32 s62, s62, s61
    s_add_u32 s62, s62, 0x00800000
    s_mul_i32 s64, s28, 1152
    s_add_u32 s64, s64, 66560
    v_mul_u32_u24 v5, 1152, v3
    v_lshl_add_u32 v5, v2, 3, v5
    v_add_u32 v5, 66560, v5
    s_lshl_b32 s44, s28, 7
    s_xor_b32 s45, s44, 0
    v_add_u32 v20, s45, v5
    v_add_u32 v24, s45, v5
    s_xor_b32 s45, s44, 128
    v_add_u32 v21, s45, v5
    v_add_u32 v25, s45, v5
    s_xor_b32 s45, s44, 256
    v_add_u32 v22, s45, v5
    v_add_u32 v26, s45, v5
    s_xor_b32 s45, s44, 384
    v_add_u32 v23, s45, v5
    v_add_u32 v27, s45, v5
    s_cmp_lg_u32 s28, 0
    s_cbranch_scc1 L_gw2_done
    v_mov_b32 v232, 0
    s_mov_b32 s46, 0x80000
    s_cmp_lg_u32 s43, 0
    s_cbranch_scc1 L_gw2_poll
    s_mov_b32 s45, 0x00f1b000
    v_lshlrev_b32 v237, 8, v1
    v_cmp_gt_u32 vcc, 16, v1
    s_nop 1
    v_cndmask_b32 v237, v4, v237, vcc
L_gw2_mp:
    v_mov_b32 v236, 0
    buffer_atomic_add v236, v237, s[16:19], s45 offen sc0 sc1
    s_waitcnt vmcnt(0)
    v_cmp_gt_u32 vcc, 48, v236
    s_sub_u32 s46, s46, 1
    s_cbranch_scc1 L_gw2_done
    s_and_b32 s40, vcc_lo, 0xffff
    s_cbranch_scc1 L_gw2_mp
    v_mov_b32 v237, 3
    buffer_store_dword v237, v232, s[16:19], s42 offen
    s_branch L_gw2_done
L_gw2_poll:
    buffer_load_dword v236, v232, s[16:19], s42 offen sc1
    s_waitcnt vmcnt(0)
    v_readfirstlane_b32 s45, v236
    s_sub_u32 s46, s46, 1
    s_cbranch_scc1 L_gw2_done
    s_cmp_lt_u32 s45, 3
    s_cbranch_scc1 L_gw2_poll
L_gw2_done:
    s_barrier
    s_add_u32 m0, s64, 0
    s_add_u32 s65, s62, 0
    buffer_load_dwordx4 v10, s[16:19], s65 offen sc1 lds
    s_add_u32 m0, s64, 4608
    s_add_u32 s65, s62, 131072
    buffer_load_dwordx4 v10, s[16:19], s65 offen sc1 lds
    s_add_u32 m0, s64, 9216
    s_add_u32 s65, s62, 262144
    buffer_load_dwordx4 v10, s[16:19], s65 offen sc1 lds
    s_add_u32 m0, s64, 13824
    s_add_u32 s65, s62, 393216
    buffer_load_dwordx4 v10, s[16:19], s65 offen sc1 lds
    s_add_u32 m0, s64, 18432
    s_add_u32 s65, s62, 524288
    buffer_load_dwordx4 v10, s[16:19], s65 offen sc1 lds
    s_add_u32 m0, s64, 23040
    s_add_u32 s65, s62, 655360
    buffer_load_dwordx4 v10, s[16:19], s65 offen sc1 lds
    s_add_u32 m0, s64, 27648
    s_add_u32 s65, s62, 786432
    buffer_load_dwordx4 v10, s[16:19], s65 offen sc1 lds
    s_add_u32 m0, s64, 32256
    s_add_u32 s65, s62, 917504
    buffer_load_dwordx4 v10, s[16:19], s65 offen sc1 lds
    s_waitcnt vmcnt(6)
    s_barrier
    ds_read_b64 v[160:161], v20 offset:0
    ds_read_b64 v[162:163], v20 offset:512
    ds_read_b64 v[164:165], v21 offset:0
    ds_read_b64 v[166:167], v21 offset:512
    ds_read_b64 v[168:169], v22 offset:0
    ds_read_b64 v[170:171], v22 offset:512
    ds_read_b64 v[172:173], v23 offset:0
    ds_read_b64 v[174:175], v23 offset:512
    s_waitcnt lgkmcnt(4)
    v_mfma_f32_16x16x32_bf16 v[88:91], v[160:163], v[240:243], 0
    ds_read_b64 v[176:177], v20 offset:4608
    ds_read_b64 v[178:179], v20 offset:5120
    v_mfma_f32_16x16x32_bf16 v[92:95], v[160:163], v[160:163], 0
    s_add_u32 m0, s64, 36864
    ds_read_b64 v[180:181], v21 offset:4608
    v_mfma_f32_16x16x32_bf16 v[40:43], v[160:163], a[0:3], 0
    s_add_u32 s65, s62, 1048576
    ds_read_b64 v[182:183], v21 offset:5120
    v_mfma_f32_16x16x32_bf16 v[56:59], v[160:163], a[4:7], 0
    buffer_load_dwordx4 v10, s[16:19], s65 offen sc1 lds
    ds_read_b64 v[184:185], v22 offset:4608
    v_mfma_f32_16x16x32_bf16 v[44:47], v[164:167], a[0:3], 0
    ds_read_b64 v[186:187], v22 offset:5120
    ds_read_b64 v[188:189], v23 offset:4608
    v_mfma_f32_16x16x32_bf16 v[60:63], v[164:167], a[4:7], 0
    ds_read_b64 v[190:191], v23 offset:5120
    s_waitcnt lgkmcnt(8)
    v_mfma_f32_16x16x32_bf16 v[48:51], v[168:171], a[0:3], 0
    s_add_u32 m0, s64, 41472
    v_mfma_f32_16x16x32_bf16 v[64:67], v[168:171], a[4:7], 0
    s_add_u32 s65, s62, 1179648
    v_mfma_f32_16x16x32_bf16 v[52:55], v[172:175], a[0:3], 0
    buffer_load_dwordx4 v10, s[16:19], s65 offen sc1 lds
    v_mfma_f32_16x16x32_bf16 v[68:71], v[172:175], a[4:7], 0
    s_waitcnt lgkmcnt(4) vmcnt(6)
    s_barrier
    v_mfma_f32_16x16x32_bf16 v[88:91], v[176:179], v[240:243], v[88:91]
    ds_read_b64 v[160:161], v20 offset:9216
    ds_read_b64 v[162:163], v20 offset:9728
    v_mfma_f32_16x16x32_bf16 v[92:95], v[176:179], v[176:179], v[92:95]
    s_add_u32 m0, s64, 46080
    ds_read_b64 v[164:165], v21 offset:9216
    v_mfma_f32_16x16x32_bf16 v[40:43], v[176:179], a[12:15], v[40:43]
    s_add_u32 s65, s62, 1310720
    ds_read_b64 v[166:167], v21 offset:9728
    v_mfma_f32_16x16x32_bf16 v[56:59], v[176:179], a[16:19], v[56:59]
    buffer_load_dwordx4 v10, s[16:19], s65 offen sc1 lds
    ds_read_b64 v[168:169], v22 offset:9216
    v_mfma_f32_16x16x32_bf16 v[44:47], v[180:183], a[12:15], v[44:47]
    ds_read_b64 v[170:171], v22 offset:9728
    ds_read_b64 v[172:173], v23 offset:9216
    v_mfma_f32_16x16x32_bf16 v[60:63], v[180:183], a[16:19], v[60:63]
    ds_read_b64 v[174:175], v23 offset:9728
    s_waitcnt lgkmcnt(8)
    v_mfma_f32_16x16x32_bf16 v[48:51], v[184:187], a[12:15], v[48:51]
    s_add_u32 m0, s64, 50688
    v_mfma_f32_16x16x32_bf16 v[64:67], v[184:187], a[16:19], v[64:67]
    s_add_u32 s65, s62, 1441792
    v_mfma_f32_16x16x32_bf16 v[52:55], v[188:191], a[12:15], v[52:55]
    buffer_load_dwordx4 v10, s[16:19], s65 offen sc1 lds
    v_mfma_f32_16x16x32_bf16 v[68:71], v[188:191], a[16:19], v[68:71]
    s_waitcnt lgkmcnt(4)
    v_mfma_f32_16x16x32_bf16 v[88:91], v[160:163], v[240:243], v[88:91]
    ds_read_b64 v[176:177], v20 offset:13824
    ds_read_b64 v[178:179], v20 offset:14336
    v_mfma_f32_16x16x32_bf16 v[92:95], v[160:163], v[160:163], v[92:95]
    s_add_u32 m0, s64, 55296
    ds_read_b64 v[180:181], v21 offset:13824
    v_mfma_f32_16x16x32_bf16 v[40:43], v[160:163], a[24:27], v[40:43]
    s_add_u32 s65, s62, 1572864
    ds_read_b64 v[182:183], v21 offset:14336
    v_mfma_f32_16x16x32_bf16 v[56:59], v[160:163], a[28:31], v[56:59]
    buffer_load_dwordx4 v10, s[16:19], s65 offen sc1 lds
    ds_read_b64 v[184:185], v22 offset:13824
    v_mfma_f32_16x16x32_bf16 v[44:47], v[164:167], a[24:27], v[44:47]
    ds_read_b64 v[186:187], v22 offset:14336
    ds_read_b64 v[188:189], v23 offset:13824
    v_mfma_f32_16x16x32_bf16 v[60:63], v[164:167], a[28:31], v[60:63]
    ds_read_b64 v[190:191], v23 offset:14336
    s_waitcnt lgkmcnt(8)
    v_mfma_f32_16x16x32_bf16 v[48:51], v[168:171], a[24:27], v[48:51]
    s_add_u32 m0, s64, 59904
    v_mfma_f32_16x16x32_bf16 v[64:67], v[168:171], a[28:31], v[64:67]
    s_add_u32 s65, s62, 1703936
    v_mfma_f32_16x16x32_bf16 v[52:55], v[172:175], a[24:27], v[52:55]
    buffer_load_dwordx4 v10, s[16:19], s65 offen sc1 lds
    v_mfma_f32_16x16x32_bf16 v[68:71], v[172:175], a[28:31], v[68:71]
    s_waitcnt lgkmcnt(4) vmcnt(8)
    s_barrier
    v_mfma_f32_16x16x32_bf16 v[88:91], v[176:179], v[240:243], v[88:91]
    ds_read_b64 v[160:161], v20 offset:18432
    ds_read_b64 v[162:163], v20 offset:18944
    v_mfma_f32_16x16x32_bf16 v[92:95], v[176:179], v[176:179], v[92:95]
    s_add_u32 m0, s64, 64512
    ds_read_b64 v[164:165], v21 offset:18432
    v_mfma_f32_16x16x32_bf16 v[40:43], v[176:179], a[36:39], v[40:43]
    s_add_u32 s65, s62, 1835008
    ds_read_b64 v[166:167], v21 offset:18944
    v_mfma_f32_16x16x32_bf16 v[56:59], v[176:179], a[40:43], v[56:59]
    buffer_load_dwordx4 v10, s[16:19], s65 offen sc1 lds
    ds_read_b64 v[168:169], v22 offset:18432
    v_mfma_f32_16x16x32_bf16 v[44:47], v[180:183], a[36:39], v[44:47]
    ds_read_b64 v[170:171], v22 offset:18944
    ds_read_b64 v[172:173], v23 offset:18432
    v_mfma_f32_16x16x32_bf16 v[60:63], v[180:183], a[40:43], v[60:63]
    ds_read_b64 v[174:175], v23 offset:18944
    s_waitcnt lgkmcnt(8)
    v_mfma_f32_16x16x32_bf16 v[48:51], v[184:187], a[36:39], v[48:51]
    s_add_u32 m0, s64, 69120
    v_mfma_f32_16x16x32_bf16 v[64:67], v[184:187], a[40:43], v[64:67]
    s_add_u32 s65, s62, 1966080
    v_mfma_f32_16x16x32_bf16 v[52:55], v[188:191], a[36:39], v[52:55]
    buffer_load_dwordx4 v10, s[16:19], s65 offen sc1 lds
    v_mfma_f32_16x16x32_bf16 v[68:71], v[188:191], a[40:43], v[68:71]
    s_waitcnt lgkmcnt(4)
    v_mfma_f32_16x16x32_bf16 v[88:91], v[160:163], v[240:243], v[88:91]
    ds_read_b64 v[176:177], v20 offset:23040
    v_mfma_f32_16x16x32_bf16 v[92:95], v[160:163], v[160:163], v[92:95]
    ds_read_b64 v[178:179], v20 offset:23552
    v_mfma_f32_16x16x32_bf16 v[40:43], v[160:163], a[48:51], v[40:43]
    ds_read_b64 v[180:181], v21 offset:23040
    v_mfma_f32_16x16x32_bf16 v[56:59], v[160:163], a[52:55], v[56:59]
    ds_read_b64 v[182:183], v21 offset:23552
    v_mfma_f32_16x16x32_bf16 v[44:47], v[164:167], a[48:51], v[44:47]
    ds_read_b64 v[184:185], v22 offset:23040
    v_mfma_f32_16x16x32_bf16 v[60:63], v[164:167], a[52:55], v[60:63]
    ds_read_b64 v[186:187], v22 offset:23552
    s_waitcnt lgkmcnt(6)
    v_mfma_f32_16x16x32_bf16 v[48:51], v[168:171], a[48:51], v[48:51]
    ds_read_b64 v[188:189], v23 offset:23040
    v_mfma_f32_16x16x32_bf16 v[64:67], v[168:171], a[52:55], v[64:67]
    ds_read_b64 v[190:191], v23 offset:23552
    v_mfma_f32_16x16x32_bf16 v[52:55], v[172:175], a[48:51], v[52:55]
    v_mfma_f32_16x16x32_bf16 v[68:71], v[172:175], a[52:55], v[68:71]
    s_waitcnt lgkmcnt(4) vmcnt(8)
    s_barrier
    v_mfma_f32_16x16x32_bf16 v[88:91], v[176:179], v[240:243], v[88:91]
    ds_read_b64 v[160:161], v20 offset:27648
    v_mfma_f32_16x16x32_bf16 v[92:95], v[176:179], v[176:179], v[92:95]
    ds_read_b64 v[162:163], v20 offset:28160
    v_mfma_f32_16x16x32_bf16 v[40:43], v[176:179], a[60:63], v[40:43]
    ds_read_b64 v[164:165], v21 offset:27648
    v_mfma_f32_16x16x32_bf16 v[56:59], v[176:179], a[64:67], v[56:59]
    ds_read_b64 v[166:167], v21 offset:28160
    v_mfma_f32_16x16x32_bf16 v[44:47], v[180:183], a[60:63], v[44:47]
    ds_read_b64 v[168:169], v22 offset:27648
    v_mfma_f32_16x16x32_bf16 v[60:63], v[180:183], a[64:67], v[60:63]
    ds_read_b64 v[170:171], v22 offset:28160
    s_waitcnt lgkmcnt(6)
    v_mfma_f32_16x16x32_bf16 v[48:51], v[184:187], a[60:63], v[48:51]
    ds_read_b64 v[172:173], v23 offset:27648
    v_mfma_f32_16x16x32_bf16 v[64:67], v[184:187], a[64:67], v[64:67]
    ds_read_b64 v[174:175], v23 offset:28160
    v_mfma_f32_16x16x32_bf16 v[52:55], v[188:191], a[60:63], v[52:55]
    v_mfma_f32_16x16x32_bf16 v[68:71], v[188:191], a[64:67], v[68:71]
    s_waitcnt lgkmcnt(4)
    v_mfma_f32_16x16x32_bf16 v[88:91], v[160:163], v[240:243], v[88:91]
    ds_read_b64 v[176:177], v20 offset:32256
    v_mfma_f32_16x16x32_bf16 v[92:95], v[160:163], v[160:163], v[92:95]
    ds_read_b64 v[178:179], v20 offset:32768
    v_mfma_f32_16x16x32_bf16 v[40:43], v[160:163], a[72:75], v[40:43]
    ds_read_b64 v[180:181], v21 offset:32256
    v_mfma_f32_16x16x32_bf16 v[56:59], v[160:163], a[76:79], v[56:59]
    ds_read_b64 v[182:183], v21 offset:32768
    v_mfma_f32_16x16x32_bf16 v[44:47], v[164:167], a[72:75], v[44:47]
    ds_read_b64 v[184:185], v22 offset:32256
    v_mfma_f32_16x16x32_bf16 v[60:63], v[164:167], a[76:79], v[60:63]
    ds_read_b64 v[186:187], v22 offset:32768
    s_waitcnt lgkmcnt(6)
    v_mfma_f32_16x16x32_bf16 v[48:51], v[168:171], a[72:75], v[48:51]
    ds_read_b64 v[188:189], v23 offset:32256
    v_mfma_f32_16x16x32_bf16 v[64:67], v[168:171], a[76:79], v[64:67]
    ds_read_b64 v[190:191], v23 offset:32768
    v_mfma_f32_16x16x32_bf16 v[52:55], v[172:175], a[72:75], v[52:55]
    v_mfma_f32_16x16x32_bf16 v[68:71], v[172:175], a[76:79], v[68:71]
    s_waitcnt lgkmcnt(4) vmcnt(6)
    s_barrier
    v_mfma_f32_16x16x32_bf16 v[88:91], v[176:179], v[240:243], v[88:91]
    v_add_u32 v20, 36864, v20
    v_add_u32 v21, 36864, v21
    v_mfma_f32_16x16x32_bf16 v[92:95], v[176:179], v[176:179], v[92:95]
    v_add_u32 v22, 36864, v22
    v_add_u32 v23, 36864, v23
    v_mfma_f32_16x16x32_bf16 v[40:43], v[176:179], a[84:87], v[40:43]
    ds_read_b64 v[160:161], v20 offset:0
    ds_read_b64 v[162:163], v20 offset:512
    v_mfma_f32_16x16x32_bf16 v[56:59], v[176:179], a[88:91], v[56:59]
    ds_read_b64 v[164:165], v21 offset:0
    v_mfma_f32_16x16x32_bf16 v[44:47], v[180:183], a[84:87], v[44:47]
    ds_read_b64 v[166:167], v21 offset:512
    v_mfma_f32_16x16x32_bf16 v[60:63], v[180:183], a[88:91], v[60:63]
    ds_read_b64 v[168:169], v22 offset:0
    s_waitcnt lgkmcnt(5)
    v_mfma_f32_16x16x32_bf16 v[48:51], v[184:187], a[84:87], v[48:51]
    ds_read_b64 v[170:171], v22 offset:512
    v_mfma_f32_16x16x32_bf16 v[64:67], v[184:187], a[88:91], v[64:67]
    ds_read_b64 v[172:173], v23 offset:0
    v_mfma_f32_16x16x32_bf16 v[52:55], v[188:191], a[84:87], v[52:55]
    ds_read_b64 v[174:175], v23 offset:512
    v_mfma_f32_16x16x32_bf16 v[68:71], v[188:191], a[88:91], v[68:71]
    s_waitcnt lgkmcnt(4)
    v_mfma_f32_16x16x32_bf16 v[88:91], v[160:163], v[240:243], v[88:91]
    ds_read_b64 v[176:177], v20 offset:4608
    v_mfma_f32_16x16x32_bf16 v[92:95], v[160:163], v[160:163], v[92:95]
    ds_read_b64 v[178:179], v20 offset:5120
    v_mfma_f32_16x16x32_bf16 v[40:43], v[160:163], a[96:99], v[40:43]
    ds_read_b64 v[180:181], v21 offset:4608
    v_mfma_f32_16x16x32_bf16 v[56:59], v[160:163], a[100:103], v[56:59]
    ds_read_b64 v[182:183], v21 offset:5120
    v_mfma_f32_16x16x32_bf16 v[44:47], v[164:167], a[96:99], v[44:47]
    ds_read_b64 v[184:185], v22 offset:4608
    v_mfma_f32_16x16x32_bf16 v[60:63], v[164:167], a[100:103], v[60:63]
    ds_read_b64 v[186:187], v22 offset:5120
    s_waitcnt lgkmcnt(6)
    v_mfma_f32_16x16x32_bf16 v[48:51], v[168:171], a[96:99], v[48:51]
    ds_read_b64 v[188:189], v23 offset:4608
    v_mfma_f32_16x16x32_bf16 v[64:67], v[168:171], a[100:103], v[64:67]
    ds_read_b64 v[190:191], v23 offset:5120
    v_mfma_f32_16x16x32_bf16 v[52:55], v[172:175], a[96:99], v[52:55]
    v_mfma_f32_16x16x32_bf16 v[68:71], v[172:175], a[100:103], v[68:71]
    s_waitcnt lgkmcnt(4) vmcnt(4)
    s_barrier
    v_mfma_f32_16x16x32_bf16 v[88:91], v[176:179], v[240:243], v[88:91]
    ds_read_b64 v[96:97], v20 offset:9216
    v_mfma_f32_16x16x32_bf16 v[92:95], v[176:179], v[176:179], v[92:95]
    ds_read_b64 v[98:99], v20 offset:9728
    v_mfma_f32_16x16x32_bf16 v[40:43], v[176:179], a[108:111], v[40:43]
    ds_read_b64 v[100:101], v21 offset:9216
    v_mfma_f32_16x16x32_bf16 v[56:59], v[176:179], a[112:115], v[56:59]
    ds_read_b64 v[102:103], v21 offset:9728
    v_mfma_f32_16x16x32_bf16 v[44:47], v[180:183], a[108:111], v[44:47]
    ds_read_b64 v[104:105], v22 offset:9216
    v_mfma_f32_16x16x32_bf16 v[60:63], v[180:183], a[112:115], v[60:63]
    ds_read_b64 v[106:107], v22 offset:9728
    s_waitcnt lgkmcnt(6)
    v_mfma_f32_16x16x32_bf16 v[48:51], v[184:187], a[108:111], v[48:51]
    ds_read_b64 v[108:109], v23 offset:9216
    v_mfma_f32_16x16x32_bf16 v[64:67], v[184:187], a[112:115], v[64:67]
    ds_read_b64 v[110:111], v23 offset:9728
    v_mfma_f32_16x16x32_bf16 v[52:55], v[188:191], a[108:111], v[52:55]
    v_mfma_f32_16x16x32_bf16 v[68:71], v[188:191], a[112:115], v[68:71]
    s_waitcnt lgkmcnt(4)
    v_mfma_f32_16x16x32_bf16 v[88:91], v[96:99], v[240:243], v[88:91]
    ds_read_b64 v[112:113], v20 offset:13824
    v_mfma_f32_16x16x32_bf16 v[92:95], v[96:99], v[96:99], v[92:95]
    ds_read_b64 v[114:115], v20 offset:14336
    v_mfma_f32_16x16x32_bf16 v[40:43], v[96:99], a[120:123], v[40:43]
    ds_read_b64 v[116:117], v21 offset:13824
    v_mfma_f32_16x16x32_bf16 v[56:59], v[96:99], a[124:127], v[56:59]
    ds_read_b64 v[118:119], v21 offset:14336
    v_mfma_f32_16x16x32_bf16 v[44:47], v[100:103], a[120:123], v[44:47]
    ds_read_b64 v[120:121], v22 offset:13824
    v_mfma_f32_16x16x32_bf16 v[60:63], v[100:103], a[124:127], v[60:63]
    ds_read_b64 v[122:123], v22 offset:14336
    s_waitcnt lgkmcnt(6)
    v_mfma_f32_16x16x32_bf16 v[48:51], v[104:107], a[120:123], v[48:51]
    ds_read_b64 v[124:125], v23 offset:13824
    v_mfma_f32_16x16x32_bf16 v[64:67], v[104:107], a[124:127], v[64:67]
    ds_read_b64 v[126:127], v23 offset:14336
    v_mfma_f32_16x16x32_bf16 v[52:55], v[108:111], a[120:123], v[52:55]
    v_mfma_f32_16x16x32_bf16 v[68:71], v[108:111], a[124:127], v[68:71]
    s_waitcnt lgkmcnt(4) vmcnt(2)
    s_barrier
    v_mfma_f32_16x16x32_bf16 v[88:91], v[112:115], v[240:243], v[88:91]
    ds_read_b64 v[128:129], v20 offset:18432
    v_mfma_f32_16x16x32_bf16 v[92:95], v[112:115], v[112:115], v[92:95]
    ds_read_b64 v[130:131], v20 offset:18944
    v_mfma_f32_16x16x32_bf16 v[40:43], v[112:115], a[132:135], v[40:43]
    ds_read_b64 v[132:133], v21 offset:18432
    v_mfma_f32_16x16x32_bf16 v[56:59], v[112:115], a[136:139], v[56:59]
    ds_read_b64 v[134:135], v21 offset:18944
    v_mfma_f32_16x16x32_bf16 v[44:47], v[116:119], a[132:135], v[44:47]
    ds_read_b64 v[136:137], v22 offset:18432
    v_mfma_f32_16x16x32_bf16 v[60:63], v[116:119], a[136:139], v[60:63]
    ds_read_b64 v[138:139], v22 offset:18944
    s_waitcnt lgkmcnt(6)
    v_mfma_f32_16x16x32_bf16 v[48:51], v[120:123], a[132:135], v[48:51]
    ds_read_b64 v[140:141], v23 offset:18432
    v_mfma_f32_16x16x32_bf16 v[64:67], v[120:123], a[136:139], v[64:67]
    ds_read_b64 v[142:143], v23 offset:18944
    v_mfma_f32_16x16x32_bf16 v[52:55], v[124:127], a[132:135], v[52:55]
    v_mfma_f32_16x16x32_bf16 v[68:71], v[124:127], a[136:139], v[68:71]
    s_waitcnt lgkmcnt(4)
    v_mfma_f32_16x16x32_bf16 v[88:91], v[128:131], v[240:243], v[88:91]
    ds_read_b64 v[144:145], v20 offset:23040
    v_mfma_f32_16x16x32_bf16 v[92:95], v[128:131], v[128:131], v[92:95]
    ds_read_b64 v[146:147], v20 offset:23552
    v_mfma_f32_16x16x32_bf16 v[40:43], v[128:131], a[144:147], v[40:43]
    ds_read_b64 v[148:149], v21 offset:23040
    v_mfma_f32_16x16x32_bf16 v[56:59], v[128:131], a[148:151], v[56:59]
    ds_read_b64 v[150:151], v21 offset:23552
    v_mfma_f32_16x16x32_bf16 v[44:47], v[132:135], a[144:147], v[44:47]
    ds_read_b64 v[152:153], v22 offset:23040
    v_mfma_f32_16x16x32_bf16 v[60:63], v[132:135], a[148:151], v[60:63]
    ds_read_b64 v[154:155], v22 offset:23552
    s_waitcnt lgkmcnt(6)
    v_mfma_f32_16x16x32_bf16 v[48:51], v[136:139], a[144:147], v[48:51]
    ds_read_b64 v[156:157], v23 offset:23040
    v_mfma_f32_16x16x32_bf16 v[64:67], v[136:139], a[148:151], v[64:67]
    ds_read_b64 v[158:159], v23 offset:23552
    v_mfma_f32_16x16x32_bf16 v[52:55], v[140:143], a[144:147], v[52:55]
    v_mfma_f32_16x16x32_bf16 v[68:71], v[140:143], a[148:151], v[68:71]
    s_waitcnt lgkmcnt(4) vmcnt(0)
    s_barrier
    v_mfma_f32_16x16x32_bf16 v[88:91], v[144:147], v[240:243], v[88:91]
    ds_read_b64 v[160:161], v20 offset:27648
    v_mfma_f32_16x16x32_bf16 v[92:95], v[144:147], v[144:147], v[92:95]
    ds_read_b64 v[162:163], v20 offset:28160
    v_mfma_f32_16x16x32_bf16 v[40:43], v[144:147], a[156:159], v[40:43]
    ds_read_b64 v[164:165], v21 offset:27648
    v_mfma_f32_16x16x32_bf16 v[56:59], v[144:147], a[160:163], v[56:59]
    ds_read_b64 v[166:167], v21 offset:28160
    v_mfma_f32_16x16x32_bf16 v[44:47], v[148:151], a[156:159], v[44:47]
    ds_read_b64 v[168:169], v22 offset:27648
    v_mfma_f32_16x16x32_bf16 v[60:63], v[148:151], a[160:163], v[60:63]
    ds_read_b64 v[170:171], v22 offset:28160
    s_waitcnt lgkmcnt(6)
    v_mfma_f32_16x16x32_bf16 v[48:51], v[152:155], a[156:159], v[48:51]
    ds_read_b64 v[172:173], v23 offset:27648
    v_mfma_f32_16x16x32_bf16 v[64:67], v[152:155], a[160:163], v[64:67]
    ds_read_b64 v[174:175], v23 offset:28160
    v_mfma_f32_16x16x32_bf16 v[52:55], v[156:159], a[156:159], v[52:55]
    v_mfma_f32_16x16x32_bf16 v[68:71], v[156:159], a[160:163], v[68:71]
    s_waitcnt lgkmcnt(4)
    v_mfma_f32_16x16x32_bf16 v[88:91], v[160:163], v[240:243], v[88:91]
    ds_read_b64 v[176:177], v20 offset:32256
    v_mfma_f32_16x16x32_bf16 v[92:95], v[160:163], v[160:163], v[92:95]
    ds_read_b64 v[178:179], v20 offset:32768
    v_mfma_f32_16x16x32_bf16 v[40:43], v[160:163], a[168:171], v[40:43]
    ds_read_b64 v[180:181], v21 offset:32256
    v_mfma_f32_16x16x32_bf16 v[56:59], v[160:163], a[172:175], v[56:59]
    ds_read_b64 v[182:183], v21 offset:32768
    v_mfma_f32_16x16x32_bf16 v[44:47], v[164:167], a[168:171], v[44:47]
    ds_read_b64 v[184:185], v22 offset:32256
    v_mfma_f32_16x16x32_bf16 v[60:63], v[164:167], a[172:175], v[60:63]
    ds_read_b64 v[186:187], v22 offset:32768
    s_waitcnt lgkmcnt(6)
    v_mfma_f32_16x16x32_bf16 v[48:51], v[168:171], a[168:171], v[48:51]
    ds_read_b64 v[188:189], v23 offset:32256
    v_mfma_f32_16x16x32_bf16 v[64:67], v[168:171], a[172:175], v[64:67]
    ds_read_b64 v[190:191], v23 offset:32768
    v_mfma_f32_16x16x32_bf16 v[52:55], v[172:175], a[168:171], v[52:55]
    v_mfma_f32_16x16x32_bf16 v[68:71], v[172:175], a[172:175], v[68:71]
    s_waitcnt lgkmcnt(4)
    v_mfma_f32_16x16x32_bf16 v[88:91], v[176:179], v[240:243], v[88:91]
    v_mfma_f32_16x16x32_bf16 v[92:95], v[176:179], v[176:179], v[92:95]
    v_mfma_f32_16x16x32_bf16 v[40:43], v[176:179], a[180:183], v[40:43]
    v_mfma_f32_16x16x32_bf16 v[56:59], v[176:179], a[184:187], v[56:59]
    v_mfma_f32_16x16x32_bf16 v[44:47], v[180:183], a[180:183], v[44:47]
    v_mfma_f32_16x16x32_bf16 v[60:63], v[180:183], a[184:187], v[60:63]
    s_waitcnt lgkmcnt(0)
    v_mfma_f32_16x16x32_bf16 v[48:51], v[184:187], a[180:183], v[48:51]
    v_mfma_f32_16x16x32_bf16 v[64:67], v[184:187], a[184:187], v[64:67]
    v_mfma_f32_16x16x32_bf16 v[52:55], v[188:191], a[180:183], v[52:55]
    v_mfma_f32_16x16x32_bf16 v[68:71], v[188:191], a[184:187], v[68:71]
    v_and_b32 v5, 3, v2
    v_cmp_eq_u32 s[48:49], 1, v5
    v_cmp_eq_u32 s[50:51], 2, v5
    v_cmp_eq_u32 s[52:53], 3, v5
    v_lshrrev_b32 v5, 2, v2
    v_cmp_eq_u32 s[54:55], v5, v3
    v_cndmask_b32 v6, v88, v89, s[48:49]
    v_cndmask_b32 v6, v6, v90, s[50:51]
    v_cndmask_b32 v6, v6, v91, s[52:53]
    v_cndmask_b32 v7, v92, v93, s[48:49]
    v_cndmask_b32 v7, v7, v94, s[50:51]
    v_cndmask_b32 v7, v7, v95, s[52:53]
    v_mul_f32 v6, 0x3b000000, v6
    v_mul_f32 v7, 0x3b000000, v7
    v_fma_f32 v7, -v6, v6, v7
    v_max_f32 v7, 0, v7
    v_cvt_pk_bf16_f32 v7, v6, v7
    v_lshlrev_b32 v6, 16, v7
    v_and_b32 v7, 0xffff0000, v7
    v_add_f32 v7, 0x3727c5ac, v7
    v_cvt_pk_bf16_f32 v7, v7, v7
    v_and_b32 v7, 0xffff0000, v7
    v_sqrt_f32 v7, v7
    s_nop 0
    v_cvt_pk_bf16_f32 v7, v7, v7
    v_and_b32 v7, 0xffff0000, v7
    v_rcp_f32 v7, v7
    s_nop 0
    v_mul_f32 v6, -v6, v7
    s_lshl_b32 s44, s28, 6
    s_add_u32 s44, s44, 140288
    v_lshl_add_u32 v8, v2, 2, s44
    s_mov_b64 s[56:57], exec
    s_mov_b64 exec, s[54:55]
    ds_write2_b32 v8, v7, v6 offset0:0 offset1:64
    s_mov_b64 exec, s[56:57]
    v_lshl_add_u32 v9, v3, 4, s44
    s_waitcnt lgkmcnt(0)
    s_barrier
    v_mfma_f32_16x16x32_bf16 v[72:75], a[128:131], v[96:99], 0
    v_xor_b32 v5, 0, v9
    ds_read_b128 v[192:195], v5
    ds_read_b128 v[208:211], v5 offset:256
    v_xor_b32 v5, 64, v9
    ds_read_b128 v[196:199], v5
    ds_read_b128 v[212:215], v5 offset:256
    v_mfma_f32_16x16x32_bf16 v[76:79], a[128:131], v[100:103], 0
    v_xor_b32 v5, 128, v9
    ds_read_b128 v[200:203], v5
    ds_read_b128 v[216:219], v5 offset:256
    v_xor_b32 v5, 192, v9
    ds_read_b128 v[204:207], v5
    ds_read_b128 v[220:223], v5 offset:256
    v_mfma_f32_16x16x32_bf16 v[80:83], a[128:131], v[104:107], 0
    s_mov_b32 s58, 0x3fb8aa3b
    s_mov_b32 s59, s58
    v_mov_b32 v36, 0x358637bd
    v_mov_b32 v37, 0xb5c1a2a0
    v_mfma_f32_16x16x32_bf16 v[84:87], a[128:131], v[108:111], 0
    v_mfma_f32_16x16x32_bf16 v[72:75], a[140:143], v[112:115], v[72:75]
    v_mfma_f32_16x16x32_bf16 v[76:79], a[140:143], v[116:119], v[76:79]
    s_waitcnt lgkmcnt(6)
    v_pk_fma_f32 v[30:31], v[208:209], v[244:245], v[36:37] op_sel_hi:[1,1,0]
    v_pk_fma_f32 v[40:41], v[40:41], v[192:193], v[30:31]
    v_pk_fma_f32 v[32:33], v[40:41], s[58:59], v[36:37] op_sel:[0,0,1] op_sel_hi:[1,1,1]
    v_exp_f32 v32, v32 clamp
    v_exp_f32 v33, v33 clamp
    v_max_f32 v40, v40, v36
    v_max_f32 v41, v41, v36
    v_pk_add_f32 v[40:41], v[40:41], v[32:33]
    v_pk_mul_f32 v[34:35], v[208:209], v[248:249]
    v_pk_fma_f32 v[56:57], v[56:57], v[192:193], v[34:35]
    v_cvt_pk_bf16_f32 v40, v40, v41
    v_cvt_pk_bf16_f32 v56, v56, v57
    v_pk_fma_f32 v[30:31], v[210:211], v[244:245], v[36:37] op_sel_hi:[1,1,0]
    v_pk_fma_f32 v[42:43], v[42:43], v[194:195], v[30:31]
    v_pk_fma_f32 v[32:33], v[42:43], s[58:59], v[36:37] op_sel:[0,0,1] op_sel_hi:[1,1,1]
    v_exp_f32 v32, v32 clamp
    v_exp_f32 v33, v33 clamp
    v_max_f32 v42, v42, v36
    v_max_f32 v43, v43, v36
    v_pk_add_f32 v[42:43], v[42:43], v[32:33]
    v_pk_mul_f32 v[34:35], v[210:211], v[248:249]
    v_pk_fma_f32 v[58:59], v[58:59], v[194:195], v[34:35]
    v_cvt_pk_bf16_f32 v41, v42, v43
    v_cvt_pk_bf16_f32 v57, v58, v59
    s_waitcnt lgkmcnt(4)
    v_pk_fma_f32 v[30:31], v[212:213], v[244:245], v[36:37] op_sel_hi:[1,1,0]
    v_pk_fma_f32 v[44:45], v[44:45], v[196:197], v[30:31]
    v_pk_fma_f32 v[32:33], v[44:45], s[58:59], v[36:37] op_sel:[0,0,1] op_sel_hi:[1,1,1]
    v_exp_f32 v32, v32 clamp
    v_exp_f32 v33, v33 clamp
    v_max_f32 v44, v44, v36
    v_max_f32 v45, v45, v36
    v_pk_add_f32 v[44:45], v[44:45], v[32:33]
    v_pk_mul_f32 v[34:35], v[212:213], v[248:249]
    v_pk_fma_f32 v[60:61], v[60:61], v[196:197], v[34:35]
    v_cvt_pk_bf16_f32 v42, v44, v45
    v_cvt_pk_bf16_f32 v58, v60, v61
    v_pk_fma_f32 v[30:31], v[214:215], v[244:245], v[36:37] op_sel_hi:[1,1,0]
    v_pk_fma_f32 v[46:47], v[46:47], v[198:199], v[30:31]
    v_pk_fma_f32 v[32:33], v[46:47], s[58:59], v[36:37] op_sel:[0,0,1] op_sel_hi:[1,1,1]
    v_exp_f32 v32, v32 clamp
    v_exp_f32 v33, v33 clamp
    v_max_f32 v46, v46, v36
    v_max_f32 v47, v47, v36
    v_pk_add_f32 v[46:47], v[46:47], v[32:33]
    v_pk_mul_f32 v[34:35], v[214:215], v[248:249]
    v_pk_fma_f32 v[62:63], v[62:63], v[198:199], v[34:35]
    v_cvt_pk_bf16_f32 v43, v46, v47
    v_cvt_pk_bf16_f32 v59, v62, v63
    s_waitcnt lgkmcnt(2)
    v_pk_fma_f32 v[30:31], v[216:217], v[244:245], v[36:37] op_sel_hi:[1,1,0]
    v_pk_fma_f32 v[48:49], v[48:49], v[200:201], v[30:31]
    v_pk_fma_f32 v[32:33], v[48:49], s[58:59], v[36:37] op_sel:[0,0,1] op_sel_hi:[1,1,1]
    v_exp_f32 v32, v32 clamp
    v_exp_f32 v33, v33 clamp
    v_max_f32 v48, v48, v36
    v_max_f32 v49, v49, v36
    v_pk_add_f32 v[48:49], v[48:49], v[32:33]
    v_pk_mul_f32 v[34:35], v[216:217], v[248:249]
    v_pk_fma_f32 v[64:65], v[64:65], v[200:201], v[34:35]
    v_cvt_pk_bf16_f32 v44, v48, v49
    v_cvt_pk_bf16_f32 v60, v64, v65
    v_pk_fma_f32 v[30:31], v[218:219], v[244:245], v[36:37] op_sel_hi:[1,1,0]
    v_pk_fma_f32 v[50:51], v[50:51], v[202:203], v[30:31]
    v_pk_fma_f32 v[32:33], v[50:51], s[58:59], v[36:37] op_sel:[0,0,1] op_sel_hi:[1,1,1]
    v_exp_f32 v32, v32 clamp
    v_exp_f32 v33, v33 clamp
    v_max_f32 v50, v50, v36
    v_max_f32 v51, v51, v36
    v_pk_add_f32 v[50:51], v[50:51], v[32:33]
    v_pk_mul_f32 v[34:35], v[218:219], v[248:249]
    v_pk_fma_f32 v[66:67], v[66:67], v[202:203], v[34:35]
    v_cvt_pk_bf16_f32 v45, v50, v51
    v_cvt_pk_bf16_f32 v61, v66, v67
    s_waitcnt lgkmcnt(0)
    v_pk_fma_f32 v[30:31], v[220:221], v[244:245], v[36:37] op_sel_hi:[1,1,0]
    v_pk_fma_f32 v[52:53], v[52:53], v[204:205], v[30:31]
    v_pk_fma_f32 v[32:33], v[52:53], s[58:59], v[36:37] op_sel:[0,0,1] op_sel_hi:[1,1,1]
    v_exp_f32 v32, v32 clamp
    v_exp_f32 v33, v33 clamp
    v_max_f32 v52, v52, v36
    v_max_f32 v53, v53, v36
    v_pk_add_f32 v[52:53], v[52:53], v[32:33]
    v_pk_mul_f32 v[34:35], v[220:221], v[248:249]
    v_pk_fma_f32 v[68:69], v[68:69], v[204:205], v[34:35]
    v_cvt_pk_bf16_f32 v46, v52, v53
    v_cvt_pk_bf16_f32 v62, v68, v69
    v_pk_fma_f32 v[30:31], v[222:223], v[244:245], v[36:37] op_sel_hi:[1,1,0]
    v_pk_fma_f32 v[54:55], v[54:55], v[206:207], v[30:31]
    v_pk_fma_f32 v[32:33], v[54:55], s[58:59], v[36:37] op_sel:[0,0,1] op_sel_hi:[1,1,1]
    v_exp_f32 v32, v32 clamp
    v_exp_f32 v33, v33 clamp
    v_max_f32 v54, v54, v36
    v_max_f32 v55, v55, v36
    v_pk_add_f32 v[54:55], v[54:55], v[32:33]
    v_pk_mul_f32 v[34:35], v[222:223], v[248:249]
    v_pk_fma_f32 v[70:71], v[70:71], v[206:207], v[34:35]
    v_cvt_pk_bf16_f32 v47, v54, v55
    v_cvt_pk_bf16_f32 v63, v70, v71
    v_mfma_f32_16x16x32_bf16 v[88:91], v[56:59], v[40:43], 0
    v_lshlrev_b32 v6, 2, v2
    v_lshl_add_u32 v7, v3, 8, v6
    v_mfma_f32_16x16x32_bf16 v[88:91], v[60:63], v[44:47], v[88:91]
    v_add_u32 v6, 1024, v6
    v_cmp_gt_u32 vcc, 16, v1
    v_mfma_f32_16x16x32_bf16 v[92:95], v[240:243], v[40:43], 0
    s_add_u32 s44, s36, 0x00f09000
    v_cndmask_b32 v6, v4, v6, vcc
    v_mfma_f32_16x16x32_bf16 v[92:95], v[240:243], v[44:47], v[92:95]
    v_mfma_f32_16x16x32_bf16 v[80:83], a[140:143], v[120:123], v[80:83]
    v_mfma_f32_16x16x32_bf16 v[84:87], a[140:143], v[124:127], v[84:87]
    v_mfma_f32_16x16x32_bf16 v[72:75], a[152:155], v[128:131], v[72:75]
    buffer_atomic_add_f32 v88, v7, s[16:19], s44 offen offset:0
    buffer_atomic_add_f32 v89, v7, s[16:19], s44 offen offset:64
    buffer_atomic_add_f32 v90, v7, s[16:19], s44 offen offset:128
    v_mfma_f32_16x16x32_bf16 v[76:79], a[152:155], v[132:135], v[76:79]
    buffer_atomic_add_f32 v91, v7, s[16:19], s44 offen offset:192
    buffer_atomic_add_f32 v92, v6, s[16:19], s44 offen
    v_xor_b32 v5, 0, v8
    v_mfma_f32_16x16x32_bf16 v[80:83], a[152:155], v[136:139], v[80:83]
    ds_read2_b32 v[224:225], v5 offset0:0 offset1:64
    v_xor_b32 v5, 64, v8
    ds_read2_b32 v[226:227], v5 offset0:0 offset1:64
    v_mfma_f32_16x16x32_bf16 v[84:87], a[152:155], v[140:143], v[84:87]
    v_xor_b32 v5, 128, v8
    ds_read2_b32 v[228:229], v5 offset0:0 offset1:64
    v_xor_b32 v5, 192, v8
    v_mfma_f32_16x16x32_bf16 v[72:75], a[164:167], v[144:147], v[72:75]
    ds_read2_b32 v[230:231], v5 offset0:0 offset1:64
    s_and_b32 s45, s28, 1
    v_and_b32 v5, 1, v3
    v_mfma_f32_16x16x32_bf16 v[76:79], a[164:167], v[148:151], v[76:79]
    v_xor_b32 v5, s45, v5
    v_lshrrev_b32 v9, 1, v2
    v_lshl_add_u32 v5, v5, 3, v9
    v_mfma_f32_16x16x32_bf16 v[80:83], a[164:167], v[152:155], v[80:83]
    v_and_b32 v9, 1, v2
    v_lshl_add_u32 v5, v9, 4, v5
    v_lshrrev_b32 v9, 1, v3
    v_mfma_f32_16x16x32_bf16 v[84:87], a[164:167], v[156:159], v[84:87]
    v_lshl_add_u32 v5, v9, 5, v5
    v_lshlrev_b32 v8, 4, v5
    s_lshl_b32 s48, s29, 16
    v_mfma_f32_16x16x32_bf16 v[72:75], a[176:179], v[160:163], v[72:75]
    s_lshl_b32 s45, s35, 10
    s_add_u32 s48, s48, s45
    s_add_u32 s48, s48, 0x00200000
    v_mfma_f32_16x16x32_bf16 v[76:79], a[176:179], v[164:167], v[76:79]
    s_lshr_b32 s45, s28, 1
    s_lshl_b32 s45, s45, 15
    s_add_u32 s46, s48, s45
    v_mfma_f32_16x16x32_bf16 v[80:83], a[176:179], v[168:171], v[80:83]
    s_xor_b32 s45, s45, 32768
    s_add_u32 s47, s48, s45
    ds_read_b64 v[192:193], v24 offset:0
    v_mfma_f32_16x16x32_bf16 v[84:87], a[176:179], v[172:175], v[84:87]
    ds_read_b64 v[194:195], v24 offset:512
    ds_read_b64 v[196:197], v25 offset:0
    ds_read_b64 v[198:199], v25 offset:512
    v_mfma_f32_16x16x32_bf16 v[72:75], a[188:191], v[176:179], v[72:75]
    ds_read_b64 v[200:201], v26 offset:0
    ds_read_b64 v[202:203], v26 offset:512
    ds_read_b64 v[204:205], v27 offset:0
    v_mfma_f32_16x16x32_bf16 v[76:79], a[188:191], v[180:183], v[76:79]
    ds_read_b64 v[206:207], v27 offset:512
    ds_read_b64 v[208:209], v24 offset:4608
    ds_read_b64 v[210:211], v24 offset:5120
    v_mfma_f32_16x16x32_bf16 v[80:83], a[188:191], v[184:187], v[80:83]
    ds_read_b64 v[212:213], v25 offset:4608
    ds_read_b64 v[214:215], v25 offset:5120
    ds_read_b64 v[216:217], v26 offset:4608
    v_mfma_f32_16x16x32_bf16 v[84:87], a[188:191], v[188:191], v[84:87]
    ds_read_b64 v[218:219], v26 offset:5120
    ds_read_b64 v[220:221], v27 offset:4608
    ds_read_b64 v[222:223], v27 offset:5120
    s_waitcnt lgkmcnt(8)
    v_mfma_f32_16x16x32_bf16 v[72:75], a[8:11], v[192:195], v[72:75]
    ds_read_b64 v[96:97], v24 offset:9216
    ds_read_b64 v[98:99], v24 offset:9728
    v_mfma_f32_16x16x32_bf16 v[76:79], a[8:11], v[196:199], v[76:79]
    ds_read_b64 v[100:101], v25 offset:9216
    ds_read_b64 v[102:103], v25 offset:9728
    v_mfma_f32_16x16x32_bf16 v[80:83], a[8:11], v[200:203], v[80:83]
    ds_read_b64 v[104:105], v26 offset:9216
    ds_read_b64 v[106:107], v26 offset:9728
    v_mfma_f32_16x16x32_bf16 v[84:87], a[8:11], v[204:207], v[84:87]
    ds_read_b64 v[108:109], v27 offset:9216
    ds_read_b64 v[110:111], v27 offset:9728
    s_waitcnt lgkmcnt(8)
    v_mfma_f32_16x16x32_bf16 v[72:75], a[20:23], v[208:211], v[72:75]
    ds_read_b64 v[192:193], v24 offset:13824
    ds_read_b64 v[194:195], v24 offset:14336
    v_mfma_f32_16x16x32_bf16 v[76:79], a[20:23], v[212:215], v[76:79]
    ds_read_b64 v[196:197], v25 offset:13824
    ds_read_b64 v[198:199], v25 offset:14336
    v_mfma_f32_16x16x32_bf16 v[80:83], a[20:23], v[216:219], v[80:83]
    ds_read_b64 v[200:201], v26 offset:13824
    ds_read_b64 v[202:203], v26 offset:14336
    v_mfma_f32_16x16x32_bf16 v[84:87], a[20:23], v[220:223], v[84:87]
    ds_read_b64 v[204:205], v27 offset:13824
    ds_read_b64 v[206:207], v27 offset:14336
    s_waitcnt lgkmcnt(8)
    v_mfma_f32_16x16x32_bf16 v[72:75], a[32:35], v[96:99], v[72:75]
    ds_read_b64 v[208:209], v24 offset:18432
    ds_read_b64 v[210:211], v24 offset:18944
    v_mfma_f32_16x16x32_bf16 v[76:79], a[32:35], v[100:103], v[76:79]
    ds_read_b64 v[212:213], v25 offset:18432
    ds_read_b64 v[214:215], v25 offset:18944
    v_mfma_f32_16x16x32_bf16 v[80:83], a[32:35], v[104:107], v[80:83]
    ds_read_b64 v[216:217], v26 offset:18432
    ds_read_b64 v[218:219], v26 offset:18944
    v_mfma_f32_16x16x32_bf16 v[84:87], a[32:35], v[108:111], v[84:87]
    ds_read_b64 v[220:221], v27 offset:18432
    ds_read_b64 v[222:223], v27 offset:18944
    s_waitcnt lgkmcnt(8)
    v_mfma_f32_16x16x32_bf16 v[72:75], a[44:47], v[192:195], v[72:75]
    ds_read_b64 v[96:97], v24 offset:23040
    ds_read_b64 v[98:99], v24 offset:23552
    v_mfma_f32_16x16x32_bf16 v[76:79], a[44:47], v[196:199], v[76:79]
    ds_read_b64 v[100:101], v25 offset:23040
    ds_read_b64 v[102:103], v25 offset:23552
    v_mfma_f32_16x16x32_bf16 v[80:83], a[44:47], v[200:203], v[80:83]
    ds_read_b64 v[104:105], v26 offset:23040
    ds_read_b64 v[106:107], v26 offset:23552
    v_mfma_f32_16x16x32_bf16 v[84:87], a[44:47], v[204:207], v[84:87]
    ds_read_b64 v[108:109], v27 offset:23040
    ds_read_b64 v[110:111], v27 offset:23552
    s_waitcnt lgkmcnt(8)
    v_mfma_f32_16x16x32_bf16 v[72:75], a[56:59], v[208:211], v[72:75]
    ds_read_b64 v[192:193], v24 offset:27648
    ds_read_b64 v[194:195], v24 offset:28160
    v_mfma_f32_16x16x32_bf16 v[76:79], a[56:59], v[212:215], v[76:79]
    ds_read_b64 v[196:197], v25 offset:27648
    ds_read_b64 v[198:199], v25 offset:28160
    v_mfma_f32_16x16x32_bf16 v[80:83], a[56:59], v[216:219], v[80:83]
    ds_read_b64 v[200:201], v26 offset:27648
    ds_read_b64 v[202:203], v26 offset:28160
    v_mfma_f32_16x16x32_bf16 v[84:87], a[56:59], v[220:223], v[84:87]
    ds_read_b64 v[204:205], v27 offset:27648
    ds_read_b64 v[206:207], v27 offset:28160
    s_waitcnt lgkmcnt(8)
    v_mfma_f32_16x16x32_bf16 v[72:75], a[68:71], v[96:99], v[72:75]
    ds_read_b64 v[208:209], v24 offset:32256
    ds_read_b64 v[210:211], v24 offset:32768
    v_mfma_f32_16x16x32_bf16 v[76:79], a[68:71], v[100:103], v[76:79]
    ds_read_b64 v[212:213], v25 offset:32256
    ds_read_b64 v[214:215], v25 offset:32768
    v_mfma_f32_16x16x32_bf16 v[80:83], a[68:71], v[104:107], v[80:83]
    ds_read_b64 v[216:217], v26 offset:32256
    ds_read_b64 v[218:219], v26 offset:32768
    v_mfma_f32_16x16x32_bf16 v[84:87], a[68:71], v[108:111], v[84:87]
    ds_read_b64 v[220:221], v27 offset:32256
    ds_read_b64 v[222:223], v27 offset:32768
    s_waitcnt lgkmcnt(8)
    v_mfma_f32_16x16x32_bf16 v[72:75], a[80:83], v[192:195], v[72:75]
    ds_read_b64 v[96:97], v24 offset:36864
    ds_read_b64 v[98:99], v24 offset:37376
    v_mfma_f32_16x16x32_bf16 v[76:79], a[80:83], v[196:199], v[76:79]
    ds_read_b64 v[100:101], v25 offset:36864
    ds_read_b64 v[102:103], v25 offset:37376
    v_mfma_f32_16x16x32_bf16 v[80:83], a[80:83], v[200:203], v[80:83]
    ds_read_b64 v[104:105], v26 offset:36864
    ds_read_b64 v[106:107], v26 offset:37376
    v_mfma_f32_16x16x32_bf16 v[84:87], a[80:83], v[204:207], v[84:87]
    ds_read_b64 v[108:109], v27 offset:36864
    ds_read_b64 v[110:111], v27 offset:37376
    s_waitcnt lgkmcnt(8)
    v_mfma_f32_16x16x32_bf16 v[72:75], a[92:95], v[208:211], v[72:75]
    ds_read_b64 v[192:193], v24 offset:41472
    ds_read_b64 v[194:195], v24 offset:41984
    v_mfma_f32_16x16x32_bf16 v[76:79], a[92:95], v[212:215], v[76:79]
    ds_read_b64 v[196:197], v25 offset:41472
    ds_read_b64 v[198:199], v25 offset:41984
    v_mfma_f32_16x16x32_bf16 v[80:83], a[92:95], v[216:219], v[80:83]
    ds_read_b64 v[200:201], v26 offset:41472
    ds_read_b64 v[202:203], v26 offset:41984
    v_mfma_f32_16x16x32_bf16 v[84:87], a[92:95], v[220:223], v[84:87]
    ds_read_b64 v[204:205], v27 offset:41472
    ds_read_b64 v[206:207], v27 offset:41984
    s_waitcnt lgkmcnt(8)
    v_mfma_f32_16x16x32_bf16 v[72:75], a[104:107], v[96:99], v[72:75]
    v_mfma_f32_16x16x32_bf16 v[76:79], a[104:107], v[100:103], v[76:79]
    v_mfma_f32_16x16x32_bf16 v[80:83], a[104:107], v[104:107], v[80:83]
    v_mfma_f32_16x16x32_bf16 v[84:87], a[104:107], v[108:111], v[84:87]
    s_waitcnt lgkmcnt(0)
    v_mfma_f32_16x16x32_bf16 v[72:75], a[116:119], v[192:195], v[72:75]
    v_mfma_f32_16x16x32_bf16 v[76:79], a[116:119], v[196:199], v[76:79]
    v_mfma_f32_16x16x32_bf16 v[80:83], a[116:119], v[200:203], v[80:83]
    v_mfma_f32_16x16x32_bf16 v[84:87], a[116:119], v[204:207], v[84:87]
    v_pk_fma_f32 v[30:31], v[252:253], v[224:225], v[36:37] op_sel:[0,1,0] op_sel_hi:[1,1,0]
    s_nop 3
    v_pk_fma_f32 v[72:73], v[72:73], v[224:225], v[30:31] op_sel_hi:[1,0,1]
    v_pk_fma_f32 v[32:33], v[72:73], s[58:59], v[36:37] op_sel:[0,0,1] op_sel_hi:[1,1,1]
    v_exp_f32 v32, v32 clamp
    v_exp_f32 v33, v33 clamp
    v_max_f32 v72, v72, v36
    v_max_f32 v73, v73, v36
    v_pk_add_f32 v[72:73], v[72:73], v[32:33]
    v_cvt_pk_bf16_f32 v120, v72, v73
    v_pk_fma_f32 v[30:31], v[254:255], v[224:225], v[36:37] op_sel:[0,1,0] op_sel_hi:[1,1,0]
    v_pk_fma_f32 v[74:75], v[74:75], v[224:225], v[30:31] op_sel_hi:[1,0,1]
    v_pk_fma_f32 v[32:33], v[74:75], s[58:59], v[36:37] op_sel:[0,0,1] op_sel_hi:[1,1,1]
    v_exp_f32 v32, v32 clamp
    v_exp_f32 v33, v33 clamp
    v_max_f32 v74, v74, v36
    v_max_f32 v75, v75, v36
    v_pk_add_f32 v[74:75], v[74:75], v[32:33]
    v_cvt_pk_bf16_f32 v121, v74, v75
    v_pk_fma_f32 v[30:31], v[252:253], v[226:227], v[36:37] op_sel:[0,1,0] op_sel_hi:[1,1,0]
    v_pk_fma_f32 v[76:77], v[76:77], v[226:227], v[30:31] op_sel_hi:[1,0,1]
    v_pk_fma_f32 v[32:33], v[76:77], s[58:59], v[36:37] op_sel:[0,0,1] op_sel_hi:[1,1,1]
    v_exp_f32 v32, v32 clamp
    v_exp_f32 v33, v33 clamp
    v_max_f32 v76, v76, v36
    v_max_f32 v77, v77, v36
    v_pk_add_f32 v[76:77], v[76:77], v[32:33]
    v_cvt_pk_bf16_f32 v122, v76, v77
    v_pk_fma_f32 v[30:31], v[254:255], v[226:227], v[36:37] op_sel:[0,1,0] op_sel_hi:[1,1,0]
    v_pk_fma_f32 v[78:79], v[78:79], v[226:227], v[30:31] op_sel_hi:[1,0,1]
    v_pk_fma_f32 v[32:33], v[78:79], s[58:59], v[36:37] op_sel:[0,0,1] op_sel_hi:[1,1,1]
    v_exp_f32 v32, v32 clamp
    v_exp_f32 v33, v33 clamp
    v_max_f32 v78, v78, v36
    v_max_f32 v79, v79, v36
    v_pk_add_f32 v[78:79], v[78:79], v[32:33]
    v_cvt_pk_bf16_f32 v123, v78, v79
    v_permlane16_swap_b32 v120, v122
    s_nop 0
    v_permlane16_swap_b32 v121, v123
    buffer_store_dwordx4 v[120:123], v8, s[16:19], s46 offen sc1
    v_pk_fma_f32 v[30:31], v[252:253], v[228:229], v[36:37] op_sel:[0,1,0] op_sel_hi:[1,1,0]
    v_pk_fma_f32 v[80:81], v[80:81], v[228:229], v[30:31] op_sel_hi:[1,0,1]
    v_pk_fma_f32 v[32:33], v[80:81], s[58:59], v[36:37] op_sel:[0,0,1] op_sel_hi:[1,1,1]
    v_exp_f32 v32, v32 clamp
    v_exp_f32 v33, v33 clamp
    v_max_f32 v80, v80, v36
    v_max_f32 v81, v81, v36
    v_pk_add_f32 v[80:81], v[80:81], v[32:33]
    v_cvt_pk_bf16_f32 v124, v80, v81
    v_pk_fma_f32 v[30:31], v[254:255], v[228:229], v[36:37] op_sel:[0,1,0] op_sel_hi:[1,1,0]
    v_pk_fma_f32 v[82:83], v[82:83], v[228:229], v[30:31] op_sel_hi:[1,0,1]
    v_pk_fma_f32 v[32:33], v[82:83], s[58:59], v[36:37] op_sel:[0,0,1] op_sel_hi:[1,1,1]
    v_exp_f32 v32, v32 clamp
    v_exp_f32 v33, v33 clamp
    v_max_f32 v82, v82, v36
    v_max_f32 v83, v83, v36
    v_pk_add_f32 v[82:83], v[82:83], v[32:33]
    v_cvt_pk_bf16_f32 v125, v82, v83
    v_pk_fma_f32 v[30:31], v[252:253], v[230:231], v[36:37] op_sel:[0,1,0] op_sel_hi:[1,1,0]
    v_pk_fma_f32 v[84:85], v[84:85], v[230:231], v[30:31] op_sel_hi:[1,0,1]
    v_pk_fma_f32 v[32:33], v[84:85], s[58:59], v[36:37] op_sel:[0,0,1] op_sel_hi:[1,1,1]
    v_exp_f32 v32, v32 clamp
    v_exp_f32 v33, v33 clamp
    v_max_f32 v84, v84, v36
    v_max_f32 v85, v85, v36
    v_pk_add_f32 v[84:85], v[84:85], v[32:33]
    v_cvt_pk_bf16_f32 v126, v84, v85
    v_pk_fma_f32 v[30:31], v[254:255], v[230:231], v[36:37] op_sel:[0,1,0] op_sel_hi:[1,1,0]
    v_pk_fma_f32 v[86:87], v[86:87], v[230:231], v[30:31] op_sel_hi:[1,0,1]
    v_pk_fma_f32 v[32:33], v[86:87], s[58:59], v[36:37] op_sel:[0,0,1] op_sel_hi:[1,1,1]
    v_exp_f32 v32, v32 clamp
    v_exp_f32 v33, v33 clamp
    v_max_f32 v86, v86, v36
    v_max_f32 v87, v87, v36
    v_pk_add_f32 v[86:87], v[86:87], v[32:33]
    v_cvt_pk_bf16_f32 v127, v86, v87
    v_permlane16_swap_b32 v124, v126
    s_nop 0
    v_permlane16_swap_b32 v125, v127
    buffer_store_dwordx4 v[124:127], v8, s[16:19], s47 offen sc1
    s_mul_i32 s64, s28, 16640
    v_sub_u32 v5, 15, v2
    v_and_b32 v6, 3, v5
    v_sub_u32 v5, v5, v6
    v_lshl_add_u32 v5, v3, 3, v5
    v_lshlrev_b32 v5, 1, v5
    v_mul_u32_u24 v6, 4160, v6
    v_add3_u32 v13, v5, v6, s64
    ds_read_b64 a[0:1], v13 offset:4032
    ds_read_b64 a[2:3], v13 offset:4040
    ds_read_b64 a[4:5], v13 offset:3968
    ds_read_b64 a[6:7], v13 offset:3976
    ds_read_b64 a[8:9], v13 offset:3904
    ds_read_b64 a[10:11], v13 offset:3912
    ds_read_b64 a[12:13], v13 offset:3840
    ds_read_b64 a[14:15], v13 offset:3848
    ds_read_b64 a[16:17], v13 offset:3776
    ds_read_b64 a[18:19], v13 offset:3784
    ds_read_b64 a[20:21], v13 offset:3712
    ds_read_b64 a[22:23], v13 offset:3720
    ds_read_b64 a[24:25], v13 offset:3648
    ds_read_b64 a[26:27], v13 offset:3656
    ds_read_b64 a[28:29], v13 offset:3584
    ds_read_b64 a[30:31], v13 offset:3592
    ds_read_b64 a[32:33], v13 offset:3520
    ds_read_b64 a[34:35], v13 offset:3528
    ds_read_b64 a[36:37], v13 offset:3456
    ds_read_b64 a[38:39], v13 offset:3464
    ds_read_b64 a[40:41], v13 offset:3392
    ds_read_b64 a[42:43], v13 offset:3400
    ds_read_b64 a[44:45], v13 offset:3328
    ds_read_b64 a[46:47], v13 offset:3336
    ds_read_b64 a[48:49], v13 offset:3264
    ds_read_b64 a[50:51], v13 offset:3272
    ds_read_b64 a[52:53], v13 offset:3200
    ds_read_b64 a[54:55], v13 offset:3208
    ds_read_b64 a[56:57], v13 offset:3136
    ds_read_b64 a[58:59], v13 offset:3144
    ds_read_b64 a[60:61], v13 offset:3072
    ds_read_b64 a[62:63], v13 offset:3080
    s_and_b32 s40, s2, 15
    s_lshl_b32 s40, s40, 8
    s_add_u32 s40, s40, 0x00f1b000
    v_mov_b32 v236, 0
    v_cmp_eq_u32 vcc, 0, v0
    s_nop 1
    v_cndmask_b32 v232, v4, v236, vcc
    v_mov_b32 v236, 1
    s_waitcnt vmcnt(0) lgkmcnt(0)
    s_barrier
    buffer_atomic_add v236, v232, s[16:19], s40 offen sc1
    s_mul_i32 s64, s28, 16640
    v_sub_u32 v5, 15, v2
    v_and_b32 v6, 3, v5
    v_sub_u32 v5, v5, v6
    v_lshl_add_u32 v5, v3, 3, v5
    v_lshlrev_b32 v5, 1, v5
    v_mul_u32_u24 v6, 4160, v6
    v_add3_u32 v13, v5, v6, s64
    ds_read_b64 a[64:65], v13 offset:3008
    ds_read_b64 a[66:67], v13 offset:3016
    ds_read_b64 a[68:69], v13 offset:2944
    ds_read_b64 a[70:71], v13 offset:2952
    ds_read_b64 a[72:73], v13 offset:2880
    ds_read_b64 a[74:75], v13 offset:2888
    ds_read_b64 a[76:77], v13 offset:2816
    ds_read_b64 a[78:79], v13 offset:2824
    ds_read_b64 a[80:81], v13 offset:2752
    ds_read_b64 a[82:83], v13 offset:2760
    ds_read_b64 a[84:85], v13 offset:2688
    ds_read_b64 a[86:87], v13 offset:2696
    ds_read_b64 a[88:89], v13 offset:2624
    ds_read_b64 a[90:91], v13 offset:2632
    ds_read_b64 a[92:93], v13 offset:2560
    ds_read_b64 a[94:95], v13 offset:2568
    ds_read_b64 a[96:97], v13 offset:2496
    ds_read_b64 a[98:99], v13 offset:2504
    ds_read_b64 a[100:101], v13 offset:2432
    ds_read_b64 a[102:103], v13 offset:2440
    ds_read_b64 a[104:105], v13 offset:2368
    ds_read_b64 a[106:107], v13 offset:2376
    ds_read_b64 a[108:109], v13 offset:2304
    ds_read_b64 a[110:111], v13 offset:2312
    ds_read_b64 a[112:113], v13 offset:2240
    ds_read_b64 a[114:115], v13 offset:2248
    ds_read_b64 a[116:117], v13 offset:2176
    ds_read_b64 a[118:119], v13 offset:2184
    ds_read_b64 a[120:121], v13 offset:2112
    ds_read_b64 a[122:123], v13 offset:2120
    ds_read_b64 a[124:125], v13 offset:2048
    ds_read_b64 a[126:127], v13 offset:2056
    ds_read_b64 a[128:129], v13 offset:1984
    ds_read_b64 a[130:131], v13 offset:1992
    v_lshlrev_b32 v10, 4, v1
    v_and_b32 v5, 31, v1
    v_lshrrev_b32 v6, 5, v1
    v_lshrrev_b32 v7, 4, v5
    v_lshl_add_u32 v12, v2, 1, v7
    s_lshr_b32 s45, s28, 1
    s_lshl_b32 s45, s45, 5
    s_lshl_b32 s46, s31, 6
    s_add_u32 s52, s45, s46
    s_and_b32 s45, s28, 1
    s_lshl_b32 s45, s45, 3
    s_lshl_b32 s46, s32, 4
    s_add_u32 s53, s45, s46
    s_mov_b32 s55, s52
    v_lshlrev_b32 v13, 14, v6
    v_lshl_add_u32 v13, v12, 3, v13
    s_lshl_b32 s54, s53, 14
    s_lshl_b32 s45, s55, 3
    s_add_u32 s54, s54, s45
    s_add_u32 s54, s54, 0x00800000
    s_add_u32 s65, s54, 0
    buffer_load_dwordx2 v[216:217], v13, s[16:19], s65 offen sc1
    s_add_u32 s65, s54, 32768
    buffer_load_dwordx2 v[218:219], v13, s[16:19], s65 offen sc1
    s_add_u32 s65, s54, 65536
    buffer_load_dwordx2 v[220:221], v13, s[16:19], s65 offen sc1
    s_add_u32 s65, s54, 98304
    buffer_load_dwordx2 v[222:223], v13, s[16:19], s65 offen sc1
    s_mul_i32 s64, s28, 9216
    s_add_u32 s64, s64, 66560
    v_min_u32 v7, 16, v5
    v_lshlrev_b32 v7, 6, v7
    v_lshl_add_u32 v7, v6, 5, v7
    v_add_u32 v11, s64, v7
    s_mul_i32 s62, s28, 8704
    s_add_u32 s62, s62, 0x00f09000
    s_lshl_b32 s44, s31, 16
    s_lshl_b32 s45, s28, 13
    s_add_u32 s44, s44, s45
    s_add_u32 s44, s44, 0x00200000
    s_lshr_b32 s45, s28, 1
    s_lshl_b32 s45, s45, 15
    s_add_u32 s50, s44, s45
    s_add_u32 s51, s50, 4096
    s_xor_b32 s45, s45, 32768
    s_add_u32 s48, s44, s45
    s_add_u32 s49, s48, 4096
    v_mov_b32 v14, 0x358637bd
    s_mul_i32 s45, s28, 12288
    s_add_u32 s45, s45, 103424
    v_add_u32 v15, s45, v10
    s_xor_b32 s45, s28, 2
    s_mul_i32 s45, s45, 12288
    s_add_u32 s45, s45, 103424
    v_add_u32 v233, s45, v10
    s_xor_b32 s45, s28, 1
    s_mul_i32 s45, s45, 12288
    s_add_u32 s45, s45, 103424
    v_add_u32 v234, s45, v10
    s_xor_b32 s45, s28, 3
    s_mul_i32 s45, s45, 12288
    s_add_u32 s45, s45, 103424
    v_add_u32 v13, s45, v10
    v_bfe_u32 v7, v1, 4, 1
    v_lshl_add_u32 v7, v7, 1, v6
    v_lshlrev_b32 v7, 14, v7
    v_lshl_add_u32 v235, v2, 4, v7
    s_lshl_b32 s56, s53, 14
    s_lshl_b32 s45, s52, 3
    s_add_u32 s56, s56, s45
    s_add_u32 s56, s56, 0x00600000
    s_add_u32 s57, s56, 65536
    s_add_u32 s58, s45, 0x00f16000
    v_lshlrev_b32 v12, 4, v2
    v_lshl_add_u32 v12, v3, 2, v12
    v_mov_b32 v8, 0
    v_mov_b32 v9, 0
    s_waitcnt vmcnt(3)
    v_lshlrev_b32 v16, 16, v216
    v_and_b32 v17, 0xffff0000, v216
    v_lshlrev_b32 v18, 16, v217
    v_and_b32 v19, 0xffff0000, v217
    s_waitcnt vmcnt(2)
    v_lshlrev_b32 v20, 16, v218
    v_and_b32 v21, 0xffff0000, v218
    v_lshlrev_b32 v22, 16, v219
    v_and_b32 v23, 0xffff0000, v219
    s_waitcnt vmcnt(1)
    v_lshlrev_b32 v24, 16, v220
    v_and_b32 v25, 0xffff0000, v220
    v_lshlrev_b32 v26, 16, v221
    v_and_b32 v27, 0xffff0000, v221
    s_waitcnt vmcnt(0)
    v_lshlrev_b32 v28, 16, v222
    v_and_b32 v29, 0xffff0000, v222
    v_lshlrev_b32 v30, 16, v223
    v_and_b32 v31, 0xffff0000, v223
    s_mov_b32 m0, s64
    s_cmp_lg_u32 s28, 0
    s_cbranch_scc1 L_gw3_done
    v_mov_b32 v232, 0
    s_mov_b32 s46, 0x80000
    s_cmp_lg_u32 s43, 0
    s_cbranch_scc1 L_gw3_poll
    s_mov_b32 s45, 0x00f1b000
    v_lshlrev_b32 v237, 8, v1
    v_cmp_gt_u32 vcc, 16, v1
    s_nop 1
    v_cndmask_b32 v237, v4, v237, vcc
L_gw3_mp:
    v_mov_b32 v236, 0
    buffer_atomic_add v236, v237, s[16:19], s45 offen sc0 sc1
    s_waitcnt vmcnt(0)
    v_cmp_gt_u32 vcc, 64, v236
    s_sub_u32 s46, s46, 1
    s_cbranch_scc1 L_gw3_done
    s_and_b32 s40, vcc_lo, 0xffff
    s_cbranch_scc1 L_gw3_mp
    v_mov_b32 v237, 4
    buffer_store_dword v237, v232, s[16:19], s42 offen
    s_branch L_gw3_done
L_gw3_poll:
    buffer_load_dword v236, v232, s[16:19], s42 offen sc1
    s_waitcnt vmcnt(0)
    v_readfirstlane_b32 s45, v236
    s_sub_u32 s46, s46, 1
    s_cbranch_scc1 L_gw3_done
    s_cmp_lt_u32 s45, 4
    s_cbranch_scc1 L_gw3_poll
L_gw3_done:
    s_waitcnt lgkmcnt(0)
    s_barrier
    buffer_load_dwordx4 v10, s[16:19], s62 offen offset:0 sc1 lds
    buffer_load_dwordx4 v10, s[16:19], s62 offen offset:1024 sc1 lds
    buffer_load_dwordx4 v[144:147], v10, s[16:19], s48 offen offset:0 sc1
    buffer_load_dwordx4 v10, s[16:19], s62 offen offset:2048 sc1 lds
    buffer_load_dwordx4 v[148:151], v10, s[16:19], s48 offen offset:1024 sc1
    buffer_load_dwordx4 v10, s[16:19], s62 offen offset:3072 sc1 lds
    buffer_load_dwordx4 v[152:155], v10, s[16:19], s48 offen offset:2048 sc1
    s_add_u32 m0, s64, 4096
    s_add_u32 s62, s62, 4096
    buffer_load_dwordx4 v10, s[16:19], s62 offen offset:0 sc1 lds
    buffer_load_dwordx4 v[156:159], v10, s[16:19], s48 offen offset:3072 sc1
    buffer_load_dwordx4 v10, s[16:19], s62 offen offset:1024 sc1 lds
    buffer_load_dwordx4 v[160:163], v10, s[16:19], s49 offen offset:0 sc1
    buffer_load_dwordx4 v10, s[16:19], s62 offen offset:2048 sc1 lds
    buffer_load_dwordx4 v[164:167], v10, s[16:19], s49 offen offset:1024 sc1
    s_waitcnt vmcnt(11)
    ds_read_b128 v[224:227], v11 offset:0
    ds_read_b128 v[228:231], v11 offset:16
    s_waitcnt lgkmcnt(1)
    v_cvt_pk_bf16_f32 v112, v224, v225
    v_cvt_pk_bf16_f32 v113, v226, v227
    s_waitcnt lgkmcnt(0)
    v_cvt_pk_bf16_f32 v114, v228, v229
    v_cvt_pk_bf16_f32 v115, v230, v231
    s_waitcnt vmcnt(10)
    s_nop 0
    v_mfma_f32_32x32x16_bf16 v[80:95], v[112:115], v[144:147], 0
    s_waitcnt vmcnt(9)
    ds_read_b128 v[224:227], v11 offset:1088
    ds_read_b128 v[228:231], v11 offset:1104
    s_waitcnt lgkmcnt(1)
    v_cvt_pk_bf16_f32 v116, v224, v225
    v_cvt_pk_bf16_f32 v117, v226, v227
    s_waitcnt lgkmcnt(0)
    v_cvt_pk_bf16_f32 v118, v228, v229
    v_cvt_pk_bf16_f32 v119, v230, v231
    s_waitcnt vmcnt(8)
    s_nop 0
    v_mfma_f32_32x32x16_bf16 v[96:111], v[116:119], v[148:151], 0
    buffer_load_dwordx4 v10, s[16:19], s62 offen offset:3072 sc1 lds
    v_add_f32 v88, v88, v14
    v_rcp_f32 v88, v88
    s_nop 0
    v_mul_f32 v80, v80, v88
    v_mul_f32 v81, v81, v88
    v_cvt_pk_bf16_f32 v208, v80, v81
    buffer_load_dwordx4 v[168:171], v10, s[16:19], s49 offen offset:2048 sc1
    s_waitcnt vmcnt(9)
    ds_read_b128 v[224:227], v11 offset:2176
    ds_read_b128 v[228:231], v11 offset:2192
    v_mul_f32 v82, v82, v88
    v_mul_f32 v83, v83, v88
    v_cvt_pk_bf16_f32 v209, v82, v83
    v_mul_f32 v84, v84, v88
    v_mul_f32 v85, v85, v88
    v_cvt_pk_bf16_f32 v210, v84, v85
    v_mul_f32 v86, v86, v88
    v_mul_f32 v87, v87, v88
    v_cvt_pk_bf16_f32 v211, v86, v87
    s_waitcnt lgkmcnt(1)
    v_cvt_pk_bf16_f32 v120, v224, v225
    v_cvt_pk_bf16_f32 v121, v226, v227
    s_waitcnt lgkmcnt(0)
    v_cvt_pk_bf16_f32 v122, v228, v229
    v_cvt_pk_bf16_f32 v123, v230, v231
    s_waitcnt vmcnt(8)
    s_nop 0
    v_mfma_f32_32x32x16_bf16 v[80:95], v[120:123], v[152:155], 0
    s_add_u32 m0, s64, 8192
    s_add_u32 s62, s62, 4096
    buffer_load_dwordx4 v10, s[16:19], s62 offen offset:0 sc1 lds
    v_add_f32 v104, v104, v14
    v_rcp_f32 v104, v104
    s_nop 0
    v_mul_f32 v96, v96, v104
    v_mul_f32 v97, v97, v104
    v_cvt_pk_bf16_f32 v212, v96, v97
    v_mfma_f32_32x32x16_bf16 v[64:79], a[196:199], v[208:211], 0
    buffer_load_dwordx4 v[172:175], v10, s[16:19], s49 offen offset:3072 sc1
    s_waitcnt vmcnt(9)
    ds_read_b128 v[224:227], v11 offset:3264
    ds_read_b128 v[228:231], v11 offset:3280
    v_mul_f32 v98, v98, v104
    v_mul_f32 v99, v99, v104
    v_cvt_pk_bf16_f32 v213, v98, v99
    v_mul_f32 v100, v100, v104
    v_mul_f32 v101, v101, v104
    v_mfma_f32_32x32x16_bf16 v[48:63], a[192:195], v[208:211], 0
    v_cvt_pk_bf16_f32 v214, v100, v101
    v_mul_f32 v102, v102, v104
    v_mul_f32 v103, v103, v104
    v_cvt_pk_bf16_f32 v215, v102, v103
    s_waitcnt lgkmcnt(1)
    v_cvt_pk_bf16_f32 v124, v224, v225
    v_cvt_pk_bf16_f32 v125, v226, v227
    s_waitcnt lgkmcnt(0)
    v_cvt_pk_bf16_f32 v126, v228, v229
    v_cvt_pk_bf16_f32 v127, v230, v231
    s_waitcnt vmcnt(8)
    s_nop 0
    v_mfma_f32_32x32x16_bf16 v[96:111], v[124:127], v[156:159], 0
    buffer_load_dwordx4 v[176:179], v10, s[16:19], s50 offen offset:0 sc1
    v_add_f32 v88, v88, v14
    v_rcp_f32 v88, v88
    s_nop 0
    v_mul_f32 v80, v80, v88
    v_mul_f32 v81, v81, v88
    v_cvt_pk_bf16_f32 v208, v80, v81
    v_mfma_f32_32x32x16_bf16 v[64:79], a[204:207], v[212:215], v[64:79]
    buffer_load_dwordx4 v[180:183], v10, s[16:19], s50 offen offset:1024 sc1
    s_waitcnt vmcnt(9)
    ds_read_b128 v[224:227], v11 offset:4352
    ds_read_b128 v[228:231], v11 offset:4368
    v_mul_f32 v82, v82, v88
    v_mul_f32 v83, v83, v88
    v_cvt_pk_bf16_f32 v209, v82, v83
    v_mul_f32 v84, v84, v88
    v_mul_f32 v85, v85, v88
    v_mfma_f32_32x32x16_bf16 v[48:63], a[200:203], v[212:215], v[48:63]
    v_cvt_pk_bf16_f32 v210, v84, v85
    v_mul_f32 v86, v86, v88
    v_mul_f32 v87, v87, v88
    v_cvt_pk_bf16_f32 v211, v86, v87
    s_waitcnt lgkmcnt(1)
    v_cvt_pk_bf16_f32 v128, v224, v225
    v_cvt_pk_bf16_f32 v129, v226, v227
    s_waitcnt lgkmcnt(0)
    v_cvt_pk_bf16_f32 v130, v228, v229
    v_cvt_pk_bf16_f32 v131, v230, v231
    s_waitcnt vmcnt(8)
    s_nop 0
    v_mfma_f32_32x32x16_bf16 v[80:95], v[128:131], v[160:163], 0
    buffer_load_dwordx4 v[184:187], v10, s[16:19], s50 offen offset:2048 sc1
    v_add_f32 v104, v104, v14
    v_rcp_f32 v104, v104
    s_nop 0
    v_mul_f32 v96, v96, v104
    v_mul_f32 v97, v97, v104
    v_cvt_pk_bf16_f32 v212, v96, v97
    v_mfma_f32_32x32x16_bf16 v[64:79], a[212:215], v[208:211], v[64:79]
    buffer_load_dwordx4 v[188:191], v10, s[16:19], s50 offen offset:3072 sc1
    s_waitcnt vmcnt(9)
    ds_read_b128 v[224:227], v11 offset:5440
    ds_read_b128 v[228:231], v11 offset:5456
    v_mul_f32 v98, v98, v104
    v_mul_f32 v99, v99, v104
    v_cvt_pk_bf16_f32 v213, v98, v99
    v_mul_f32 v100, v100, v104
    v_mul_f32 v101, v101, v104
    v_mfma_f32_32x32x16_bf16 v[48:63], a[208:211], v[208:211], v[48:63]
    v_cvt_pk_bf16_f32 v214, v100, v101
    v_mul_f32 v102, v102, v104
    v_mul_f32 v103, v103, v104
    v_cvt_pk_bf16_f32 v215, v102, v103
    s_waitcnt lgkmcnt(1)
    v_cvt_pk_bf16_f32 v132, v224, v225
    v_cvt_pk_bf16_f32 v133, v226, v227
    s_waitcnt lgkmcnt(0)
    v_cvt_pk_bf16_f32 v134, v228, v229
    v_cvt_pk_bf16_f32 v135, v230, v231
    s_waitcnt vmcnt(8)
    s_nop 0
    v_mfma_f32_32x32x16_bf16 v[96:111], v[132:135], v[164:167], 0
    buffer_load_dwordx4 v[192:195], v10, s[16:19], s51 offen offset:0 sc1
    v_add_f32 v88, v88, v14
    v_rcp_f32 v88, v88
    s_nop 0
    v_mul_f32 v80, v80, v88
    v_mul_f32 v81, v81, v88
    v_cvt_pk_bf16_f32 v208, v80, v81
    v_mfma_f32_32x32x16_bf16 v[64:79], a[220:223], v[212:215], v[64:79]
    buffer_load_dwordx4 v[196:199], v10, s[16:19], s51 offen offset:1024 sc1
    s_waitcnt vmcnt(9)
    ds_read_b128 v[224:227], v11 offset:6528
    ds_read_b128 v[228:231], v11 offset:6544
    v_mul_f32 v82, v82, v88
    v_mul_f32 v83, v83, v88
    v_cvt_pk_bf16_f32 v209, v82, v83
    v_mul_f32 v84, v84, v88
    v_mul_f32 v85, v85, v88
    v_mfma_f32_32x32x16_bf16 v[48:63], a[216:219], v[212:215], v[48:63]
    v_cvt_pk_bf16_f32 v210, v84, v85
    v_mul_f32 v86, v86, v88
    v_mul_f32 v87, v87, v88
    v_cvt_pk_bf16_f32 v211, v86, v87
    s_waitcnt lgkmcnt(1)
    v_cvt_pk_bf16_f32 v136, v224, v225
    v_cvt_pk_bf16_f32 v137, v226, v227
    s_waitcnt lgkmcnt(0)
    v_cvt_pk_bf16_f32 v138, v228, v229
    v_cvt_pk_bf16_f32 v139, v230, v231
    s_waitcnt vmcnt(8)
    s_nop 0
    v_mfma_f32_32x32x16_bf16 v[80:95], v[136:139], v[168:171], 0
    buffer_load_dwordx4 v[200:203], v10, s[16:19], s51 offen offset:2048 sc1
    v_add_f32 v104, v104, v14
    v_rcp_f32 v104, v104
    s_nop 0
    v_mul_f32 v96, v96, v104
    v_mul_f32 v97, v97, v104
    v_cvt_pk_bf16_f32 v212, v96, v97
    v_mfma_f32_32x32x16_bf16 v[64:79], a[228:231], v[208:211], v[64:79]
    buffer_load_dwordx4 v[204:207], v10, s[16:19], s51 offen offset:3072 sc1
    s_waitcnt vmcnt(9)
    ds_read_b128 v[224:227], v11 offset:7616
    ds_read_b128 v[228:231], v11 offset:7632
    v_mul_f32 v98, v98, v104
    v_mul_f32 v99, v99, v104
    v_cvt_pk_bf16_f32 v213, v98, v99
    v_mul_f32 v100, v100, v104
    v_mul_f32 v101, v101, v104
    v_mfma_f32_32x32x16_bf16 v[48:63], a[224:227], v[208:211], v[48:63]
    v_cvt_pk_bf16_f32 v214, v100, v101
    v_mul_f32 v102, v102, v104
    v_mul_f32 v103, v103, v104
    v_cvt_pk_bf16_f32 v215, v102, v103
    s_waitcnt lgkmcnt(1)
    v_cvt_pk_bf16_f32 v140, v224, v225
    v_cvt_pk_bf16_f32 v141, v226, v227
    s_waitcnt lgkmcnt(0)
    v_cvt_pk_bf16_f32 v142, v228, v229
    v_cvt_pk_bf16_f32 v143, v230, v231
    s_waitcnt vmcnt(8)
    s_nop 0
    v_mfma_f32_32x32x16_bf16 v[96:111], v[140:143], v[172:175], 0
    v_add_f32 v88, v88, v14
    v_rcp_f32 v88, v88
    s_nop 0
    v_mul_f32 v80, v80, v88
    v_mul_f32 v81, v81, v88
    v_cvt_pk_bf16_f32 v208, v80, v81
    v_mfma_f32_32x32x16_bf16 v[64:79], a[236:239], v[212:215], v[64:79]
    v_mul_f32 v82, v82, v88
    v_mul_f32 v83, v83, v88
    v_cvt_pk_bf16_f32 v209, v82, v83
    v_mul_f32 v84, v84, v88
    v_mul_f32 v85, v85, v88
    v_mfma_f32_32x32x16_bf16 v[48:63], a[232:235], v[212:215], v[48:63]
    v_cvt_pk_bf16_f32 v210, v84, v85
    v_mul_f32 v86, v86, v88
    v_mul_f32 v87, v87, v88
    v_cvt_pk_bf16_f32 v211, v86, v87
    s_waitcnt vmcnt(7)
    v_mfma_f32_32x32x16_bf16 v[80:95], v[112:115], v[176:179], 0
    v_add_f32 v104, v104, v14
    v_rcp_f32 v104, v104
    s_nop 0
    v_mul_f32 v96, v96, v104
    v_mul_f32 v97, v97, v104
    v_cvt_pk_bf16_f32 v212, v96, v97
    v_mfma_f32_32x32x16_bf16 v[64:79], a[244:247], v[208:211], v[64:79]
    v_mul_f32 v98, v98, v104
    v_mul_f32 v99, v99, v104
    v_cvt_pk_bf16_f32 v213, v98, v99
    v_mul_f32 v100, v100, v104
    v_mul_f32 v101, v101, v104
    v_mfma_f32_32x32x16_bf16 v[48:63], a[240:243], v[208:211], v[48:63]
    v_cvt_pk_bf16_f32 v214, v100, v101
    v_mul_f32 v102, v102, v104
    v_mul_f32 v103, v103, v104
    v_cvt_pk_bf16_f32 v215, v102, v103
    s_waitcnt vmcnt(6)
    v_mfma_f32_32x32x16_bf16 v[96:111], v[116:119], v[180:183], 0
    v_add_f32 v88, v88, v14
    v_rcp_f32 v88, v88
    s_nop 0
    v_mul_f32 v80, v80, v88
    v_mul_f32 v81, v81, v88
    v_cvt_pk_bf16_f32 v208, v80, v81
    v_mfma_f32_32x32x16_bf16 v[64:79], a[252:255], v[212:215], v[64:79]
    v_mul_f32 v82, v82, v88
    v_mul_f32 v83, v83, v88
    v_cvt_pk_bf16_f32 v209, v82, v83
    v_mul_f32 v84, v84, v88
    v_mul_f32 v85, v85, v88
    v_mfma_f32_32x32x16_bf16 v[48:63], a[248:251], v[212:215], v[48:63]
    v_cvt_pk_bf16_f32 v210, v84, v85
    v_mul_f32 v86, v86, v88
    v_mul_f32 v87, v87, v88
    v_cvt_pk_bf16_f32 v211, v86, v87
    s_waitcnt vmcnt(5)
    v_mfma_f32_32x32x16_bf16 v[80:95], v[120:123], v[184:187], 0
    v_add_f32 v104, v104, v14
    v_rcp_f32 v104, v104
    s_nop 0
    v_mul_f32 v96, v96, v104
    v_mul_f32 v97, v97, v104
    v_cvt_pk_bf16_f32 v212, v96, v97
    v_mfma_f32_32x32x16_bf16 v[32:47], a[196:199], v[208:211], 0
    ds_write_b128 v15, v[64:67] offset:4096
    v_mul_f32 v98, v98, v104
    v_mul_f32 v99, v99, v104
    v_cvt_pk_bf16_f32 v213, v98, v99
    v_mul_f32 v100, v100, v104
    v_mul_f32 v101, v101, v104
    v_mfma_f32_32x32x16_bf16 v[16:31], a[192:195], v[208:211], v[16:31]
    ds_write_b128 v15, v[68:71] offset:5120
    v_cvt_pk_bf16_f32 v214, v100, v101
    v_mul_f32 v102, v102, v104
    v_mul_f32 v103, v103, v104
    v_cvt_pk_bf16_f32 v215, v102, v103
    s_waitcnt vmcnt(4)
    v_mfma_f32_32x32x16_bf16 v[96:111], v[124:127], v[188:191], 0
    v_add_f32 v88, v88, v14
    v_rcp_f32 v88, v88
    s_nop 0
    v_mul_f32 v80, v80, v88
    v_mul_f32 v81, v81, v88
    v_cvt_pk_bf16_f32 v208, v80, v81
    v_mfma_f32_32x32x16_bf16 v[32:47], a[204:207], v[212:215], v[32:47]
    ds_write_b128 v15, v[72:75] offset:6144
    v_mul_f32 v82, v82, v88
    v_mul_f32 v83, v83, v88
    v_cvt_pk_bf16_f32 v209, v82, v83
    v_mul_f32 v84, v84, v88
    v_mul_f32 v85, v85, v88
    v_mfma_f32_32x32x16_bf16 v[16:31], a[200:203], v[212:215], v[16:31]
    ds_write_b128 v15, v[76:79] offset:7168
    v_cvt_pk_bf16_f32 v210, v84, v85
    v_mul_f32 v86, v86, v88
    v_mul_f32 v87, v87, v88
    v_cvt_pk_bf16_f32 v211, v86, v87
    s_waitcnt vmcnt(3)
    v_mfma_f32_32x32x16_bf16 v[80:95], v[128:131], v[192:195], 0
    v_add_f32 v104, v104, v14
    v_rcp_f32 v104, v104
    s_nop 0
    v_mul_f32 v96, v96, v104
    v_mul_f32 v97, v97, v104
    v_cvt_pk_bf16_f32 v212, v96, v97
    v_mfma_f32_32x32x16_bf16 v[32:47], a[212:215], v[208:211], v[32:47]
    ds_write_b128 v15, v[48:51] offset:0
    v_mul_f32 v98, v98, v104
    v_mul_f32 v99, v99, v104
    v_cvt_pk_bf16_f32 v213, v98, v99
    v_mul_f32 v100, v100, v104
    v_mul_f32 v101, v101, v104
    v_mfma_f32_32x32x16_bf16 v[16:31], a[208:211], v[208:211], v[16:31]
    ds_write_b128 v15, v[52:55] offset:1024
    v_cvt_pk_bf16_f32 v214, v100, v101
    v_mul_f32 v102, v102, v104
    v_mul_f32 v103, v103, v104
    v_cvt_pk_bf16_f32 v215, v102, v103
    s_waitcnt vmcnt(2)
    v_mfma_f32_32x32x16_bf16 v[96:111], v[132:135], v[196:199], 0
    v_add_f32 v88, v88, v14
    v_rcp_f32 v88, v88
    s_nop 0
    v_mul_f32 v80, v80, v88
    v_mul_f32 v81, v81, v88
    v_cvt_pk_bf16_f32 v208, v80, v81
    v_mfma_f32_32x32x16_bf16 v[32:47], a[220:223], v[212:215], v[32:47]
    ds_write_b128 v15, v[56:59] offset:2048
    v_mul_f32 v82, v82, v88
    v_mul_f32 v83, v83, v88
    v_cvt_pk_bf16_f32 v209, v82, v83
    v_mul_f32 v84, v84, v88
    v_mul_f32 v85, v85, v88
    v_mfma_f32_32x32x16_bf16 v[16:31], a[216:219], v[212:215], v[16:31]
    ds_write_b128 v15, v[60:63] offset:3072
    v_cvt_pk_bf16_f32 v210, v84, v85
    v_mul_f32 v86, v86, v88
    v_mul_f32 v87, v87, v88
    v_cvt_pk_bf16_f32 v211, v86, v87
    s_waitcnt vmcnt(1)
    v_mfma_f32_32x32x16_bf16 v[80:95], v[136:139], v[200:203], 0
    v_add_f32 v104, v104, v14
    v_rcp_f32 v104, v104
    s_nop 0
    v_mul_f32 v96, v96, v104
    v_mul_f32 v97, v97, v104
    v_cvt_pk_bf16_f32 v212, v96, v97
    v_mfma_f32_32x32x16_bf16 v[32:47], a[228:231], v[208:211], v[32:47]
    v_mul_f32 v98, v98, v104
    v_mul_f32 v99, v99, v104
    v_cvt_pk_bf16_f32 v213, v98, v99
    v_mul_f32 v100, v100, v104
    v_mul_f32 v101, v101, v104
    v_mfma_f32_32x32x16_bf16 v[16:31], a[224:227], v[208:211], v[16:31]
    v_cvt_pk_bf16_f32 v214, v100, v101
    v_mul_f32 v102, v102, v104
    v_mul_f32 v103, v103, v104
    v_cvt_pk_bf16_f32 v215, v102, v103
    s_waitcnt lgkmcnt(0)
    s_barrier
    s_waitcnt vmcnt(0)
    v_mfma_f32_32x32x16_bf16 v[96:111], v[140:143], v[204:207], 0
    v_add_f32 v88, v88, v14
    v_rcp_f32 v88, v88
    s_nop 0
    v_mul_f32 v80, v80, v88
    v_mul_f32 v81, v81, v88
    v_cvt_pk_bf16_f32 v208, v80, v81
    v_mfma_f32_32x32x16_bf16 v[32:47], a[236:239], v[212:215], v[32:47]
    ds_read_b128 v[144:147], v233 offset:0
    ds_read_b128 v[148:151], v233 offset:1024
    v_mul_f32 v82, v82, v88
    v_mul_f32 v83, v83, v88
    v_cvt_pk_bf16_f32 v209, v82, v83
    v_mul_f32 v84, v84, v88
    v_mul_f32 v85, v85, v88
    v_mfma_f32_32x32x16_bf16 v[16:31], a[232:235], v[212:215], v[16:31]
    ds_read_b128 v[152:155], v233 offset:2048
    ds_read_b128 v[156:159], v233 offset:3072
    v_cvt_pk_bf16_f32 v210, v84, v85
    v_mul_f32 v86, v86, v88
    v_mul_f32 v87, v87, v88
    v_cvt_pk_bf16_f32 v211, v86, v87
    v_add_f32 v104, v104, v14
    v_rcp_f32 v104, v104
    s_nop 0
    v_mul_f32 v96, v96, v104
    v_mul_f32 v97, v97, v104
    v_cvt_pk_bf16_f32 v212, v96, v97
    v_mfma_f32_32x32x16_bf16 v[32:47], a[244:247], v[208:211], v[32:47]
    ds_read_b128 v[160:163], v13 offset:4096
    ds_read_b128 v[164:167], v13 offset:5120
    v_mul_f32 v98, v98, v104
    v_mul_f32 v99, v99, v104
    v_cvt_pk_bf16_f32 v213, v98, v99
    v_mul_f32 v100, v100, v104
    v_mul_f32 v101, v101, v104
    v_mfma_f32_32x32x16_bf16 v[16:31], a[240:243], v[208:211], v[16:31]
    ds_read_b128 v[168:171], v13 offset:6144
    ds_read_b128 v[172:175], v13 offset:7168
    v_cvt_pk_bf16_f32 v214, v100, v101
    v_mul_f32 v102, v102, v104
    v_mul_f32 v103, v103, v104
    v_cvt_pk_bf16_f32 v215, v102, v103
    s_nop 1
    v_mfma_f32_32x32x16_bf16 v[32:47], a[252:255], v[212:215], v[32:47]
    v_mfma_f32_32x32x16_bf16 v[16:31], a[248:251], v[212:215], v[16:31]
    s_waitcnt lgkmcnt(3)
    v_add_f32 v144, v144, v160
    v_add_f32 v145, v145, v161
    v_add_f32 v146, v146, v162
    v_add_f32 v147, v147, v163
    s_waitcnt lgkmcnt(2)
    v_add_f32 v148, v148, v164
    v_add_f32 v149, v149, v165
    s_nop 2
    ds_write_b128 v15, v[32:35] offset:8192
    v_add_f32 v150, v150, v166
    v_add_f32 v151, v151, v167
    ds_write_b128 v15, v[36:39] offset:9216
    s_waitcnt lgkmcnt(3)
    v_add_f32 v152, v152, v168
    v_add_f32 v153, v153, v169
    ds_write_b128 v15, v[40:43] offset:10240
    v_add_f32 v154, v154, v170
    v_add_f32 v155, v155, v171
    ds_write_b128 v15, v[44:47] offset:11264
    s_waitcnt lgkmcnt(4)
    v_add_f32 v156, v156, v172
    v_add_f32 v157, v157, v173
    v_add_f32 v158, v158, v174
    v_add_f32 v159, v159, v175
    v_pk_add_f32 v[16:17], v[16:17], v[144:145]
    v_pk_add_f32 v[18:19], v[18:19], v[146:147]
    v_pk_add_f32 v[20:21], v[20:21], v[148:149]
    v_pk_add_f32 v[22:23], v[22:23], v[150:151]
    v_pk_add_f32 v[24:25], v[24:25], v[152:153]
    v_pk_add_f32 v[26:27], v[26:27], v[154:155]
    v_pk_add_f32 v[28:29], v[28:29], v[156:157]
    v_pk_add_f32 v[30:31], v[30:31], v[158:159]
    s_waitcnt lgkmcnt(0)
    s_barrier
    ds_read_b128 v[80:83], v234 offset:8192
    ds_read_b128 v[84:87], v234 offset:9216
    ds_read_b128 v[88:91], v234 offset:10240
    ds_read_b128 v[92:95], v234 offset:11264
    s_waitcnt lgkmcnt(3)
    v_pk_add_f32 v[16:17], v[16:17], v[80:81]
    v_cvt_pk_bf16_f32 v96, v16, v17
    v_pk_add_f32 v[18:19], v[18:19], v[82:83]
    v_cvt_pk_bf16_f32 v97, v18, v19
    s_waitcnt lgkmcnt(2)
    v_pk_add_f32 v[20:21], v[20:21], v[84:85]
    v_cvt_pk_bf16_f32 v98, v20, v21
    v_pk_add_f32 v[22:23], v[22:23], v[86:87]
    v_cvt_pk_bf16_f32 v99, v22, v23
    s_waitcnt lgkmcnt(1)
    v_pk_add_f32 v[24:25], v[24:25], v[88:89]
    v_cvt_pk_bf16_f32 v100, v24, v25
    v_pk_add_f32 v[26:27], v[26:27], v[90:91]
    v_cvt_pk_bf16_f32 v101, v26, v27
    s_waitcnt lgkmcnt(0)
    v_pk_add_f32 v[28:29], v[28:29], v[92:93]
    v_cvt_pk_bf16_f32 v102, v28, v29
    v_pk_add_f32 v[30:31], v[30:31], v[94:95]
    v_cvt_pk_bf16_f32 v103, v30, v31
    v_dot2_f32_bf16 v8, v96, v240, v8
    v_dot2_f32_bf16 v9, v96, v96, v9
    v_dot2_f32_bf16 v8, v97, v240, v8
    v_dot2_f32_bf16 v9, v97, v97, v9
    v_dot2_f32_bf16 v8, v98, v240, v8
    v_dot2_f32_bf16 v9, v98, v98, v9
    v_dot2_f32_bf16 v8, v99, v240, v8
    v_dot2_f32_bf16 v9, v99, v99, v9
    v_dot2_f32_bf16 v8, v100, v240, v8
    v_dot2_f32_bf16 v9, v100, v100, v9
    v_dot2_f32_bf16 v8, v101, v240, v8
    v_dot2_f32_bf16 v9, v101, v101, v9
    v_dot2_f32_bf16 v8, v102, v240, v8
    v_dot2_f32_bf16 v9, v102, v102, v9
    v_dot2_f32_bf16 v8, v103, v240, v8
    v_dot2_f32_bf16 v9, v103, v103, v9
    v_permlane16_swap_b32 v96, v98
    v_permlane16_swap_b32 v97, v99
    v_permlane16_swap_b32 v100, v102
    v_permlane32_swap_b32 v8, v9
    v_add_f32 v8, v8, v9
    buffer_atomic_add_f32 v8, v12, s[16:19], s58 offen
    v_permlane16_swap_b32 v101, v103
    buffer_store_dwordx4 v[96:99], v235, s[16:19], s56 offen sc1
    buffer_store_dwordx4 v[100:103], v235, s[16:19], s57 offen sc1
    s_and_b32 s40, s2, 15
    s_lshl_b32 s40, s40, 8
    s_add_u32 s40, s40, 0x00f1b000
    v_mov_b32 v236, 0
    v_cmp_eq_u32 vcc, 0, v0
    s_nop 1
    v_cndmask_b32 v232, v4, v236, vcc
    v_mov_b32 v236, 1
    s_waitcnt vmcnt(0)
    s_barrier
    buffer_atomic_add v236, v232, s[16:19], s40 offen sc1
    s_mul_i32 s64, s28, 16640
    v_sub_u32 v5, 15, v2
    v_and_b32 v6, 3, v5
    v_sub_u32 v5, v5, v6
    v_lshl_add_u32 v5, v3, 3, v5
    v_lshlrev_b32 v5, 1, v5
    v_mul_u32_u24 v6, 4160, v6
    v_add3_u32 v13, v5, v6, s64
    v_lshl_add_u32 v8, v1, 4, s64
    s_lshr_b32 s56, s28, 1
    s_cmp_eq_u32 s56, s34
    s_cselect_b32 s57, 0, 1
    s_lshl_b32 s56, s57, 12
    v_lshl_add_u32 v10, v0, 4, s56
    v_xor_b32 v233, 0x1000, v10
    s_lshl_b32 s48, s33, 14
    s_add_u32 s49, s48, 0x00600000
    s_add_u32 s51, s49, 8192
    s_mul_i32 s50, s28, 4608
    s_add_u32 s50, s50, 66560
    v_lshlrev_b32 v5, 5, v2
    v_lshl_add_u32 v5, v3, 4, v5
    v_add3_u32 v14, v5, 32, s50
    v_lshrrev_b32 v15, 2, v10
    v_add_u32 v15, 67072, v15
    v_lshrrev_b32 v234, 2, v233
    v_add_u32 v234, 67072, v234
    v_mov_b32 v6, 0
    v_mov_b32 v7, 0
    v_lshl_add_u32 v5, v1, 3, s50
    ds_write_b64 v5, v[6:7]
    s_mov_b32 s52, 0x3b000000
    s_mov_b32 s53, s52
    s_mov_b32 s54, 0x3727c5ac
    s_mov_b32 s55, s54
    s_mov_b32 s60, 0x00f16000
    s_mov_b32 s61, 0x00f18000
    s_mul_i32 s56, s28, 4608
    s_add_u32 s56, s56, 84992
    v_lshrrev_b32 v5, 1, v2
    v_add_u32 v5, v5, v3
    v_lshlrev_b32 v5, 4, v5
    v_lshl_add_u32 v5, v2, 6, v5
    v_add_u32 v11, s56, v5
    v_and_b32 v5, 127, v0
    v_lshrrev_b32 v6, 4, v5
    v_lshlrev_b32 v6, 4, v6
    v_lshl_add_u32 v5, v5, 3, v6
    s_mul_i32 s56, s57, 1152
    s_add_u32 s56, s56, 84992
    v_add_u32 v12, s56, v5
    v_lshlrev_b32 v9, 11, v0
    s_lshl_b32 s58, s57, 19
    s_lshl_b32 s59, s33, 3
    s_add_u32 s58, s58, s59
    s_add_u32 s59, s58, 0x100000
    v_add_u32 v5, 4, v2
    v_mov_b32 v6, 511
    v_lshlrev_b32 v5, v5, v6
    v_lshlrev_b32 v6, 3, v3
    v_lshrrev_b32 v5, v6, v5
    v_bfe_u32 v6, v5, 0, 1
    v_bfe_u32 v7, v5, 1, 1
    v_lshl_or_b32 v6, v7, 16, v6
    v_mul_u32_u24 v104, 0x3f80, v6
    v_bfe_u32 v6, v5, 2, 1
    v_bfe_u32 v7, v5, 3, 1
    v_lshl_or_b32 v6, v7, 16, v6
    v_mul_u32_u24 v105, 0x3f80, v6
    v_bfe_u32 v6, v5, 4, 1
    v_bfe_u32 v7, v5, 5, 1
    v_lshl_or_b32 v6, v7, 16, v6
    v_mul_u32_u24 v106, 0x3f80, v6
    v_bfe_u32 v6, v5, 6, 1
    v_bfe_u32 v7, v5, 7, 1
    v_lshl_or_b32 v6, v7, 16, v6
    v_mul_u32_u24 v107, 0x3f80, v6
    v_add_u32 v5, 5, v2
    v_mov_b32 v6, 127
    v_lshlrev_b32 v5, v5, v6
    v_lshlrev_b32 v6, 3, v3
    v_lshrrev_b32 v5, v6, v5
    v_bfe_u32 v6, v5, 0, 1
    v_bfe_u32 v7, v5, 1, 1
    v_lshl_or_b32 v6, v7, 16, v6
    v_mul_u32_u24 v108, 0x3f80, v6
    v_bfe_u32 v6, v5, 2, 1
    v_bfe_u32 v7, v5, 3, 1
    v_lshl_or_b32 v6, v7, 16, v6
    v_mul_u32_u24 v109, 0x3f80, v6
    v_bfe_u32 v6, v5, 4, 1
    v_bfe_u32 v7, v5, 5, 1
    v_lshl_or_b32 v6, v7, 16, v6
    v_mul_u32_u24 v110, 0x3f80, v6
    v_bfe_u32 v6, v5, 6, 1
    v_bfe_u32 v7, v5, 7, 1
    v_lshl_or_b32 v6, v7, 16, v6
    v_mul_u32_u24 v111, 0x3f80, v6
    s_cmp_lg_u32 s28, 0
    s_cbranch_scc1 L_gw4_done
    v_mov_b32 v232, 0
    s_mov_b32 s46, 0x80000
    s_cmp_lg_u32 s43, 0
    s_cbranch_scc1 L_gw4_poll
    s_mov_b32 s45, 0x00f1b000
    v_lshlrev_b32 v237, 8, v1
    v_cmp_gt_u32 vcc, 16, v1
    s_nop 1
    v_cndmask_b32 v237, v4, v237, vcc
L_gw4_mp:
    v_mov_b32 v236, 0
    buffer_atomic_add v236, v237, s[16:19], s45 offen sc0 sc1
    s_waitcnt vmcnt(0)
    v_cmp_gt_u32 vcc, 80, v236
    s_sub_u32 s46, s46, 1
    s_cbranch_scc1 L_gw4_done
    s_and_b32 s40, vcc_lo, 0xffff
    s_cbranch_scc1 L_gw4_mp
    v_mov_b32 v237, 5
    buffer_store_dword v237, v232, s[16:19], s42 offen
    s_branch L_gw4_done
L_gw4_poll:
    buffer_load_dword v236, v232, s[16:19], s42 offen sc1
    s_waitcnt vmcnt(0)
    v_readfirstlane_b32 s45, v236
    s_sub_u32 s46, s46, 1
    s_cbranch_scc1 L_gw4_done
    s_cmp_lt_u32 s45, 5
    s_cbranch_scc1 L_gw4_poll
L_gw4_done:
    s_waitcnt lgkmcnt(0)
    s_barrier
    buffer_load_dwordx4 v[16:19], v10, s[16:19], s60 offen sc1
    buffer_load_dwordx4 v[32:35], v10, s[16:19], s49 offen sc1
    buffer_load_dwordx4 v[20:23], v233, s[16:19], s60 offen sc1
    buffer_load_dwordx4 v[36:39], v233, s[16:19], s49 offen sc1
    buffer_load_dwordx4 v[24:27], v10, s[16:19], s61 offen sc1
    buffer_load_dwordx4 v[40:43], v10, s[16:19], s51 offen sc1
    buffer_load_dwordx4 v[28:31], v233, s[16:19], s61 offen sc1
    buffer_load_dwordx4 v[44:47], v233, s[16:19], s51 offen sc1
    s_waitcnt vmcnt(7)
    v_pk_mul_f32 v[16:17], v[16:17], s[52:53]
    v_pk_mul_f32 v[18:19], v[18:19], s[52:53]
    v_pk_fma_f32 v[18:19], v[16:17], v[16:17], v[18:19] neg_lo:[1,0,0] neg_hi:[1,0,0]
    v_cvt_pk_bf16_f32 v17, v16, v17
    v_cvt_pk_bf16_f32 v19, v18, v19
    v_pk_max_i16 v19, v19, 0
    v_lshlrev_b32 v16, 16, v17
    v_and_b32 v17, 0xffff0000, v17
    v_lshlrev_b32 v18, 16, v19
    v_and_b32 v19, 0xffff0000, v19
    v_pk_add_f32 v[18:19], v[18:19], s[54:55]
    v_cvt_pk_bf16_f32 v19, v18, v19
    v_lshlrev_b32 v18, 16, v19
    v_and_b32 v19, 0xffff0000, v19
    v_sqrt_f32 v18, v18
    v_sqrt_f32 v19, v19
    s_waitcnt vmcnt(6)
    v_lshlrev_b32 v64, 16, v32
    v_cvt_pk_bf16_f32 v19, v18, v19
    v_lshlrev_b32 v18, 16, v19
    v_and_b32 v19, 0xffff0000, v19
    v_rcp_f32 v18, v18
    v_rcp_f32 v19, v19
    v_lshlrev_b32 v68, 16, v33
    v_lshlrev_b32 v65, 16, v34
    v_lshlrev_b32 v69, 16, v35
    v_and_b32 v66, 0xffff0000, v32
    v_and_b32 v70, 0xffff0000, v33
    v_and_b32 v67, 0xffff0000, v34
    v_and_b32 v71, 0xffff0000, v35
    v_pk_mul_f32 v[16:17], v[16:17], v[18:19] neg_lo:[1,0] neg_hi:[1,0]
    v_pk_fma_f32 v[80:81], v[64:65], v[18:19], v[16:17]
    v_pk_fma_f32 v[82:83], v[66:67], v[18:19], v[16:17]
    v_pk_fma_f32 v[84:85], v[68:69], v[18:19], v[16:17]
    v_pk_fma_f32 v[86:87], v[70:71], v[18:19], v[16:17]
    v_cvt_pk_bf16_f32 v88, v80, v81
    v_cvt_pk_bf16_f32 v89, v82, v83
    v_cvt_pk_bf16_f32 v90, v84, v85
    v_cvt_pk_bf16_f32 v91, v86, v87
    ds_write2st64_b32 v15, v88, v89 offset0:0 offset1:18
    ds_write2st64_b32 v15, v90, v91 offset0:36 offset1:54
    s_waitcnt vmcnt(5)
    v_pk_mul_f32 v[20:21], v[20:21], s[52:53]
    v_pk_mul_f32 v[22:23], v[22:23], s[52:53]
    v_pk_fma_f32 v[22:23], v[20:21], v[20:21], v[22:23] neg_lo:[1,0,0] neg_hi:[1,0,0]
    v_cvt_pk_bf16_f32 v21, v20, v21
    v_cvt_pk_bf16_f32 v23, v22, v23
    v_pk_max_i16 v23, v23, 0
    v_lshlrev_b32 v20, 16, v21
    v_and_b32 v21, 0xffff0000, v21
    v_lshlrev_b32 v22, 16, v23
    v_and_b32 v23, 0xffff0000, v23
    v_pk_add_f32 v[22:23], v[22:23], s[54:55]
    v_cvt_pk_bf16_f32 v23, v22, v23
    v_lshlrev_b32 v22, 16, v23
    v_and_b32 v23, 0xffff0000, v23
    v_sqrt_f32 v22, v22
    v_sqrt_f32 v23, v23
    s_waitcnt vmcnt(4)
    v_lshlrev_b32 v80, 16, v36
    v_cvt_pk_bf16_f32 v23, v22, v23
    v_lshlrev_b32 v22, 16, v23
    v_and_b32 v23, 0xffff0000, v23
    v_rcp_f32 v22, v22
    v_rcp_f32 v23, v23
    v_lshlrev_b32 v84, 16, v37
    v_lshlrev_b32 v81, 16, v38
    v_lshlrev_b32 v85, 16, v39
    v_and_b32 v82, 0xffff0000, v36
    v_and_b32 v86, 0xffff0000, v37
    v_and_b32 v83, 0xffff0000, v38
    v_and_b32 v87, 0xffff0000, v39
    v_pk_mul_f32 v[20:21], v[20:21], v[22:23] neg_lo:[1,0] neg_hi:[1,0]
    v_pk_fma_f32 v[80:81], v[80:81], v[22:23], v[20:21]
    v_pk_fma_f32 v[82:83], v[82:83], v[22:23], v[20:21]
    v_pk_fma_f32 v[84:85], v[84:85], v[22:23], v[20:21]
    v_pk_fma_f32 v[86:87], v[86:87], v[22:23], v[20:21]
    v_cvt_pk_bf16_f32 v88, v80, v81
    v_cvt_pk_bf16_f32 v89, v82, v83
    v_cvt_pk_bf16_f32 v90, v84, v85
    v_cvt_pk_bf16_f32 v91, v86, v87
    ds_write2st64_b32 v234, v88, v89 offset0:0 offset1:18
    ds_write2st64_b32 v234, v90, v91 offset0:36 offset1:54
    s_waitcnt vmcnt(3)
    v_pk_mul_f32 v[24:25], v[24:25], s[52:53]
    v_pk_mul_f32 v[26:27], v[26:27], s[52:53]
    v_pk_fma_f32 v[26:27], v[24:25], v[24:25], v[26:27] neg_lo:[1,0,0] neg_hi:[1,0,0]
    v_cvt_pk_bf16_f32 v25, v24, v25
    v_cvt_pk_bf16_f32 v27, v26, v27
    v_pk_max_i16 v27, v27, 0
    v_lshlrev_b32 v24, 16, v25
    v_and_b32 v25, 0xffff0000, v25
    v_lshlrev_b32 v26, 16, v27
    v_and_b32 v27, 0xffff0000, v27
    v_pk_add_f32 v[26:27], v[26:27], s[54:55]
    v_cvt_pk_bf16_f32 v27, v26, v27
    v_lshlrev_b32 v26, 16, v27
    v_and_b32 v27, 0xffff0000, v27
    v_sqrt_f32 v26, v26
    v_sqrt_f32 v27, v27
    s_waitcnt vmcnt(2)
    v_lshlrev_b32 v72, 16, v40
    v_cvt_pk_bf16_f32 v27, v26, v27
    v_lshlrev_b32 v26, 16, v27
    v_and_b32 v27, 0xffff0000, v27
    v_rcp_f32 v26, v26
    v_rcp_f32 v27, v27
    v_lshlrev_b32 v76, 16, v41
    v_lshlrev_b32 v73, 16, v42
    v_lshlrev_b32 v77, 16, v43
    v_and_b32 v74, 0xffff0000, v40
    v_and_b32 v78, 0xffff0000, v41
    v_and_b32 v75, 0xffff0000, v42
    v_and_b32 v79, 0xffff0000, v43
    v_pk_mul_f32 v[24:25], v[24:25], v[26:27] neg_lo:[1,0] neg_hi:[1,0]
    v_pk_fma_f32 v[80:81], v[72:73], v[26:27], v[24:25]
    v_pk_fma_f32 v[82:83], v[74:75], v[26:27], v[24:25]
    v_pk_fma_f32 v[84:85], v[76:77], v[26:27], v[24:25]
    v_pk_fma_f32 v[86:87], v[78:79], v[26:27], v[24:25]
    v_cvt_pk_bf16_f32 v88, v80, v81
    v_cvt_pk_bf16_f32 v89, v82, v83
    v_cvt_pk_bf16_f32 v90, v84, v85
    v_cvt_pk_bf16_f32 v91, v86, v87
    ds_write2st64_b32 v15, v88, v89 offset0:8 offset1:26
    ds_write2st64_b32 v15, v90, v91 offset0:44 offset1:62
    s_waitcnt vmcnt(1)
    v_pk_mul_f32 v[28:29], v[28:29], s[52:53]
    v_pk_mul_f32 v[30:31], v[30:31], s[52:53]
    v_pk_fma_f32 v[30:31], v[28:29], v[28:29], v[30:31] neg_lo:[1,0,0] neg_hi:[1,0,0]
    v_cvt_pk_bf16_f32 v29, v28, v29
    v_cvt_pk_bf16_f32 v31, v30, v31
    v_pk_max_i16 v31, v31, 0
    v_lshlrev_b32 v28, 16, v29
    v_and_b32 v29, 0xffff0000, v29
    v_lshlrev_b32 v30, 16, v31
    v_and_b32 v31, 0xffff0000, v31
    v_pk_add_f32 v[30:31], v[30:31], s[54:55]
    v_cvt_pk_bf16_f32 v31, v30, v31
    v_lshlrev_b32 v30, 16, v31
    v_and_b32 v31, 0xffff0000, v31
    v_sqrt_f32 v30, v30
    v_sqrt_f32 v31, v31
    s_waitcnt vmcnt(0)
    v_lshlrev_b32 v80, 16, v44
    v_cvt_pk_bf16_f32 v31, v30, v31
    v_lshlrev_b32 v30, 16, v31
    v_and_b32 v31, 0xffff0000, v31
    v_rcp_f32 v30, v30
    v_rcp_f32 v31, v31
    v_lshlrev_b32 v84, 16, v45
    v_lshlrev_b32 v81, 16, v46
    v_lshlrev_b32 v85, 16, v47
    v_and_b32 v82, 0xffff0000, v44
    v_and_b32 v86, 0xffff0000, v45
    v_and_b32 v83, 0xffff0000, v46
    v_and_b32 v87, 0xffff0000, v47
    v_pk_mul_f32 v[28:29], v[28:29], v[30:31] neg_lo:[1,0] neg_hi:[1,0]
    v_pk_fma_f32 v[80:81], v[80:81], v[30:31], v[28:29]
    v_pk_fma_f32 v[82:83], v[82:83], v[30:31], v[28:29]
    v_pk_fma_f32 v[84:85], v[84:85], v[30:31], v[28:29]
    v_pk_fma_f32 v[86:87], v[86:87], v[30:31], v[28:29]
    v_cvt_pk_bf16_f32 v88, v80, v81
    v_cvt_pk_bf16_f32 v89, v82, v83
    v_cvt_pk_bf16_f32 v90, v84, v85
    v_cvt_pk_bf16_f32 v91, v86, v87
    ds_write2st64_b32 v234, v88, v89 offset0:8 offset1:26
    ds_write2st64_b32 v234, v90, v91 offset0:44 offset1:62
    s_waitcnt lgkmcnt(0)
    s_barrier
    s_cmp_lg_u32 s34, 0
    s_cbranch_scc1 L_c1_p1
    ds_read_b128 v[112:115], v14 offset:448
    ds_read_b128 v[116:119], v14 offset:1984
    ds_read_b128 v[120:123], v14 offset:1472
    ds_read_b128 v[124:127], v14 offset:960
    s_waitcnt lgkmcnt(3)
    v_mfma_f32_16x16x32_bf16 v[48:51], a[0:3], v[112:115], 0
    ds_read_b128 v[128:131], v14 offset:384
    s_waitcnt lgkmcnt(3)
    v_mfma_f32_16x16x32_bf16 v[52:55], a[0:3], v[116:119], 0
    ds_read_b128 v[132:135], v14 offset:1920
    s_waitcnt lgkmcnt(3)
    v_mfma_f32_16x16x32_bf16 v[52:55], a[32:35], v[120:123], v[52:55]
    ds_read_b128 v[136:139], v14 offset:1408
    s_waitcnt lgkmcnt(3)
    v_mfma_f32_16x16x32_bf16 v[52:55], a[64:67], v[124:127], v[52:55]
    ds_read_b128 v[140:143], v14 offset:896
    v_mfma_f32_16x16x32_bf16 v[52:55], a[96:99], v[112:115], v[52:55]
    ds_read_b128 v[144:147], v14 offset:320
    s_waitcnt lgkmcnt(4)
    v_mfma_f32_16x16x32_bf16 v[48:51], a[4:7], v[128:131], v[48:51]
    ds_read_b128 v[148:151], v14 offset:1856
    s_waitcnt lgkmcnt(4)
    v_mfma_f32_16x16x32_bf16 v[52:55], a[4:7], v[132:135], v[52:55]
    ds_read_b128 v[152:155], v14 offset:1344
    s_waitcnt lgkmcnt(4)
    v_mfma_f32_16x16x32_bf16 v[52:55], a[36:39], v[136:139], v[52:55]
    ds_read_b128 v[156:159], v14 offset:832
    s_waitcnt lgkmcnt(4)
    v_mfma_f32_16x16x32_bf16 v[52:55], a[68:71], v[140:143], v[52:55]
    ds_read_b128 v[160:163], v14 offset:256
    v_mfma_f32_16x16x32_bf16 v[52:55], a[100:103], v[128:131], v[52:55]
    ds_read_b128 v[164:167], v14 offset:1792
    s_waitcnt lgkmcnt(5)
    v_mfma_f32_16x16x32_bf16 v[48:51], a[8:11], v[144:147], v[48:51]
    ds_read_b128 v[168:171], v14 offset:1280
    s_waitcnt lgkmcnt(5)
    v_mfma_f32_16x16x32_bf16 v[52:55], a[8:11], v[148:151], v[52:55]
    ds_read_b128 v[172:175], v14 offset:768
    s_waitcnt lgkmcnt(5)
    v_mfma_f32_16x16x32_bf16 v[52:55], a[40:43], v[152:155], v[52:55]
    ds_read_b128 v[176:179], v14 offset:192
    s_waitcnt lgkmcnt(5)
    v_mfma_f32_16x16x32_bf16 v[52:55], a[72:75], v[156:159], v[52:55]
    ds_read_b128 v[180:183], v14 offset:1728
    v_mfma_f32_16x16x32_bf16 v[52:55], a[104:107], v[144:147], v[52:55]
    ds_read_b128 v[184:187], v14 offset:1216
    s_waitcnt lgkmcnt(6)
    v_mfma_f32_16x16x32_bf16 v[48:51], a[12:15], v[160:163], v[48:51]
    ds_read_b128 v[188:191], v14 offset:704
    s_waitcnt lgkmcnt(6)
    v_mfma_f32_16x16x32_bf16 v[52:55], a[12:15], v[164:167], v[52:55]
    ds_read_b128 v[192:195], v14 offset:128
    s_waitcnt lgkmcnt(6)
    v_mfma_f32_16x16x32_bf16 v[52:55], a[44:47], v[168:171], v[52:55]
    ds_read_b128 v[196:199], v14 offset:1664
    s_waitcnt lgkmcnt(6)
    v_mfma_f32_16x16x32_bf16 v[52:55], a[76:79], v[172:175], v[52:55]
    ds_read_b128 v[200:203], v14 offset:1152
    v_mfma_f32_16x16x32_bf16 v[52:55], a[108:111], v[160:163], v[52:55]
    ds_read_b128 v[204:207], v14 offset:640
    s_waitcnt lgkmcnt(6)
    v_mfma_f32_16x16x32_bf16 v[48:51], a[16:19], v[176:179], v[48:51]
    ds_read_b128 v[208:211], v14 offset:64
    v_mfma_f32_16x16x32_bf16 v[52:55], a[16:19], v[180:183], v[52:55]
    ds_read_b128 v[212:215], v14 offset:1600
    s_waitcnt lgkmcnt(6)
    v_mfma_f32_16x16x32_bf16 v[52:55], a[48:51], v[184:187], v[52:55]
    ds_read_b128 v[216:219], v14 offset:1088
    v_mfma_f32_16x16x32_bf16 v[52:55], a[80:83], v[188:191], v[52:55]
    ds_read_b128 v[220:223], v14 offset:576
    v_mfma_f32_16x16x32_bf16 v[52:55], a[112:115], v[176:179], v[52:55]
    ds_read_b128 v[224:227], v14 offset:0
    s_waitcnt lgkmcnt(6)
    v_mfma_f32_16x16x32_bf16 v[48:51], a[20:23], v[192:195], v[48:51]
    ds_read_b128 v[228:231], v14 offset:1536
    v_mfma_f32_16x16x32_bf16 v[52:55], a[20:23], v[196:199], v[52:55]
    ds_read_b128 v[16:19], v14 offset:1024
    v_mfma_f32_16x16x32_bf16 v[52:55], a[52:55], v[200:203], v[52:55]
    ds_read_b128 v[20:23], v14 offset:512
    s_waitcnt lgkmcnt(6)
    v_mfma_f32_16x16x32_bf16 v[52:55], a[84:87], v[204:207], v[52:55]
    ds_read_b128 v[24:27], v14 offset:2496
    v_mfma_f32_16x16x32_bf16 v[52:55], a[116:119], v[192:195], v[52:55]
    ds_read_b128 v[28:31], v14 offset:4032
    v_mfma_f32_16x16x32_bf16 v[48:51], a[24:27], v[208:211], v[48:51]
    ds_read_b128 v[32:35], v14 offset:1984
    v_mfma_f32_16x16x32_bf16 v[52:55], a[24:27], v[212:215], v[52:55]
    ds_read_b128 v[36:39], v14 offset:3520
    s_waitcnt lgkmcnt(6)
    v_mfma_f32_16x16x32_bf16 v[52:55], a[56:59], v[216:219], v[52:55]
    ds_read_b128 v[40:43], v14 offset:1472
    v_mfma_f32_16x16x32_bf16 v[52:55], a[88:91], v[220:223], v[52:55]
    ds_read_b128 v[44:47], v14 offset:3008
    v_mfma_f32_16x16x32_bf16 v[52:55], a[120:123], v[208:211], v[52:55]
    ds_read_b128 v[116:119], v14 offset:960
    v_mfma_f32_16x16x32_bf16 v[48:51], a[28:31], v[224:227], v[48:51]
    ds_read_b128 v[120:123], v14 offset:448
    v_mfma_f32_16x16x32_bf16 v[52:55], a[28:31], v[228:231], v[52:55]
    ds_read_b128 v[124:127], v14 offset:2432
    s_waitcnt lgkmcnt(6)
    v_mfma_f32_16x16x32_bf16 v[52:55], a[60:63], v[16:19], v[52:55]
    ds_read_b128 v[112:115], v14 offset:3968
    v_mfma_f32_16x16x32_bf16 v[52:55], a[92:95], v[20:23], v[52:55]
    ds_read_b128 v[132:135], v14 offset:1920
    v_mfma_f32_16x16x32_bf16 v[52:55], a[124:127], v[224:227], v[52:55]
    ds_read_b128 v[136:139], v14 offset:3456
    v_mfma_f32_16x16x32_bf16 v[56:59], a[0:3], v[24:27], 0
    ds_read_b128 v[140:143], v14 offset:1408
    v_mfma_f32_16x16x32_bf16 v[60:63], a[0:3], v[28:31], 0
    ds_read_b128 v[128:131], v14 offset:2944
    v_mfma_f32_16x16x32_bf16 v[56:59], a[32:35], v[32:35], v[56:59]
    ds_write_b128 v11, v[48:51]
    ds_read_b128 v[148:151], v14 offset:896
    s_waitcnt lgkmcnt(7)
    v_mfma_f32_16x16x32_bf16 v[60:63], a[32:35], v[36:39], v[60:63]
    ds_write_b128 v11, v[52:55] offset:1152
    ds_read_b128 v[152:155], v14 offset:2368
    v_mfma_f32_16x16x32_bf16 v[56:59], a[64:67], v[40:43], v[56:59]
    ds_read_b128 v[156:159], v14 offset:3904
    v_mfma_f32_16x16x32_bf16 v[60:63], a[64:67], v[44:47], v[60:63]
    ds_read_b128 v[144:147], v14 offset:1856
    v_mfma_f32_16x16x32_bf16 v[56:59], a[96:99], v[116:119], v[56:59]
    ds_read_b128 v[164:167], v14 offset:3392
    v_mfma_f32_16x16x32_bf16 v[60:63], a[96:99], v[24:27], v[60:63]
    s_waitcnt lgkmcnt(0)
    s_barrier
    ds_read_b128 v[168:171], v14 offset:1344
    v_mfma_f32_16x16x32_bf16 v[56:59], a[128:131], v[120:123], v[56:59]
    ds_read_b64 v[92:93], v12 offset:0
    ds_read_b128 v[172:175], v14 offset:2880
    v_mfma_f32_16x16x32_bf16 v[60:63], a[128:131], v[32:35], v[60:63]
    ds_read_b64 v[94:95], v12 offset:4608
    ds_read_b128 v[160:163], v14 offset:832
    v_mfma_f32_16x16x32_bf16 v[56:59], a[4:7], v[124:127], v[56:59]
    ds_read_b64 v[96:97], v12 offset:9216
    ds_read_b128 v[180:183], v14 offset:2304
    v_mfma_f32_16x16x32_bf16 v[60:63], a[4:7], v[112:115], v[60:63]
    ds_read_b64 v[98:99], v12 offset:13824
    ds_read_b128 v[184:187], v14 offset:3840
    v_mfma_f32_16x16x32_bf16 v[56:59], a[36:39], v[132:135], v[56:59]
    ds_read_b128 v[188:191], v14 offset:1792
    v_mfma_f32_16x16x32_bf16 v[60:63], a[36:39], v[136:139], v[60:63]
    ds_read_b128 v[176:179], v14 offset:3328
    v_mfma_f32_16x16x32_bf16 v[56:59], a[68:71], v[140:143], v[56:59]
    ds_read_b128 v[196:199], v14 offset:1280
    v_mfma_f32_16x16x32_bf16 v[60:63], a[68:71], v[128:131], v[60:63]
    ds_read_b128 v[200:203], v14 offset:2816
    v_mfma_f32_16x16x32_bf16 v[56:59], a[100:103], v[148:151], v[56:59]
    ds_read_b128 v[204:207], v14 offset:768
    v_mfma_f32_16x16x32_bf16 v[60:63], a[100:103], v[124:127], v[60:63]
    ds_read_b128 v[192:195], v14 offset:2240
    v_mfma_f32_16x16x32_bf16 v[56:59], a[8:11], v[152:155], v[56:59]
    s_waitcnt lgkmcnt(13)
    v_add_f32 v92, v92, v64
    ds_read_b128 v[212:215], v14 offset:3776
    v_mfma_f32_16x16x32_bf16 v[60:63], a[8:11], v[156:159], v[60:63]
    v_add_f32 v93, v93, v65
    ds_read_b128 v[216:219], v14 offset:432
    v_mfma_f32_16x16x32_bf16 v[56:59], a[40:43], v[144:147], v[56:59]
    s_waitcnt lgkmcnt(13)
    v_add_f32 v94, v94, v66
    ds_read_b128 v[220:223], v14 offset:416
    v_mfma_f32_16x16x32_bf16 v[60:63], a[40:43], v[164:167], v[60:63]
    v_add_f32 v95, v95, v67
    ds_read_b128 v[208:211], v14 offset:1728
    v_mfma_f32_16x16x32_bf16 v[56:59], a[72:75], v[168:171], v[56:59]
    s_waitcnt lgkmcnt(13)
    v_add_f32 v96, v96, v68
    ds_read_b128 v[228:231], v14 offset:3264
    v_mfma_f32_16x16x32_bf16 v[60:63], a[72:75], v[172:175], v[60:63]
    v_add_f32 v97, v97, v69
    ds_read_b128 v[16:19], v14 offset:1216
    v_mfma_f32_16x16x32_bf16 v[56:59], a[104:107], v[160:163], v[56:59]
    s_waitcnt lgkmcnt(13)
    v_add_f32 v98, v98, v70
    ds_read_b128 v[20:23], v14 offset:2752
    v_mfma_f32_16x16x32_bf16 v[60:63], a[104:107], v[152:155], v[60:63]
    v_add_f32 v99, v99, v71
    ds_read_b128 v[224:227], v14 offset:944
    v_mfma_f32_16x16x32_bf16 v[56:59], a[12:15], v[180:183], v[56:59]
    v_cvt_pk_bf16_f32 v100, v92, v94
    ds_read_b128 v[28:31], v14 offset:928
    s_waitcnt lgkmcnt(6)
    v_mfma_f32_16x16x32_bf16 v[60:63], a[12:15], v[184:187], v[60:63]
    v_cvt_pk_bf16_f32 v101, v96, v98
    ds_read_b128 v[36:39], v14 offset:704
    v_mfma_f32_16x16x32_bf16 v[56:59], a[44:47], v[188:191], v[56:59]
    v_cvt_pk_bf16_f32 v102, v93, v95
    ds_read_b128 v[40:43], v14 offset:2176
    v_mfma_f32_16x16x32_bf16 v[60:63], a[44:47], v[176:179], v[60:63]
    v_cvt_pk_bf16_f32 v103, v97, v99
    ds_read_b128 v[44:47], v14 offset:3712
    v_mfma_f32_16x16x32_bf16 v[56:59], a[76:79], v[196:199], v[56:59]
    buffer_store_dwordx2 v[100:101], v9, s[24:27], s58 offen
    ds_read_b128 v[116:119], v14 offset:1456
    v_mfma_f32_16x16x32_bf16 v[60:63], a[76:79], v[200:203], v[60:63]
    ds_read_b128 v[24:27], v14 offset:1440
    v_mfma_f32_16x16x32_bf16 v[56:59], a[108:111], v[204:207], v[56:59]
    ds_read_b128 v[120:123], v14 offset:1664
    v_mfma_f32_16x16x32_bf16 v[60:63], a[108:111], v[180:183], v[60:63]
    ds_read_b128 v[32:35], v14 offset:3200
    v_mfma_f32_16x16x32_bf16 v[56:59], a[16:19], v[192:195], v[56:59]
    ds_read_b128 v[112:115], v14 offset:1152
    v_mfma_f32_16x16x32_bf16 v[60:63], a[16:19], v[212:215], v[60:63]
    ds_read_b128 v[132:135], v14 offset:2688
    v_mfma_f32_16x16x32_bf16 v[80:83], v[216:219], v[104:107], 0
    ds_read_b128 v[136:139], v14 offset:1968
    v_mfma_f32_16x16x32_bf16 v[84:87], v[220:223], v[108:111], 0
    ds_read_b128 v[128:131], v14 offset:1952
    s_waitcnt lgkmcnt(6)
    v_mfma_f32_16x16x32_bf16 v[56:59], a[48:51], v[208:211], v[56:59]
    ds_read_b128 v[148:151], v14 offset:640
    v_mfma_f32_16x16x32_bf16 v[60:63], a[48:51], v[228:231], v[60:63]
    ds_read_b128 v[124:127], v14 offset:2112
    v_mfma_f32_16x16x32_bf16 v[56:59], a[80:83], v[16:19], v[56:59]
    s_nop 0
    v_cvt_pk_bf16_f32 v140, v80, v84
    v_cvt_pk_bf16_f32 v141, v81, v85
    ds_read_b128 v[156:159], v14 offset:3648
    v_mfma_f32_16x16x32_bf16 v[60:63], a[80:83], v[20:23], v[60:63]
    v_cvt_pk_bf16_f32 v142, v82, v86
    v_cvt_pk_bf16_f32 v143, v83, v87
    ds_read_b128 v[144:147], v14 offset:1600
    v_mfma_f32_16x16x32_bf16 v[80:83], v[224:227], v[104:107], 0
    ds_read_b128 v[164:167], v14 offset:3136
    v_mfma_f32_16x16x32_bf16 v[84:87], v[28:31], v[108:111], 0
    ds_read_b128 v[172:175], v14 offset:1088
    v_mfma_f32_16x16x32_bf16 v[56:59], a[112:115], v[36:39], v[56:59]
    ds_read_b128 v[160:163], v14 offset:2624
    v_mfma_f32_16x16x32_bf16 v[60:63], a[112:115], v[192:195], v[60:63]
    ds_read_b128 v[152:155], v14 offset:576
    v_mfma_f32_16x16x32_bf16 v[56:59], a[20:23], v[40:43], v[56:59]
    s_nop 1
    v_cvt_pk_bf16_f32 v168, v80, v84
    v_cvt_pk_bf16_f32 v169, v81, v85
    ds_read_b128 v[184:187], v8 offset:0
    v_mfma_f32_16x16x32_bf16 v[60:63], a[20:23], v[44:47], v[60:63]
    v_cvt_pk_bf16_f32 v170, v82, v86
    v_cvt_pk_bf16_f32 v171, v83, v87
    ds_read_b128 v[188:191], v14 offset:2048
    v_mfma_f32_16x16x32_bf16 v[80:83], v[116:119], v[104:107], 0
    ds_read_b128 v[176:179], v8 offset:12480
    v_mfma_f32_16x16x32_bf16 v[84:87], v[24:27], v[108:111], 0
    ds_read_b128 v[200:203], v14 offset:3584
    s_waitcnt lgkmcnt(6)
    v_mfma_f32_16x16x32_bf16 v[56:59], a[52:55], v[120:123], v[56:59]
    ds_read_b128 v[204:207], v8 offset:8320
    v_mfma_f32_16x16x32_bf16 v[60:63], a[52:55], v[32:35], v[60:63]
    buffer_store_dwordx2 v[102:103], v9, s[24:27], s58 offen offset:1024
    ds_read_b128 v[180:183], v14 offset:1536
    v_mfma_f32_16x16x32_bf16 v[56:59], a[84:87], v[112:115], v[56:59]
    v_cvt_pk_bf16_f32 v196, v80, v84
    v_cvt_pk_bf16_f32 v197, v81, v85
    ds_read_b128 v[212:215], v8 offset:4160
    v_mfma_f32_16x16x32_bf16 v[60:63], a[84:87], v[132:135], v[60:63]
    v_cvt_pk_bf16_f32 v198, v82, v86
    v_cvt_pk_bf16_f32 v199, v83, v87
    ds_read_b128 v[216:219], v14 offset:3072
    v_mfma_f32_16x16x32_bf16 v[80:83], v[136:139], v[104:107], 0
    ds_read_b128 v[220:223], v14 offset:1024
    v_mfma_f32_16x16x32_bf16 v[84:87], v[128:131], v[108:111], 0
    ds_read_b128 v[228:231], v14 offset:2560
    v_mfma_f32_16x16x32_bf16 v[56:59], a[116:119], v[148:151], v[56:59]
    ds_read_b128 v[16:19], v14 offset:512
    v_mfma_f32_16x16x32_bf16 v[60:63], a[116:119], v[40:43], v[60:63]
    v_mfma_f32_16x16x32_bf16 v[56:59], a[24:27], v[124:127], v[56:59]
    s_nop 2
    v_cvt_pk_bf16_f32 v208, v80, v84
    v_cvt_pk_bf16_f32 v209, v81, v85
    v_mfma_f32_16x16x32_bf16 v[60:63], a[24:27], v[156:159], v[60:63]
    v_cvt_pk_bf16_f32 v210, v82, v86
    v_cvt_pk_bf16_f32 v211, v83, v87
    v_mfma_f32_16x16x32_bf16 v[56:59], a[56:59], v[144:147], v[56:59]
    v_mfma_f32_16x16x32_bf16 v[60:63], a[56:59], v[164:167], v[60:63]
    v_mfma_f32_16x16x32_bf16 v[56:59], a[88:91], v[172:175], v[56:59]
    s_waitcnt lgkmcnt(0)
    v_mfma_f32_16x16x32_bf16 v[60:63], a[88:91], v[160:163], v[60:63]
    v_mfma_f32_16x16x32_bf16 v[56:59], a[120:123], v[152:155], v[56:59]
    v_mfma_f32_16x16x32_bf16 v[60:63], a[120:123], v[124:127], v[60:63]
    v_mfma_f32_16x16x32_bf16 v[56:59], v[140:143], v[184:187], v[56:59]
    v_mfma_f32_16x16x32_bf16 v[56:59], a[28:31], v[188:191], v[56:59]
    v_mfma_f32_16x16x32_bf16 v[60:63], v[140:143], v[176:179], v[60:63]
    v_mfma_f32_16x16x32_bf16 v[60:63], a[28:31], v[200:203], v[60:63]
    v_mfma_f32_16x16x32_bf16 v[60:63], v[168:171], v[204:207], v[60:63]
    v_mfma_f32_16x16x32_bf16 v[56:59], a[60:63], v[180:183], v[56:59]
    v_mfma_f32_16x16x32_bf16 v[60:63], v[196:199], v[212:215], v[60:63]
    v_mfma_f32_16x16x32_bf16 v[60:63], a[60:63], v[216:219], v[60:63]
    v_mfma_f32_16x16x32_bf16 v[60:63], v[208:211], v[184:187], v[60:63]
    v_mfma_f32_16x16x32_bf16 v[56:59], a[92:95], v[220:223], v[56:59]
    v_mfma_f32_16x16x32_bf16 v[60:63], a[92:95], v[228:231], v[60:63]
    v_mfma_f32_16x16x32_bf16 v[56:59], a[124:127], v[16:19], v[56:59]
    v_mfma_f32_16x16x32_bf16 v[60:63], a[124:127], v[188:191], v[60:63]
    s_branch L_c1_epi
L_c1_p1:
    ds_read_b128 v[112:115], v14 offset:960
    ds_read_b128 v[116:119], v14 offset:1472
    ds_read_b128 v[120:123], v14 offset:448
    ds_read_b128 v[124:127], v14 offset:896
    s_waitcnt lgkmcnt(3)
    v_mfma_f32_16x16x32_bf16 v[48:51], a[0:3], v[112:115], 0
    ds_read_b128 v[128:131], v14 offset:1408
    s_waitcnt lgkmcnt(3)
    v_mfma_f32_16x16x32_bf16 v[52:55], a[0:3], v[116:119], 0
    ds_read_b128 v[132:135], v14 offset:384
    s_waitcnt lgkmcnt(3)
    v_mfma_f32_16x16x32_bf16 v[48:51], a[32:35], v[120:123], v[48:51]
    ds_read_b128 v[136:139], v14 offset:832
    v_mfma_f32_16x16x32_bf16 v[52:55], a[32:35], v[112:115], v[52:55]
    ds_read_b128 v[140:143], v14 offset:1344
    v_mfma_f32_16x16x32_bf16 v[52:55], a[64:67], v[120:123], v[52:55]
    ds_read_b128 v[144:147], v14 offset:320
    s_waitcnt lgkmcnt(5)
    v_mfma_f32_16x16x32_bf16 v[48:51], a[4:7], v[124:127], v[48:51]
    ds_read_b128 v[148:151], v14 offset:768
    s_waitcnt lgkmcnt(5)
    v_mfma_f32_16x16x32_bf16 v[52:55], a[4:7], v[128:131], v[52:55]
    ds_read_b128 v[152:155], v14 offset:1280
    s_waitcnt lgkmcnt(5)
    v_mfma_f32_16x16x32_bf16 v[48:51], a[36:39], v[132:135], v[48:51]
    ds_read_b128 v[156:159], v14 offset:256
    v_mfma_f32_16x16x32_bf16 v[52:55], a[36:39], v[124:127], v[52:55]
    ds_read_b128 v[160:163], v14 offset:704
    v_mfma_f32_16x16x32_bf16 v[52:55], a[68:71], v[132:135], v[52:55]
    ds_read_b128 v[164:167], v14 offset:1216
    s_waitcnt lgkmcnt(6)
    v_mfma_f32_16x16x32_bf16 v[48:51], a[8:11], v[136:139], v[48:51]
    ds_read_b128 v[168:171], v14 offset:192
    v_mfma_f32_16x16x32_bf16 v[52:55], a[8:11], v[140:143], v[52:55]
    ds_read_b128 v[172:175], v14 offset:640
    s_waitcnt lgkmcnt(6)
    v_mfma_f32_16x16x32_bf16 v[48:51], a[40:43], v[144:147], v[48:51]
    ds_read_b128 v[176:179], v14 offset:1152
    v_mfma_f32_16x16x32_bf16 v[52:55], a[40:43], v[136:139], v[52:55]
    ds_read_b128 v[180:183], v14 offset:128
    v_mfma_f32_16x16x32_bf16 v[52:55], a[72:75], v[144:147], v[52:55]
    ds_read_b128 v[184:187], v14 offset:576
    v_mfma_f32_16x16x32_bf16 v[48:51], a[12:15], v[148:151], v[48:51]
    ds_read_b128 v[188:191], v14 offset:1088
    s_waitcnt lgkmcnt(6)
    v_mfma_f32_16x16x32_bf16 v[52:55], a[12:15], v[152:155], v[52:55]
    ds_read_b128 v[192:195], v14 offset:64
    v_mfma_f32_16x16x32_bf16 v[48:51], a[44:47], v[156:159], v[48:51]
    ds_read_b128 v[196:199], v14 offset:512
    v_mfma_f32_16x16x32_bf16 v[52:55], a[44:47], v[148:151], v[52:55]
    ds_read_b128 v[200:203], v14 offset:1024
    v_mfma_f32_16x16x32_bf16 v[52:55], a[76:79], v[156:159], v[52:55]
    ds_read_b128 v[204:207], v14 offset:0
    v_mfma_f32_16x16x32_bf16 v[48:51], a[16:19], v[160:163], v[48:51]
    ds_read_b128 v[208:211], v14 offset:3008
    v_mfma_f32_16x16x32_bf16 v[52:55], a[16:19], v[164:167], v[52:55]
    ds_read_b128 v[212:215], v14 offset:3520
    s_waitcnt lgkmcnt(6)
    v_mfma_f32_16x16x32_bf16 v[48:51], a[48:51], v[168:171], v[48:51]
    ds_read_b128 v[216:219], v14 offset:2496
    v_mfma_f32_16x16x32_bf16 v[52:55], a[48:51], v[160:163], v[52:55]
    ds_read_b128 v[220:223], v14 offset:1984
    v_mfma_f32_16x16x32_bf16 v[52:55], a[80:83], v[168:171], v[52:55]
    ds_read_b128 v[224:227], v14 offset:1472
    v_mfma_f32_16x16x32_bf16 v[48:51], a[20:23], v[172:175], v[48:51]
    ds_read_b128 v[228:231], v14 offset:960
    v_mfma_f32_16x16x32_bf16 v[52:55], a[20:23], v[176:179], v[52:55]
    ds_read_b128 v[16:19], v14 offset:2944
    v_mfma_f32_16x16x32_bf16 v[48:51], a[52:55], v[180:183], v[48:51]
    ds_read_b128 v[20:23], v14 offset:3456
    v_mfma_f32_16x16x32_bf16 v[52:55], a[52:55], v[172:175], v[52:55]
    ds_read_b128 v[24:27], v14 offset:2432
    v_mfma_f32_16x16x32_bf16 v[52:55], a[84:87], v[180:183], v[52:55]
    ds_read_b128 v[28:31], v14 offset:1920
    v_mfma_f32_16x16x32_bf16 v[48:51], a[24:27], v[184:187], v[48:51]
    ds_read_b128 v[32:35], v14 offset:1408
    v_mfma_f32_16x16x32_bf16 v[52:55], a[24:27], v[188:191], v[52:55]
    ds_read_b128 v[36:39], v14 offset:2880
    s_waitcnt lgkmcnt(6)
    v_mfma_f32_16x16x32_bf16 v[48:51], a[56:59], v[192:195], v[48:51]
    ds_read_b128 v[40:43], v14 offset:3392
    v_mfma_f32_16x16x32_bf16 v[52:55], a[56:59], v[184:187], v[52:55]
    ds_read_b128 v[44:47], v14 offset:2368
    v_mfma_f32_16x16x32_bf16 v[52:55], a[88:91], v[192:195], v[52:55]
    ds_read_b128 v[116:119], v14 offset:1856
    v_mfma_f32_16x16x32_bf16 v[48:51], a[28:31], v[196:199], v[48:51]
    ds_read_b128 v[112:115], v14 offset:1344
    v_mfma_f32_16x16x32_bf16 v[52:55], a[28:31], v[200:203], v[52:55]
    ds_read_b128 v[120:123], v14 offset:2816
    v_mfma_f32_16x16x32_bf16 v[48:51], a[60:63], v[204:207], v[48:51]
    ds_read_b128 v[128:131], v14 offset:3328
    v_mfma_f32_16x16x32_bf16 v[52:55], a[60:63], v[196:199], v[52:55]
    ds_read_b128 v[124:127], v14 offset:2304
    v_mfma_f32_16x16x32_bf16 v[52:55], a[92:95], v[204:207], v[52:55]
    ds_read_b128 v[132:135], v14 offset:1792
    v_mfma_f32_16x16x32_bf16 v[56:59], a[0:3], v[208:211], 0
    ds_read_b128 v[140:143], v14 offset:1280
    v_mfma_f32_16x16x32_bf16 v[60:63], a[0:3], v[212:215], 0
    ds_read_b128 v[136:139], v14 offset:2752
    v_mfma_f32_16x16x32_bf16 v[56:59], a[32:35], v[216:219], v[56:59]
    ds_write_b128 v11, v[48:51]
    ds_read_b128 v[144:147], v14 offset:3264
    v_mfma_f32_16x16x32_bf16 v[60:63], a[32:35], v[208:211], v[60:63]
    ds_write_b128 v11, v[52:55] offset:1152
    ds_read_b128 v[152:155], v14 offset:432
    v_mfma_f32_16x16x32_bf16 v[56:59], a[64:67], v[220:223], v[56:59]
    ds_read_b128 v[148:151], v14 offset:416
    v_mfma_f32_16x16x32_bf16 v[60:63], a[64:67], v[216:219], v[60:63]
    ds_read_b128 v[156:159], v14 offset:2240
    v_mfma_f32_16x16x32_bf16 v[56:59], a[96:99], v[224:227], v[56:59]
    ds_read_b128 v[164:167], v14 offset:1728
    v_mfma_f32_16x16x32_bf16 v[60:63], a[96:99], v[220:223], v[60:63]
    s_waitcnt lgkmcnt(0)
    s_barrier
    ds_read_b128 v[160:163], v14 offset:944
    v_mfma_f32_16x16x32_bf16 v[56:59], a[128:131], v[228:231], v[56:59]
    ds_read_b64 v[92:93], v12 offset:0
    ds_read_b128 v[168:171], v14 offset:928
    v_mfma_f32_16x16x32_bf16 v[60:63], a[128:131], v[224:227], v[60:63]
    ds_read_b64 v[94:95], v12 offset:4608
    ds_read_b128 v[176:179], v14 offset:1216
    v_mfma_f32_16x16x32_bf16 v[56:59], a[4:7], v[16:19], v[56:59]
    ds_read_b64 v[96:97], v12 offset:9216
    ds_read_b128 v[172:175], v14 offset:2688
    v_mfma_f32_16x16x32_bf16 v[60:63], a[4:7], v[20:23], v[60:63]
    ds_read_b64 v[98:99], v12 offset:13824
    ds_read_b128 v[180:183], v14 offset:3200
    v_mfma_f32_16x16x32_bf16 v[56:59], a[36:39], v[24:27], v[56:59]
    ds_read_b128 v[188:191], v14 offset:1456
    v_mfma_f32_16x16x32_bf16 v[60:63], a[36:39], v[16:19], v[60:63]
    ds_read_b128 v[184:187], v14 offset:1440
    v_mfma_f32_16x16x32_bf16 v[56:59], a[68:71], v[28:31], v[56:59]
    ds_read_b128 v[192:195], v14 offset:2176
    v_mfma_f32_16x16x32_bf16 v[60:63], a[68:71], v[24:27], v[60:63]
    ds_read_b128 v[200:203], v14 offset:1664
    v_mfma_f32_16x16x32_bf16 v[56:59], a[100:103], v[32:35], v[56:59]
    ds_read_b128 v[196:199], v14 offset:1152
    v_mfma_f32_16x16x32_bf16 v[60:63], a[100:103], v[28:31], v[60:63]
    ds_read_b128 v[204:207], v14 offset:2624
    v_mfma_f32_16x16x32_bf16 v[56:59], a[8:11], v[36:39], v[56:59]
    s_waitcnt lgkmcnt(13)
    v_add_f32 v92, v92, v64
    ds_read_b128 v[212:215], v14 offset:3136
    v_mfma_f32_16x16x32_bf16 v[60:63], a[8:11], v[40:43], v[60:63]
    v_add_f32 v93, v93, v65
    ds_read_b128 v[208:211], v14 offset:2112
    v_mfma_f32_16x16x32_bf16 v[56:59], a[40:43], v[44:47], v[56:59]
    s_waitcnt lgkmcnt(13)
    v_add_f32 v94, v94, v66
    ds_read_b128 v[216:219], v8 offset:4160
    v_mfma_f32_16x16x32_bf16 v[60:63], a[40:43], v[36:39], v[60:63]
    v_add_f32 v95, v95, v67
    ds_read_b128 v[220:223], v14 offset:1600
    v_mfma_f32_16x16x32_bf16 v[56:59], a[72:75], v[116:119], v[56:59]
    s_waitcnt lgkmcnt(13)
    v_add_f32 v96, v96, v68
    ds_read_b128 v[228:231], v8 offset:8320
    v_mfma_f32_16x16x32_bf16 v[60:63], a[72:75], v[44:47], v[60:63]
    v_add_f32 v97, v97, v69
    ds_read_b128 v[224:227], v8 offset:0
    v_mfma_f32_16x16x32_bf16 v[56:59], a[104:107], v[112:115], v[56:59]
    s_waitcnt lgkmcnt(13)
    v_add_f32 v98, v98, v70
    ds_read_b128 v[20:23], v14 offset:1088
    v_mfma_f32_16x16x32_bf16 v[60:63], a[104:107], v[116:119], v[60:63]
    v_add_f32 v99, v99, v71
    ds_read_b128 v[16:19], v14 offset:2560
    v_mfma_f32_16x16x32_bf16 v[56:59], a[12:15], v[120:123], v[56:59]
    v_cvt_pk_bf16_f32 v100, v92, v94
    ds_read_b128 v[24:27], v14 offset:3072
    v_mfma_f32_16x16x32_bf16 v[60:63], a[12:15], v[128:131], v[60:63]
    v_cvt_pk_bf16_f32 v101, v96, v98
    ds_read_b128 v[32:35], v14 offset:2048
    v_mfma_f32_16x16x32_bf16 v[56:59], a[44:47], v[124:127], v[56:59]
    v_cvt_pk_bf16_f32 v102, v93, v95
    ds_read_b128 v[28:31], v14 offset:1536
    v_mfma_f32_16x16x32_bf16 v[60:63], a[44:47], v[120:123], v[60:63]
    v_cvt_pk_bf16_f32 v103, v97, v99
    ds_read_b128 v[40:43], v14 offset:1024
    v_mfma_f32_16x16x32_bf16 v[56:59], a[76:79], v[132:135], v[56:59]
    buffer_store_dwordx2 v[100:101], v9, s[24:27], s58 offen
    v_mfma_f32_16x16x32_bf16 v[60:63], a[76:79], v[124:127], v[60:63]
    v_mfma_f32_16x16x32_bf16 v[56:59], a[108:111], v[140:143], v[56:59]
    v_mfma_f32_16x16x32_bf16 v[60:63], a[108:111], v[132:135], v[60:63]
    v_mfma_f32_16x16x32_bf16 v[56:59], a[16:19], v[136:139], v[56:59]
    v_mfma_f32_16x16x32_bf16 v[60:63], a[16:19], v[144:147], v[60:63]
    v_mfma_f32_16x16x32_bf16 v[80:83], v[152:155], v[104:107], 0
    v_mfma_f32_16x16x32_bf16 v[84:87], v[148:151], v[108:111], 0
    v_mfma_f32_16x16x32_bf16 v[56:59], a[48:51], v[156:159], v[56:59]
    v_mfma_f32_16x16x32_bf16 v[60:63], a[48:51], v[136:139], v[60:63]
    v_mfma_f32_16x16x32_bf16 v[56:59], a[80:83], v[164:167], v[56:59]
    s_nop 4
    v_cvt_pk_bf16_f32 v36, v80, v84
    v_cvt_pk_bf16_f32 v37, v81, v85
    v_mfma_f32_16x16x32_bf16 v[60:63], a[80:83], v[156:159], v[60:63]
    v_cvt_pk_bf16_f32 v38, v82, v86
    v_cvt_pk_bf16_f32 v39, v83, v87
    v_mfma_f32_16x16x32_bf16 v[80:83], v[160:163], v[104:107], 0
    v_mfma_f32_16x16x32_bf16 v[84:87], v[168:171], v[108:111], 0
    v_mfma_f32_16x16x32_bf16 v[56:59], a[112:115], v[176:179], v[56:59]
    v_mfma_f32_16x16x32_bf16 v[60:63], a[112:115], v[164:167], v[60:63]
    v_mfma_f32_16x16x32_bf16 v[56:59], a[20:23], v[172:175], v[56:59]
    s_nop 4
    v_cvt_pk_bf16_f32 v44, v80, v84
    v_cvt_pk_bf16_f32 v45, v81, v85
    s_waitcnt lgkmcnt(0)
    v_mfma_f32_16x16x32_bf16 v[60:63], a[20:23], v[180:183], v[60:63]
    v_cvt_pk_bf16_f32 v46, v82, v86
    v_cvt_pk_bf16_f32 v47, v83, v87
    v_mfma_f32_16x16x32_bf16 v[80:83], v[188:191], v[104:107], 0
    v_mfma_f32_16x16x32_bf16 v[84:87], v[184:187], v[108:111], 0
    v_mfma_f32_16x16x32_bf16 v[56:59], a[52:55], v[192:195], v[56:59]
    v_mfma_f32_16x16x32_bf16 v[60:63], a[52:55], v[172:175], v[60:63]
    buffer_store_dwordx2 v[102:103], v9, s[24:27], s58 offen offset:1024
    v_mfma_f32_16x16x32_bf16 v[56:59], a[84:87], v[200:203], v[56:59]
    s_nop 3
    v_cvt_pk_bf16_f32 v112, v80, v84
    v_cvt_pk_bf16_f32 v113, v81, v85
    v_mfma_f32_16x16x32_bf16 v[60:63], a[84:87], v[192:195], v[60:63]
    v_cvt_pk_bf16_f32 v114, v82, v86
    v_cvt_pk_bf16_f32 v115, v83, v87
    v_mfma_f32_16x16x32_bf16 v[56:59], a[116:119], v[196:199], v[56:59]
    v_mfma_f32_16x16x32_bf16 v[60:63], a[116:119], v[200:203], v[60:63]
    v_mfma_f32_16x16x32_bf16 v[56:59], a[24:27], v[204:207], v[56:59]
    v_mfma_f32_16x16x32_bf16 v[60:63], a[24:27], v[212:215], v[60:63]
    v_mfma_f32_16x16x32_bf16 v[56:59], a[56:59], v[208:211], v[56:59]
    v_mfma_f32_16x16x32_bf16 v[60:63], a[56:59], v[204:207], v[60:63]
    v_mfma_f32_16x16x32_bf16 v[56:59], v[36:39], v[216:219], v[56:59]
    v_mfma_f32_16x16x32_bf16 v[56:59], a[88:91], v[220:223], v[56:59]
    v_mfma_f32_16x16x32_bf16 v[60:63], v[36:39], v[228:231], v[60:63]
    v_mfma_f32_16x16x32_bf16 v[60:63], a[88:91], v[208:211], v[60:63]
    v_mfma_f32_16x16x32_bf16 v[56:59], v[44:47], v[224:227], v[56:59]
    v_mfma_f32_16x16x32_bf16 v[56:59], a[120:123], v[20:23], v[56:59]
    v_mfma_f32_16x16x32_bf16 v[60:63], v[44:47], v[216:219], v[60:63]
    v_mfma_f32_16x16x32_bf16 v[60:63], a[120:123], v[220:223], v[60:63]
    v_mfma_f32_16x16x32_bf16 v[60:63], v[112:115], v[224:227], v[60:63]
    v_mfma_f32_16x16x32_bf16 v[56:59], a[28:31], v[16:19], v[56:59]
    v_mfma_f32_16x16x32_bf16 v[60:63], a[28:31], v[24:27], v[60:63]
    v_mfma_f32_16x16x32_bf16 v[56:59], a[60:63], v[32:35], v[56:59]
    v_mfma_f32_16x16x32_bf16 v[60:63], a[60:63], v[16:19], v[60:63]
    v_mfma_f32_16x16x32_bf16 v[56:59], a[92:95], v[28:31], v[56:59]
    v_mfma_f32_16x16x32_bf16 v[60:63], a[92:95], v[32:35], v[60:63]
    v_mfma_f32_16x16x32_bf16 v[56:59], a[124:127], v[40:43], v[56:59]
    v_mfma_f32_16x16x32_bf16 v[60:63], a[124:127], v[28:31], v[60:63]
L_c1_epi:
    s_nop 6
    ds_write_b128 v11, v[56:59] offset:2304
    ds_write_b128 v11, v[60:63] offset:3456
    s_waitcnt lgkmcnt(0)
    s_barrier
    ds_read_b64 v[92:93], v12 offset:2304
    ds_read_b64 v[94:95], v12 offset:6912
    ds_read_b64 v[96:97], v12 offset:11520
    ds_read_b64 v[98:99], v12 offset:16128
    s_waitcnt lgkmcnt(3)
    v_pk_add_f32 v[92:93], v[92:93], v[72:73]
    s_waitcnt lgkmcnt(2)
    v_pk_add_f32 v[94:95], v[94:95], v[74:75]
    s_waitcnt lgkmcnt(1)
    v_pk_add_f32 v[96:97], v[96:97], v[76:77]
    s_waitcnt lgkmcnt(0)
    v_pk_add_f32 v[98:99], v[98:99], v[78:79]
    v_cvt_pk_bf16_f32 v100, v92, v94
    v_cvt_pk_bf16_f32 v101, v96, v98
    v_cvt_pk_bf16_f32 v102, v93, v95
    v_cvt_pk_bf16_f32 v103, v97, v99
    buffer_store_dwordx2 v[100:101], v9, s[24:27], s59 offen
    buffer_store_dwordx2 v[102:103], v9, s[24:27], s59 offen offset:1024
L_end:
    s_endpgm
L_fl_spin:
    s_sleep 1
    buffer_load_dword v17, v15, s[20:23], 0 offen sc1
    s_waitcnt vmcnt(0)
    v_cmp_eq_u32 vcc, 0, v17
    s_sub_u32 s46, s46, 1
    s_cbranch_scc1 L_fl_ok
    s_cbranch_vccnz L_fl_spin
    s_branch L_fl_ok
.p2align 8
.fill 256, 4, 0xbf800000
L_code_end:
L_za:
L_zb:
.section .rodata,"a"
.p2align 6
.amdhsa_kernel interleave_layers__linear_attn_block__ssm_conv_s4__prompt_kernel
  .amdhsa_next_free_vgpr 512
  .amdhsa_next_free_sgpr 102
  .amdhsa_accum_offset 256
  .amdhsa_group_segment_fixed_size 0
  .amdhsa_kernarg_size 120
  .amdhsa_user_sgpr_count 2
  .amdhsa_user_sgpr_kernarg_segment_ptr 1
  .amdhsa_system_sgpr_workgroup_id_x 1
  .amdhsa_float_denorm_mode_32 3
  .amdhsa_float_denorm_mode_16_64 3
.end_amdhsa_kernel
```
